```python
import torch

def _softmax(x, axis=-1):
    return torch.softmax(x, dim=axis)
def _gelu(x):
    return torch.nn.functional.gelu(x, approximate="tanh")
def _silu(x):
    return torch.nn.functional.silu(x)
def _sigmoid(x):
    return torch.sigmoid(x)
def _layernorm(x, axis=-1, eps=1e-5):
    m = x.mean(dim=axis, keepdim=True)
    v = x.var(dim=axis, keepdim=True, unbiased=False)
    return (x - m) / torch.sqrt(v + eps)
def _scatter_add(tgt, idx, src, axis=0):
    return tgt.clone().index_add_(axis, idx, src)
def _segment_sum(src, seg, n):
    out = torch.zeros((n,) + src.shape[1:], dtype=src.dtype)
    return out.index_add_(0, seg, src)
def _pad(x, pw):
    flat = tuple(v for pair in reversed(pw) for v in pair)
    return torch.nn.functional.pad(x, flat)

kernel_name = 'standalone__gqa_softmax__near_ridge'

def setup_inputs():

    _w = (lambda a: (lambda t: t.to(torch.bfloat16) if t.is_floating_point() else t)(torch.as_tensor(a)))
    B, Hq, Hkv, Sq, Sk, D = 16, 32, 8, 496, 512, 128
    return {
        "q": _w((lambda *s: torch.randn(*s, dtype=torch.bfloat16) * 0.8)(B, Hq, Sq, D)),
        "k": _w((lambda *s: torch.randn(*s, dtype=torch.bfloat16) * 0.8)(B, Hkv, Sk, D)),
        "v": _w((lambda *s: torch.randn(*s, dtype=torch.bfloat16) * 0.05)(B, Hkv, Sk, D)),
    }

def reference(q, k, v):
    B, Hq, Sq, D = q.shape
    Hkv = k.shape[1]
    rep = Hq // Hkv
    k = (lambda x, n, axis: torch.repeat_interleave(x, n, dim=axis))(k, rep, axis=1)
    v = (lambda x, n, axis: torch.repeat_interleave(x, n, dim=axis))(v, rep, axis=1)
    scale = D ** -0.5
    scores = torch.einsum("bhqd,bhkd->bhqk", q, k) * scale
    p = _softmax(scores, axis=-1)
    return torch.einsum("bhqk,bhkd->bhqd", p, v)
```

```asm
; @launch grid=(256,1,1) block=(256,1,1) lds=163840
.amdgcn_target "amdgcn-amd-amdhsa--gfx950"
.text
.globl standalone__gqa_softmax__near_ridge_kernel
.p2align 8
.type standalone__gqa_softmax__near_ridge_kernel,@function
standalone__gqa_softmax__near_ridge_kernel:

    s_cmp_ge_u32 s2, 256
    s_cbranch_scc1 L_end
    s_load_dwordx4 s[4:7], s[0:1], 0
    s_load_dwordx4 s[8:11], s[0:1], 16
    s_getpc_b64 s[80:81]
L_pc:
    v_lshlrev_b32 v228, 6, v0
    s_mov_b32 s82, L_pass-L_pc-4
    v_min_u32 v229, s82, v228
    global_load_dword v230, v229, s[80:81]
    v_add_u32 v228, 16384, v228
    v_min_u32 v229, s82, v228
    global_load_dword v231, v229, s[80:81]
    v_add_u32 v228, 16384, v228
    v_min_u32 v229, s82, v228
    global_load_dword v232, v229, s[80:81]
    v_add_u32 v228, 16384, v228
    v_lshlrev_b32 v254, 7, v0
    v_add_u32 v254, L_pass-L_pc, v254
    s_mov_b32 s82, L_code_end-L_pc-68
    v_min_u32 v254, s82, v254
    v_and_b32 v224, 63, v0
    v_lshrrev_b32 v225, 6, v0
    v_mov_b32 v255, 0x78
    v_readfirstlane_b32 s28, v225
    v_and_b32 v225, 15, v224
    v_lshrrev_b32 v226, 4, v224
    v_lshlrev_b32 v246, 8, v225
    v_lshl_add_u32 v246, v226, 4, v246
    v_lshrrev_b32 v227, 2, v225
    v_lshlrev_b32 v216, 1, v227
    v_lshrrev_b32 v227, v216, v255
    v_and_b32 v227, 3, v227

    v_xor_b32 v227, v227, v226
    v_lshl_add_u32 v227, v225, 2, v227
    v_lshlrev_b32 v240, 4, v227
    v_add_u32 v241, 0x10000, v240
    v_lshlrev_b32 v227, 2, v226
    v_xor_b32 v227, v227, v225
    v_lshlrev_b32 v227, 4, v227
    v_lshl_add_u32 v247, v226, 8, v227
    v_lshrrev_b32 v225, 4, v224
    v_lshlrev_b32 v216, 1, v225
    v_lshrrev_b32 v225, v216, v255
    v_and_b32 v225, 3, v225

    v_and_b32 v227, 3, v224
    v_xor_b32 v225, v225, v227
    v_lshlrev_b32 v225, 4, v225
    v_lshrrev_b32 v227, 2, v224
    v_lshl_add_u32 v252, v227, 8, v225
    v_bfe_u32 v225, v224, 2, 2
    v_and_b32 v227, 3, v224
    v_lshl_add_u32 v226, v226, 2, v225
    v_lshlrev_b32 v226, 8, v226
    v_lshl_add_u32 v226, v227, 4, v226
    v_add_u32 v226, 131072, v226
    v_xor_b32 v227, 0, v225
    v_lshl_add_u32 v242, v227, 6, v226
    v_xor_b32 v227, 1, v225
    v_lshl_add_u32 v243, v227, 6, v226
    v_xor_b32 v227, 2, v225
    v_lshl_add_u32 v244, v227, 6, v226
    v_xor_b32 v227, 3, v225
    v_lshl_add_u32 v245, v227, 6, v226

    v_lshlrev_b32 v253, 7, v224
    v_lshlrev_b32 v224, 4, v224
    s_and_b32 s45, s2, 7
    s_lshr_b32 s46, s2, 3
    s_lshl_b32 s45, s45, 4
    s_lshr_b32 s52, s46, 1
    s_add_u32 s45, s45, s52
    s_and_b32 s46, s46, 1
    s_lshl_b32 s49, s45, 17
    s_mul_i32 s41, s45, 507904
    s_mul_i32 s52, s46, 253952
    s_add_u32 s41, s41, s52
    s_mul_i32 s53, s46, 0
    s_mul_i32 s83, s46, 131072
    s_mov_b32 s84, s46
    s_lshl_b32 s45, s28, 11
    s_add_u32 s38, s49, s45
    s_sub_u32 s70, s38, s83
    s_add_u32 s38, s38, s53
    s_add_u32 s40, s45, 131072
    s_mov_b32 s47, 0x3e0293ee
    s_mov_b32 s50, 0x80000000
    s_mov_b64 s[42:43], 0
    s_mov_b32 s29, 0
    s_lshl_b32 s44, s28, 6
    s_add_u32 s45, s44, 0
    s_lshl_b32 s45, s45, 8
    s_add_u32 s30, s45, s41
    s_mov_b32 s34, s50
    s_add_u32 s45, s44, 16
    s_lshl_b32 s45, s45, 8
    s_add_u32 s31, s45, s41
    s_mov_b32 s35, s50
    s_add_u32 s45, s44, 32
    s_lshl_b32 s45, s45, 8
    s_add_u32 s32, s45, s41
    s_mov_b32 s36, s50
    s_add_u32 s45, s44, 48
    s_lshl_b32 s45, s45, 8
    s_add_u32 s33, s45, s41
    s_mov_b32 s37, s50
    s_lshr_b32 s45, s28, 1
    s_lshl_b32 s45, s45, 13
    s_and_b32 s46, s28, 1
    s_lshl_b32 s46, s46, 6
    s_add_u32 s45, s45, s46
    s_add_u32 s75, s45, s49
    s_sub_u32 s76, s75, s83
    s_add_u32 s75, s75, s53

    s_lshr_b32 s45, s28, 1
    s_lshl_b32 s45, s45, 12
    s_and_b32 s46, s28, 1
    s_lshl_b32 s52, s46, 7
    s_add_u32 s71, s49, s45
    s_add_u32 s71, s71, s52
    s_sub_u32 s72, s71, s83
    s_add_u32 s71, s71, s53
    s_lshl_b32 s46, s46, 11
    s_add_u32 s73, s45, s46
    v_add_u32 v248, s73, v224
    v_add_u32 v249, 0x10000, v248
    s_lshl_b32 s87, s28, 14
    s_add_u32 s87, s87, 0x10000
    v_add_u32 v251, s87, v240
    v_mov_b32 v255, 0x3f803f80
    v_accvgpr_write_b32 a240, v255
    v_accvgpr_write_b32 a241, v255
    v_accvgpr_write_b32 a242, v255
    v_accvgpr_write_b32 a243, v255
    v_mov_b32 v255, 0x4e800000
    s_waitcnt lgkmcnt(0)
    s_mov_b32 s12, s4
    s_and_b32 s13, s5, 0xffff
    s_mov_b32 s14, 65011712
    s_mov_b32 s15, 0x00020000
    s_mov_b32 s16, s6
    s_and_b32 s17, s7, 0xffff
    s_mov_b32 s18, 16777216
    s_mov_b32 s19, 0x00020000
    s_mov_b32 s20, s8
    s_and_b32 s21, s9, 0xffff
    s_mov_b32 s22, 16777216
    s_mov_b32 s23, 0x00020000
    s_mov_b32 s24, s10
    s_and_b32 s25, s11, 0xffff
    s_mov_b32 s26, 65011712
    s_mov_b32 s27, 0x00020000
    s_add_u32 m0, s73, 0
    s_add_u32 s74, s71, 0
    buffer_load_dwordx4 v252, s[16:19], s74 offen lds
    s_add_u32 m0, s73, 1024
    s_add_u32 s74, s71, 64
    buffer_load_dwordx4 v252, s[16:19], s74 offen lds
    s_add_u32 m0, s73, 8192
    s_add_u32 s74, s71, 8192
    buffer_load_dwordx4 v252, s[16:19], s74 offen lds
    s_add_u32 m0, s73, 9216
    s_add_u32 s74, s71, 8256
    buffer_load_dwordx4 v252, s[16:19], s74 offen lds
    s_add_u32 m0, s87, 0
    s_add_u32 s74, s30, 0
    buffer_load_dwordx4 v252, s[12:15], s74 offen lds
    s_add_u32 m0, s87, 1024
    s_add_u32 s74, s30, 64
    buffer_load_dwordx4 v252, s[12:15], s74 offen lds
    s_add_u32 m0, s87, 2048
    s_add_u32 s74, s30, 128
    buffer_load_dwordx4 v252, s[12:15], s74 offen lds
    s_add_u32 m0, s87, 3072
    s_add_u32 s74, s30, 192
    buffer_load_dwordx4 v252, s[12:15], s74 offen lds
    s_add_u32 m0, s87, 4096
    s_add_u32 s74, s31, 0
    buffer_load_dwordx4 v252, s[12:15], s74 offen lds
    s_add_u32 m0, s87, 5120
    s_add_u32 s74, s31, 64
    buffer_load_dwordx4 v252, s[12:15], s74 offen lds
    s_add_u32 m0, s87, 6144
    s_add_u32 s74, s31, 128
    buffer_load_dwordx4 v252, s[12:15], s74 offen lds
    s_add_u32 m0, s87, 7168
    s_add_u32 s74, s31, 192
    buffer_load_dwordx4 v252, s[12:15], s74 offen lds
    s_add_u32 m0, s87, 8192
    s_add_u32 s74, s32, 0
    buffer_load_dwordx4 v252, s[12:15], s74 offen lds
    s_add_u32 m0, s87, 9216
    s_add_u32 s74, s32, 64
    buffer_load_dwordx4 v252, s[12:15], s74 offen lds
    s_add_u32 m0, s87, 10240
    s_add_u32 s74, s32, 128
    buffer_load_dwordx4 v252, s[12:15], s74 offen lds
    s_add_u32 m0, s87, 11264
    s_add_u32 s74, s32, 192
    buffer_load_dwordx4 v252, s[12:15], s74 offen lds
    s_add_u32 m0, s87, 12288
    s_add_u32 s74, s33, 0
    buffer_load_dwordx4 v252, s[12:15], s74 offen lds
    s_add_u32 m0, s87, 13312
    s_add_u32 s74, s33, 64
    buffer_load_dwordx4 v252, s[12:15], s74 offen lds
    s_add_u32 m0, s87, 14336
    s_add_u32 s74, s33, 128
    buffer_load_dwordx4 v252, s[12:15], s74 offen lds
    s_add_u32 m0, s87, 15360
    s_add_u32 s74, s33, 192
    buffer_load_dwordx4 v252, s[12:15], s74 offen lds
    s_add_u32 m0, s73, 16384
    s_add_u32 s74, s71, 16384
    buffer_load_dwordx4 v252, s[16:19], s74 offen lds
    s_add_u32 m0, s73, 17408
    s_add_u32 s74, s71, 16448
    buffer_load_dwordx4 v252, s[16:19], s74 offen lds
    s_add_u32 m0, s73, 24576
    s_add_u32 s74, s71, 24576
    buffer_load_dwordx4 v252, s[16:19], s74 offen lds
    s_add_u32 m0, s73, 25600
    s_add_u32 s74, s71, 24640
    buffer_load_dwordx4 v252, s[16:19], s74 offen lds
    s_add_u32 m0, s40, 0
    s_add_u32 s39, s38, 0
    buffer_load_dwordx4 v247, s[20:23], s39 offen offset:0 lds
    buffer_load_dwordx4 v247, s[20:23], s39 offen offset:1024 lds
    s_add_u32 m0, s40, 8192
    s_add_u32 s51, s38, 8192
    buffer_load_dwordx4 v247, s[20:23], s51 offen offset:0 lds
    buffer_load_dwordx4 v247, s[20:23], s51 offen offset:1024 lds
    s_add_u32 s77, s75, 16384
    buffer_load_dword v250, v253, s[20:23], s77 offen
    s_add_u32 m0, s73, 32768
    s_add_u32 s74, s71, 32768
    buffer_load_dwordx4 v252, s[16:19], s74 offen lds
    s_add_u32 m0, s73, 33792
    s_add_u32 s74, s71, 32832
    buffer_load_dwordx4 v252, s[16:19], s74 offen lds
    s_add_u32 m0, s73, 40960
    s_add_u32 s74, s71, 40960
    buffer_load_dwordx4 v252, s[16:19], s74 offen lds
    s_add_u32 m0, s73, 41984
    s_add_u32 s74, s71, 41024
    buffer_load_dwordx4 v252, s[16:19], s74 offen lds
    s_mov_b32 s66, s34
    s_mov_b32 s34, s30
    s_mov_b32 s67, s35
    s_mov_b32 s35, s31
    s_mov_b32 s68, s36
    s_mov_b32 s36, s32
    s_mov_b32 s69, s37
    s_mov_b32 s37, s33
    s_add_u32 s44, s44, 256
    s_add_u32 s45, s44, 0
    s_lshl_b32 s46, s45, 8
    s_add_u32 s46, s46, s41
    s_cmp_lt_u32 s45, 992
    s_cselect_b32 s30, s46, s50
    s_add_u32 s45, s44, 16
    s_lshl_b32 s46, s45, 8
    s_add_u32 s46, s46, s41
    s_cmp_lt_u32 s45, 992
    s_cselect_b32 s31, s46, s50
    s_add_u32 s45, s44, 32
    s_lshl_b32 s46, s45, 8
    s_add_u32 s46, s46, s41
    s_cmp_lt_u32 s45, 992
    s_cselect_b32 s32, s46, s50
    s_add_u32 s45, s44, 48
    s_lshl_b32 s46, s45, 8
    s_add_u32 s46, s46, s41
    s_cmp_lt_u32 s45, 992
    s_cselect_b32 s33, s46, s50
.p2align 3
    s_waitcnt vmcnt(31)
    ds_read_b128 v[216:219], v248 offset:0
    ds_read_b128 v[228:231], v248 offset:1024
    s_waitcnt vmcnt(29)
    s_waitcnt vmcnt(25)
    ds_read_b128 a[0:3], v251 offset:0
    ds_read_b128 a[4:7], v251 offset:1024
    ds_read_b128 a[8:11], v251 offset:2048
    ds_read_b128 a[12:15], v251 offset:3072
    s_waitcnt lgkmcnt(0)
    s_waitcnt lgkmcnt(15)
    v_lshlrev_b32 v220, 16, v216
    v_and_b32 v221, 0xffff0000, v216
    v_mul_f32 v220, s47, v220
    v_mul_f32 v221, s47, v221
    v_cvt_pk_bf16_f32 v216, v220, v221
    v_lshlrev_b32_e64 v222, 16, v217
    v_and_b32 v223, 0xffff0000, v217
    v_mul_f32 v222, s47, v222
    v_mul_f32 v223, s47, v223
    v_cvt_pk_bf16_f32 v217, v222, v223
    v_lshlrev_b32_e64 v224, 16, v218
    v_and_b32 v225, 0xffff0000, v218
    v_mul_f32 v224, s47, v224
    v_mul_f32 v225, s47, v225
    v_cvt_pk_bf16_f32 v218, v224, v225
    v_lshlrev_b32_e64 v226, 16, v219
    v_and_b32 v227, 0xffff0000, v219
    v_mul_f32 v226, s47, v226
    v_mul_f32 v227, s47, v227
    v_cvt_pk_bf16_f32 v219, v226, v227
    ds_write_b128 v248, v[216:219] offset:0
    s_waitcnt lgkmcnt(15)
    v_lshlrev_b32 v232, 16, v228
    v_and_b32 v233, 0xffff0000, v228
    v_mul_f32 v232, s47, v232
    v_mul_f32 v233, s47, v233
    v_cvt_pk_bf16_f32 v228, v232, v233
    v_lshlrev_b32_e64 v234, 16, v229
    v_and_b32 v235, 0xffff0000, v229
    v_mul_f32 v234, s47, v234
    v_mul_f32 v235, s47, v235
    v_cvt_pk_bf16_f32 v229, v234, v235
    v_lshlrev_b32_e64 v236, 16, v230
    v_and_b32 v237, 0xffff0000, v230
    v_mul_f32 v236, s47, v236
    v_mul_f32 v237, s47, v237
    v_cvt_pk_bf16_f32 v230, v236, v237
    v_lshlrev_b32_e64 v238, 16, v231
    v_and_b32 v239, 0xffff0000, v231
    v_mul_f32 v238, s47, v238
    v_mul_f32 v239, s47, v239
    v_cvt_pk_bf16_f32 v231, v238, v239
    ds_write_b128 v248, v[228:231] offset:1024
    ds_read_b128 v[216:219], v248 offset:8192
    ds_read_b128 v[228:231], v248 offset:9216
    s_waitcnt lgkmcnt(1)
    v_lshlrev_b32 v220, 16, v216
    v_and_b32 v221, 0xffff0000, v216
    v_mul_f32 v220, s47, v220
    v_mul_f32 v221, s47, v221
    v_cvt_pk_bf16_f32 v216, v220, v221
    v_lshlrev_b32_e64 v222, 16, v217
    v_and_b32 v223, 0xffff0000, v217
    v_mul_f32 v222, s47, v222
    v_mul_f32 v223, s47, v223
    v_cvt_pk_bf16_f32 v217, v222, v223
    v_lshlrev_b32_e64 v224, 16, v218
    v_and_b32 v225, 0xffff0000, v218
    v_mul_f32 v224, s47, v224
    v_mul_f32 v225, s47, v225
    v_cvt_pk_bf16_f32 v218, v224, v225
    v_lshlrev_b32_e64 v226, 16, v219
    v_and_b32 v227, 0xffff0000, v219
    v_mul_f32 v226, s47, v226
    v_mul_f32 v227, s47, v227
    v_cvt_pk_bf16_f32 v219, v226, v227
    ds_write_b128 v248, v[216:219] offset:8192
    s_waitcnt lgkmcnt(1)
    v_lshlrev_b32 v232, 16, v228
    v_and_b32 v233, 0xffff0000, v228
    v_mul_f32 v232, s47, v232
    v_mul_f32 v233, s47, v233
    v_cvt_pk_bf16_f32 v228, v232, v233
    v_lshlrev_b32_e64 v234, 16, v229
    v_and_b32 v235, 0xffff0000, v229
    v_mul_f32 v234, s47, v234
    v_mul_f32 v235, s47, v235
    v_cvt_pk_bf16_f32 v229, v234, v235
    v_lshlrev_b32_e64 v236, 16, v230
    v_and_b32 v237, 0xffff0000, v230
    v_mul_f32 v236, s47, v236
    v_mul_f32 v237, s47, v237
    v_cvt_pk_bf16_f32 v230, v236, v237
    v_lshlrev_b32_e64 v238, 16, v231
    v_and_b32 v239, 0xffff0000, v231
    v_mul_f32 v238, s47, v238
    v_mul_f32 v239, s47, v239
    v_cvt_pk_bf16_f32 v231, v238, v239
    ds_write_b128 v248, v[228:231] offset:9216
    s_waitcnt lgkmcnt(0)
    s_barrier
    ds_read_b128 a[128:131], v240 offset:0
    ds_read_b128 a[132:135], v240 offset:1024
    ds_read_b128 a[136:139], v240 offset:2048
    ds_read_b128 a[140:143], v240 offset:3072
    s_waitcnt lgkmcnt(0)
    v_mfma_f32_16x16x32_bf16 v[128:131], a[128:131], a[0:3], 0
    ds_read_b128 a[144:147], v240 offset:4096
    s_waitcnt vmcnt(9)
    v_mfma_f32_16x16x32_bf16 v[128:131], a[132:135], a[4:7], v[128:131]
    ds_read_b128 a[148:151], v240 offset:5120
    s_waitcnt vmcnt(63)
    ds_read_b128 a[16:19], v251 offset:4096
    ds_read_b128 a[20:23], v251 offset:5120
    ds_read_b128 a[24:27], v251 offset:6144
    ds_read_b128 a[28:31], v251 offset:7168
    v_mfma_f32_16x16x32_bf16 v[128:131], a[136:139], a[8:11], v[128:131]
    ds_read_b128 a[152:155], v240 offset:6144
    s_add_u32 s77, s75, 32768
    v_mfma_f32_16x16x32_bf16 v[128:131], a[140:143], a[12:15], v[128:131]
    buffer_load_dword v250, v253, s[20:23], s77 offen
    s_waitcnt lgkmcnt(1)
    v_mfma_f32_16x16x32_bf16 v[132:135], a[128:131], a[16:19], 0
    ds_read_b128 a[156:159], v240 offset:7168
    s_add_u32 m0, s73, 49152
    v_mfma_f32_16x16x32_bf16 v[132:135], a[132:135], a[20:23], v[132:135]
    ds_read_b128 a[160:163], v240 offset:8192
    s_waitcnt vmcnt(63)
    v_max3_f32 v216, v128, v129, v130
    v_max_f32 v216, v216, v131
    v_mov_b32_e64 v217, v216
    ds_read_b128 a[32:35], v251 offset:8192
    ds_read_b128 a[36:39], v251 offset:9216
    v_permlane16_swap_b32 v216, v217
    v_max_f32 v216, v216, v217
    v_mov_b32_e64 v217, v216
    ds_read_b128 a[40:43], v251 offset:10240
    ds_read_b128 a[44:47], v251 offset:11264
    v_permlane32_swap_b32 v216, v217
    v_max_f32 v216, v216, v217
    v_sub_f32 v192, 0, v216
    v_sub_f32 v193, 0, v216
    v_sub_f32 v194, 0, v216
    v_sub_f32 v195, 0, v216
    v_sub_f32 v128, v128, v216
    v_sub_f32 v129, v129, v216
    v_sub_f32 v130, v130, v216
    v_sub_f32 v131, v131, v216
    s_add_u32 s74, s71, 49152
    v_mfma_f32_16x16x32_bf16 v[132:135], a[136:139], a[24:27], v[132:135]
    s_add_u32 s39, s38, 16384
    v_exp_f32_e64 v128, v128
    buffer_load_dwordx4 v252, s[16:19], s74 offen lds
    v_mfma_f32_16x16x32_bf16 v[132:135], a[140:143], a[28:31], v[132:135]
    ds_read_b128 v[228:231], v248 offset:17408
    s_waitcnt lgkmcnt(1)
    s_add_u32 m0, s73, 50176
    v_mfma_f32_16x16x32_bf16 v[136:139], a[128:131], a[32:35], 0
    s_add_u32 s74, s71, 49216
    v_exp_f32 v129, v129
    v_mfma_f32_16x16x32_bf16 v[136:139], a[132:135], a[36:39], v[136:139]
    buffer_load_dwordx4 v252, s[16:19], s74 offen lds
    v_max3_f32 v218, v132, v133, v134
    v_max_f32 v218, v218, v135
    v_mov_b32 v219, v218
    s_waitcnt vmcnt(63)
    ds_read_b128 a[48:51], v251 offset:12288
    v_permlane16_swap_b32 v218, v219
    v_max_f32 v218, v218, v219
    v_mov_b32 v219, v218
    ds_read_b128 a[52:55], v251 offset:13312
    ds_read_b128 a[56:59], v251 offset:14336
    v_permlane32_swap_b32 v218, v219
    v_max_f32 v218, v218, v219
    v_sub_f32 v196, 0, v218
    v_sub_f32 v197, 0, v218
    v_sub_f32 v198, 0, v218
    v_sub_f32 v199, 0, v218
    v_sub_f32 v132, v132, v218
    v_sub_f32 v133, v133, v218
    v_sub_f32 v134, v134, v218
    v_sub_f32 v135, v135, v218
    ds_read_b128 v[216:219], v248 offset:16384
    ds_read_b128 a[60:63], v251 offset:15360
    v_mfma_f32_16x16x32_bf16 v[136:139], a[136:139], a[40:43], v[136:139]
    s_add_u32 m0, s73, 57344
    v_exp_f32_e64 v130, v130
    v_mfma_f32_16x16x32_bf16 v[136:139], a[140:143], a[44:47], v[136:139]
    ds_read_b128 a[164:167], v240 offset:9216
    v_cvt_pk_bf16_f32 v160, v128, v129
    s_waitcnt lgkmcnt(1)
    s_add_u32 s74, s71, 57344
    v_mfma_f32_16x16x32_bf16 v[140:143], a[128:131], a[48:51], 0
    s_add_u32 s51, s38, 24576
    v_exp_f32 v131, v131
    buffer_load_dwordx4 v252, s[16:19], s74 offen lds
    v_max3_f32 v220, v136, v137, v138
    v_max_f32 v220, v220, v139
    v_mov_b32 v221, v220
    v_mfma_f32_16x16x32_bf16 v[140:143], a[132:135], a[52:55], v[140:143]
    ds_read_b128 a[168:171], v240 offset:10240
    v_permlane16_swap_b32 v220, v221
    v_max_f32 v220, v220, v221
    v_mov_b32_e64 v221, v220
    s_add_u32 m0, s73, 58368
    v_mfma_f32_16x16x32_bf16 v[140:143], a[136:139], a[56:59], v[140:143]
    s_waitcnt lgkmcnt(15)
    v_exp_f32 v132, v132
    v_permlane32_swap_b32 v220, v221
    v_max_f32 v220, v220, v221
    v_sub_f32 v200, 0, v220
    v_sub_f32 v201, 0, v220
    v_sub_f32 v202, 0, v220
    v_sub_f32 v203, 0, v220
    v_sub_f32 v136, v136, v220
    v_sub_f32 v137, v137, v220
    v_sub_f32 v138, v138, v220
    v_sub_f32 v139, v139, v220
    v_lshlrev_b32_e64 v232, 16, v228
    v_and_b32 v233, 0xffff0000, v228
    v_mul_f32 v232, s47, v232
    v_mul_f32 v233, s47, v233
    v_cvt_pk_bf16_f32 v228, v232, v233
    v_lshlrev_b32_e64 v234, 16, v229
    v_and_b32 v235, 0xffff0000, v229
    v_mul_f32 v234, s47, v234
    v_mul_f32 v235, s47, v235
    v_cvt_pk_bf16_f32 v229, v234, v235
    v_lshlrev_b32_e64 v236, 16, v230
    v_and_b32 v237, 0xffff0000, v230
    s_add_u32 s74, s71, 57408
    v_mul_f32 v236, s47, v236
    v_mul_f32 v237, s47, v237
    v_cvt_pk_bf16_f32 v230, v236, v237
    v_mfma_f32_16x16x32_bf16 v[140:143], a[140:143], a[60:63], v[140:143]
    buffer_load_dwordx4 v252, s[16:19], s74 offen lds
    v_lshlrev_b32 v238, 16, v231
    s_waitcnt lgkmcnt(15)
    v_and_b32 v239, 0xffff0000, v231
    v_mul_f32 v238, s47, v238
    v_mfma_f32_16x16x32_bf16 v[144:147], a[144:147], a[0:3], v[192:195]
    s_waitcnt lgkmcnt(15)
    v_exp_f32_e64 v133, v133
    v_max3_f32 v222, v140, v141, v142
    v_max_f32 v222, v222, v143
    v_mov_b32 v223, v222
    v_lshlrev_b32_e64 v220, 16, v216
    v_and_b32 v221, 0xffff0000, v216
    v_permlane16_swap_b32 v222, v223
    v_max_f32 v222, v222, v223
    v_mov_b32 v223, v222
    v_mul_f32 v220, s47, v220
    v_mul_f32 v221, s47, v221
    v_cvt_pk_bf16_f32 v216, v220, v221
    v_permlane32_swap_b32 v222, v223
    v_max_f32 v222, v222, v223
    v_sub_f32 v204, 0, v222
    v_sub_f32 v205, 0, v222
    v_sub_f32 v206, 0, v222
    v_sub_f32 v207, 0, v222
    v_sub_f32 v140, v140, v222
    v_sub_f32 v141, v141, v222
    v_sub_f32 v142, v142, v222
    v_sub_f32 v143, v143, v222
    v_lshlrev_b32 v222, 16, v217
    v_and_b32 v223, 0xffff0000, v217
    v_mul_f32 v222, s47, v222
    v_mul_f32 v223, s47, v223
    v_cvt_pk_bf16_f32 v217, v222, v223
    v_lshlrev_b32_e64 v224, 16, v218
    v_and_b32 v225, 0xffff0000, v218
    v_mul_f32 v224, s47, v224
    v_mul_f32 v225, s47, v225
    v_cvt_pk_bf16_f32 v218, v224, v225
    v_lshlrev_b32_e64 v226, 16, v219
    v_and_b32 v227, 0xffff0000, v219
    v_mul_f32 v226, s47, v226
    v_mul_f32 v227, s47, v227
    v_cvt_pk_bf16_f32 v219, v226, v227
    ds_write_b128 v248, v[216:219] offset:16384
    ds_read_b128 v[216:219], v248 offset:24576
    s_add_u32 s77, s75, 49152
    v_mul_f32 v239, s47, v239
    v_cvt_pk_bf16_f32 v231, v238, v239
    ds_write_b128 v248, v[228:231] offset:17408
    v_mfma_f32_16x16x32_bf16 v[144:147], a[148:151], a[4:7], v[144:147]
    buffer_load_dword v250, v253, s[20:23], s77 offen
    v_cvt_pk_bf16_f32 v161, v130, v131
    v_mfma_f32_16x16x32_bf16 v[144:147], a[152:155], a[8:11], v[144:147]
    s_add_u32 m0, s40, 16384
    v_exp_f32 v134, v134
    v_mfma_f32_16x16x32_bf16 v[144:147], a[156:159], a[12:15], v[144:147]
    ds_read_b128 a[172:175], v240 offset:11264
    v_cvt_pk_bf16_f32 v164, v132, v133
    v_mfma_f32_16x16x32_bf16 v[148:151], a[144:147], a[16:19], v[196:199]
    s_add_u32 s74, s71, 65536
    v_exp_f32_e64 v135, v135
    v_mfma_f32_16x16x32_bf16 v[148:151], a[148:151], a[20:23], v[148:151]
    ds_read_b128 a[176:179], v240 offset:12288
    v_cvt_pk_bf16_f32 v165, v134, v135
    v_mfma_f32_16x16x32_bf16 v[148:151], a[152:155], a[24:27], v[148:151]
    s_mov_b32 s66, s34
    v_exp_f32 v144, v144
    ds_read_b128 v[228:231], v248 offset:25600
    v_mfma_f32_16x16x32_bf16 v[148:151], a[156:159], a[28:31], v[148:151]
    ds_read_b128 a[180:183], v240 offset:13312
    s_waitcnt lgkmcnt(5)
    v_lshlrev_b32 v220, 16, v216
    v_and_b32 v221, 0xffff0000, v216
    v_mul_f32 v220, s47, v220
    v_mul_f32 v221, s47, v221
    v_cvt_pk_bf16_f32 v216, v220, v221
    v_lshlrev_b32_e64 v222, 16, v217
    v_and_b32 v223, 0xffff0000, v217
    v_mul_f32 v222, s47, v222
    v_mul_f32 v223, s47, v223
    v_cvt_pk_bf16_f32 v217, v222, v223
    v_lshlrev_b32_e64 v224, 16, v218
    v_and_b32 v225, 0xffff0000, v218
    v_mul_f32 v224, s47, v224
    v_mul_f32 v225, s47, v225
    v_cvt_pk_bf16_f32 v218, v224, v225
    v_lshlrev_b32_e64 v226, 16, v219
    v_and_b32 v227, 0xffff0000, v219
    v_mul_f32 v226, s47, v226
    v_mul_f32 v227, s47, v227
    v_cvt_pk_bf16_f32 v219, v226, v227
    v_mfma_f32_16x16x32_bf16 v[152:155], a[144:147], a[32:35], v[200:203]
    s_mov_b32 s34, s30
    v_exp_f32 v145, v145
    ds_write_b128 v248, v[216:219] offset:24576
    v_mfma_f32_16x16x32_bf16 v[152:155], a[148:151], a[36:39], v[152:155]
    ds_read_b128 a[184:187], v240 offset:14336
    v_cvt_pk_bf16_f32 v162, v144, v145
    v_mfma_f32_16x16x32_bf16 v[152:155], a[152:155], a[40:43], v[152:155]
    s_mov_b32 s67, s35
    v_exp_f32 v146, v146
    v_mfma_f32_16x16x32_bf16 v[152:155], a[156:159], a[44:47], v[152:155]
    ds_read_b128 a[188:191], v240 offset:15360
    v_mfma_f32_16x16x32_bf16 v[156:159], a[144:147], a[48:51], v[204:207]
    s_mov_b32 s35, s31
    v_exp_f32 v147, v147
    v_mfma_f32_16x16x32_bf16 v[156:159], a[148:151], a[52:55], v[156:159]
    s_waitcnt lgkmcnt(4)
    v_lshlrev_b32 v232, 16, v228
    v_and_b32 v233, 0xffff0000, v228
    v_mul_f32 v232, s47, v232
    v_mul_f32 v233, s47, v233
    v_cvt_pk_bf16_f32 v228, v232, v233
    v_lshlrev_b32_e64 v234, 16, v229
    v_and_b32 v235, 0xffff0000, v229
    v_mul_f32 v234, s47, v234
    v_mul_f32 v235, s47, v235
    v_cvt_pk_bf16_f32 v229, v234, v235
    v_lshlrev_b32_e64 v236, 16, v230
    v_and_b32 v237, 0xffff0000, v230
    v_mul_f32 v236, s47, v236
    v_mul_f32 v237, s47, v237
    v_cvt_pk_bf16_f32 v230, v236, v237
    v_mfma_f32_16x16x32_bf16 v[156:159], a[152:155], a[56:59], v[156:159]
    s_waitcnt lgkmcnt(15)
    v_exp_f32 v148, v148
    v_lshlrev_b32_e64 v238, 16, v231
    v_and_b32 v239, 0xffff0000, v231
    v_mul_f32 v238, s47, v238
    v_mfma_f32_16x16x32_bf16 v[156:159], a[156:159], a[60:63], v[156:159]
    s_mov_b32 s68, s36
    v_mul_f32 v239, s47, v239
    v_cvt_pk_bf16_f32 v231, v238, v239
    ds_write_b128 v248, v[228:231] offset:25600
    v_mfma_f32_16x16x32_bf16 v[128:131], a[160:163], a[0:3], v[192:195]
    s_mov_b32 s36, s32
    v_exp_f32_e64 v149, v149
    v_mfma_f32_16x16x32_bf16 v[128:131], a[164:167], a[4:7], v[128:131]
    s_mov_b32 s69, s37
    v_cvt_pk_bf16_f32 v163, v146, v147
    v_cvt_pk_bf16_f32 v166, v148, v149
    v_mfma_f32_16x16x32_bf16 v[128:131], a[168:171], a[8:11], v[128:131]
    s_waitcnt lgkmcnt(1)
    v_exp_f32_e64 v150, v150
    v_mfma_f32_16x16x32_bf16 v[128:131], a[172:175], a[12:15], v[128:131]
    s_mov_b32 s37, s33
    v_mfma_f32_16x16x32_bf16 v[144:147], a[176:179], a[0:3], v[192:195]
    s_add_u32 s44, s44, 256
    v_exp_f32 v151, v151
    v_mfma_f32_16x16x32_bf16 v[144:147], a[180:183], a[4:7], v[144:147]
    v_cvt_pk_bf16_f32 v167, v150, v151
    v_mfma_f32_16x16x32_bf16 v[144:147], a[184:187], a[8:11], v[144:147]
    v_exp_f32_e64 v136, v136
    v_mfma_f32_16x16x32_bf16 v[144:147], a[188:191], a[12:15], v[144:147]
    v_mfma_f32_16x16x32_bf16 v[132:135], a[160:163], a[16:19], v[196:199]
    s_waitcnt vmcnt(11)
    v_exp_f32 v137, v137
    v_mfma_f32_16x16x32_bf16 v[132:135], a[164:167], a[20:23], v[132:135]
    s_waitcnt lgkmcnt(0)
    v_cvt_pk_bf16_f32 v168, v136, v137
    v_mfma_f32_16x16x32_bf16 v[132:135], a[168:171], a[24:27], v[132:135]
    v_exp_f32 v138, v138
    v_mfma_f32_16x16x32_bf16 v[132:135], a[172:175], a[28:31], v[132:135]
    s_barrier
    v_mfma_f32_16x16x32_bf16 v[148:151], a[176:179], a[16:19], v[196:199]
    s_add_u32 s77, s75, 65536
    v_exp_f32 v139, v139
    v_mfma_f32_16x16x32_bf16 v[148:151], a[180:183], a[20:23], v[148:151]
    buffer_load_dwordx4 v247, s[20:23], s39 offen offset:0 lds
    v_cvt_pk_bf16_f32 v169, v138, v139
    s_waitcnt vmcnt(7)
    v_mfma_f32_16x16x32_bf16 v[148:151], a[184:187], a[24:27], v[148:151]
    v_exp_f32 v152, v152
    v_mfma_f32_16x16x32_bf16 v[148:151], a[188:191], a[28:31], v[148:151]
    buffer_load_dwordx4 v247, s[20:23], s39 offen offset:1024 lds
    v_mfma_f32_16x16x32_bf16 v[136:139], a[160:163], a[32:35], v[200:203]
    s_add_u32 m0, s40, 24576
    v_exp_f32_e64 v153, v153
    v_mfma_f32_16x16x32_bf16 v[136:139], a[164:167], a[36:39], v[136:139]
    buffer_load_dwordx4 v247, s[20:23], s51 offen offset:0 lds
    v_cvt_pk_bf16_f32 v170, v152, v153
    v_mfma_f32_16x16x32_bf16 v[136:139], a[168:171], a[40:43], v[136:139]
    s_add_u32 s39, s38, 32768
    v_exp_f32_e64 v154, v154
    v_mfma_f32_16x16x32_bf16 v[136:139], a[172:175], a[44:47], v[136:139]
    v_exp_f32 v155, v155
    s_nop 0
    v_cvt_pk_bf16_f32 v171, v154, v155
    v_mfma_f32_16x16x32_bf16 v[152:155], a[176:179], a[32:35], v[200:203]
    buffer_load_dwordx4 v247, s[20:23], s51 offen offset:1024 lds
    v_mfma_f32_16x16x32_bf16 v[152:155], a[180:183], a[36:39], v[152:155]
    s_add_u32 m0, s73, 65536
    v_exp_f32_e64 v140, v140
    v_mfma_f32_16x16x32_bf16 v[152:155], a[184:187], a[40:43], v[152:155]
    ds_read_b64_tr_b16 a[192:193], v242 offset:0
    v_mfma_f32_16x16x32_bf16 v[152:155], a[188:191], a[44:47], v[152:155]
    s_add_u32 s51, s38, 40960
    v_exp_f32 v141, v141
    v_exp_f32 v142, v142
    v_cvt_pk_bf16_f32 v172, v140, v141
    v_exp_f32 v143, v143
    s_nop 0
    v_cvt_pk_bf16_f32 v173, v142, v143
    v_mfma_f32_16x16x32_bf16 v[140:143], a[160:163], a[48:51], v[204:207]
    ds_read_b64_tr_b16 a[194:195], v242 offset:4096
    v_mfma_f32_16x16x32_bf16 v[140:143], a[164:167], a[52:55], v[140:143]
    v_exp_f32_e64 v156, v156
    v_mfma_f32_16x16x32_bf16 v[140:143], a[168:171], a[56:59], v[140:143]
    ds_read_b64_tr_b16 a[196:197], v242 offset:8
    v_mfma_f32_16x16x32_bf16 v[140:143], a[172:175], a[60:63], v[140:143]
    v_exp_f32 v157, v157
    v_exp_f32 v158, v158
    v_cvt_pk_bf16_f32 v174, v156, v157
    v_exp_f32 v159, v159
    s_nop 0
    v_cvt_pk_bf16_f32 v175, v158, v159
    v_mfma_f32_16x16x32_bf16 v[156:159], a[176:179], a[48:51], v[204:207]
    ds_read_b64_tr_b16 a[198:199], v242 offset:4104
    v_mfma_f32_16x16x32_bf16 v[156:159], a[180:183], a[52:55], v[156:159]
    v_exp_f32_e64 v128, v128
    v_mfma_f32_16x16x32_bf16 v[156:159], a[184:187], a[56:59], v[156:159]
    buffer_load_dwordx4 v252, s[16:19], s74 offen lds
    v_mfma_f32_16x16x32_bf16 v[156:159], a[188:191], a[60:63], v[156:159]
    s_add_u32 m0, s73, 66560
    v_exp_f32_e64 v129, v129
    v_mfma_f32_16x16x32_bf16 a[224:227], a[240:243], v[160:163], 0
    ds_read_b64_tr_b16 a[200:201], v243 offset:0
    v_cvt_pk_bf16_f32 v176, v128, v129
    v_mfma_f32_16x16x32_bf16 a[228:231], a[240:243], v[164:167], 0
    s_waitcnt lgkmcnt(3)
    v_exp_f32 v130, v130
    v_mfma_f32_16x16x32_bf16 a[232:235], a[240:243], v[168:171], 0
    ds_read_b64_tr_b16 a[202:203], v243 offset:4096
    v_mfma_f32_16x16x32_bf16 a[236:239], a[240:243], v[172:175], 0
    s_add_u32 s74, s71, 65600
    v_exp_f32_e64 v131, v131
    v_mfma_f32_16x16x32_bf16 v[0:3], a[192:195], v[160:163], 0
    buffer_load_dwordx4 v252, s[16:19], s74 offen lds
    v_cvt_pk_bf16_f32 v177, v130, v131
    v_mfma_f32_16x16x32_bf16 v[4:7], a[192:195], v[164:167], 0
    s_waitcnt lgkmcnt(2)
    v_exp_f32 v144, v144
    v_mfma_f32_16x16x32_bf16 v[8:11], a[192:195], v[168:171], 0
    ds_read_b64_tr_b16 a[204:205], v243 offset:8
    v_mfma_f32_16x16x32_bf16 v[12:15], a[192:195], v[172:175], 0
    s_add_u32 m0, s73, 73728
    v_exp_f32_e64 v145, v145
    v_mfma_f32_16x16x32_bf16 v[16:19], a[196:199], v[160:163], 0
    ds_read_b64_tr_b16 a[206:207], v243 offset:4104
    v_cvt_pk_bf16_f32 v178, v144, v145
    v_mfma_f32_16x16x32_bf16 v[20:23], a[196:199], v[164:167], 0
    s_add_u32 s74, s71, 73728
    v_exp_f32_e64 v146, v146
    v_mfma_f32_16x16x32_bf16 v[24:27], a[196:199], v[168:171], 0
    ds_read_b64_tr_b16 a[208:209], v244 offset:0
    v_mfma_f32_16x16x32_bf16 v[28:31], a[196:199], v[172:175], 0
    s_waitcnt lgkmcnt(3)
    v_exp_f32 v147, v147
    v_mfma_f32_16x16x32_bf16 v[32:35], a[200:203], v[160:163], 0
    ds_read_b64_tr_b16 a[210:211], v244 offset:4096
    v_cvt_pk_bf16_f32 v179, v146, v147
    v_mfma_f32_16x16x32_bf16 v[36:39], a[200:203], v[164:167], 0
    v_exp_f32_e64 v132, v132
    buffer_load_dwordx4 v252, s[16:19], s74 offen lds
    v_mfma_f32_16x16x32_bf16 v[40:43], a[200:203], v[168:171], 0
    ds_read_b64_tr_b16 a[212:213], v244 offset:8
    v_mfma_f32_16x16x32_bf16 v[44:47], a[200:203], v[172:175], 0
    s_add_u32 m0, s73, 74752
    v_exp_f32 v133, v133
    s_waitcnt lgkmcnt(3)
    v_mfma_f32_16x16x32_bf16 v[48:51], a[204:207], v[160:163], 0
    ds_read_b64_tr_b16 a[214:215], v244 offset:4104
    v_cvt_pk_bf16_f32 v180, v132, v133
    ds_read_b128 v[216:219], v248 offset:32768
    v_mfma_f32_16x16x32_bf16 v[52:55], a[204:207], v[164:167], 0
    s_add_u32 s74, s71, 73792
    v_exp_f32_e64 v134, v134
    v_mfma_f32_16x16x32_bf16 v[56:59], a[204:207], v[168:171], 0
    buffer_load_dwordx4 v252, s[16:19], s74 offen lds
    v_mfma_f32_16x16x32_bf16 v[60:63], a[204:207], v[172:175], 0
    s_waitcnt lgkmcnt(3)
    v_exp_f32 v135, v135
    v_mfma_f32_16x16x32_bf16 v[64:67], a[208:211], v[160:163], 0
    ds_read_b64_tr_b16 a[216:217], v245 offset:0
    v_cvt_pk_bf16_f32 v181, v134, v135
    ds_read_b64_tr_b16 a[218:219], v245 offset:4096
    v_mfma_f32_16x16x32_bf16 v[68:71], a[208:211], v[164:167], 0
    s_add_u32 m0, s40, 0
    v_exp_f32 v148, v148
    v_mfma_f32_16x16x32_bf16 v[72:75], a[208:211], v[168:171], 0
    buffer_load_dword v250, v253, s[20:23], s77 offen
    v_mfma_f32_16x16x32_bf16 v[76:79], a[208:211], v[172:175], 0
    s_waitcnt lgkmcnt(3)
    v_exp_f32 v149, v149
    s_waitcnt lgkmcnt(2)
    v_mfma_f32_16x16x32_bf16 v[80:83], a[212:215], v[160:163], 0
    ds_read_b64_tr_b16 a[220:221], v245 offset:8
    v_lshlrev_b32 v220, 16, v216
    v_and_b32 v221, 0xffff0000, v216
    ds_read_b64_tr_b16 a[222:223], v245 offset:4104
    v_mfma_f32_16x16x32_bf16 v[84:87], a[212:215], v[164:167], 0
    s_add_u32 s74, s71, 81920
    v_exp_f32_e64 v150, v150
    v_mfma_f32_16x16x32_bf16 v[88:91], a[212:215], v[168:171], 0
    ds_read_b128 a[128:131], v240 offset:16384
    v_mul_f32 v220, s47, v220
    v_mul_f32 v221, s47, v221
    v_mfma_f32_16x16x32_bf16 v[92:95], a[212:215], v[172:175], 0
    s_waitcnt lgkmcnt(3)
    v_exp_f32 v151, v151
    v_mfma_f32_16x16x32_bf16 v[96:99], a[216:219], v[160:163], 0
    ds_read_b128 a[132:135], v240 offset:17408
    v_cvt_pk_bf16_f32 v216, v220, v221
    v_lshlrev_b32_e64 v222, 16, v217
    ds_read_b128 a[136:139], v240 offset:18432
    ds_read_b128 a[140:143], v240 offset:19456
    v_mfma_f32_16x16x32_bf16 v[100:103], a[216:219], v[164:167], 0
    v_exp_f32_e64 v136, v136
    v_mfma_f32_16x16x32_bf16 v[104:107], a[216:219], v[168:171], 0
    ds_read_b128 a[144:147], v240 offset:20480
    v_and_b32 v223, 0xffff0000, v217
    v_mul_f32 v222, s47, v222
    v_mfma_f32_16x16x32_bf16 v[108:111], a[216:219], v[172:175], 0
    s_waitcnt lgkmcnt(5)
    v_exp_f32_e64 v137, v137
    v_mfma_f32_16x16x32_bf16 v[112:115], a[220:223], v[160:163], 0
    ds_read_b128 a[148:151], v240 offset:21504
    v_mul_f32 v223, s47, v223
    v_cvt_pk_bf16_f32 v217, v222, v223
    ds_read_b128 a[152:155], v240 offset:22528
    ds_read_b128 a[156:159], v240 offset:23552
    v_mfma_f32_16x16x32_bf16 v[116:119], a[220:223], v[164:167], 0
    v_exp_f32 v138, v138
    v_mfma_f32_16x16x32_bf16 v[120:123], a[220:223], v[168:171], 0
    ds_read_b128 v[228:231], v248 offset:33792
    v_lshlrev_b32_e64 v224, 16, v218
    v_and_b32 v225, 0xffff0000, v218
    v_mfma_f32_16x16x32_bf16 v[124:127], a[220:223], v[172:175], 0
    s_waitcnt lgkmcnt(5)
    v_exp_f32 v139, v139
    v_mfma_f32_16x16x32_bf16 v[128:131], a[128:131], a[0:3], v[192:195]
    ds_read_b64_tr_b16 a[192:193], v242 offset:8192
    v_mul_f32 v224, s47, v224
    v_mul_f32 v225, s47, v225
    v_mfma_f32_16x16x32_bf16 v[128:131], a[132:135], a[4:7], v[128:131]
    v_exp_f32_e64 v152, v152
    v_cvt_pk_bf16_f32 v218, v224, v225
    v_mfma_f32_16x16x32_bf16 v[128:131], a[136:139], a[8:11], v[128:131]
    ds_read_b64_tr_b16 a[194:195], v242 offset:12288
    v_lshlrev_b32_e64 v226, 16, v219
    v_and_b32 v227, 0xffff0000, v219
    v_mfma_f32_16x16x32_bf16 v[128:131], a[140:143], a[12:15], v[128:131]
    s_waitcnt lgkmcnt(3)
    v_exp_f32 v153, v153
    v_mfma_f32_16x16x32_bf16 v[144:147], a[144:147], a[0:3], v[192:195]
    ds_read_b64_tr_b16 a[196:197], v242 offset:8200
    v_mul_f32 v226, s47, v226
    v_mul_f32 v227, s47, v227
    v_mfma_f32_16x16x32_bf16 v[144:147], a[148:151], a[4:7], v[144:147]
    v_exp_f32_e64 v154, v154
    v_mfma_f32_16x16x32_bf16 v[144:147], a[152:155], a[8:11], v[144:147]
    ds_read_b64_tr_b16 a[198:199], v242 offset:12296
    v_cvt_pk_bf16_f32 v219, v226, v227
    v_cvt_pk_bf16_f32 v182, v148, v149
    v_mfma_f32_16x16x32_bf16 v[144:147], a[156:159], a[12:15], v[144:147]
    s_waitcnt lgkmcnt(4)
    v_exp_f32 v155, v155
    ds_write_b128 v248, v[216:219] offset:32768
    v_mfma_f32_16x16x32_bf16 v[132:135], a[128:131], a[16:19], v[196:199]
    ds_read_b128 v[216:219], v248 offset:40960
    v_lshlrev_b32_e64 v232, 16, v228
    v_cvt_pk_bf16_f32 v183, v150, v151
    v_mfma_f32_16x16x32_bf16 v[132:135], a[132:135], a[20:23], v[132:135]
    v_exp_f32_e64 v140, v140
    v_mfma_f32_16x16x32_bf16 v[132:135], a[136:139], a[24:27], v[132:135]
    ds_read_b64_tr_b16 a[200:201], v243 offset:8192
    v_and_b32 v233, 0xffff0000, v228
    v_mul_f32 v232, s47, v232
    v_mfma_f32_16x16x32_bf16 v[132:135], a[140:143], a[28:31], v[132:135]
    v_exp_f32 v141, v141
    v_mfma_f32_16x16x32_bf16 v[148:151], a[144:147], a[16:19], v[196:199]
    ds_read_b64_tr_b16 a[202:203], v243 offset:12288
    v_mul_f32 v233, s47, v233
    v_cvt_pk_bf16_f32 v228, v232, v233
    v_mfma_f32_16x16x32_bf16 v[148:151], a[148:151], a[20:23], v[148:151]
    v_exp_f32 v142, v142
    v_mfma_f32_16x16x32_bf16 v[148:151], a[152:155], a[24:27], v[148:151]
    ds_read_b64_tr_b16 a[204:205], v243 offset:8200
    v_cvt_pk_bf16_f32 v184, v136, v137
    v_cvt_pk_bf16_f32 v185, v138, v139
    v_mfma_f32_16x16x32_bf16 v[148:151], a[156:159], a[28:31], v[148:151]
    v_exp_f32 v143, v143
    v_lshlrev_b32 v234, 16, v229
    v_and_b32 v235, 0xffff0000, v229
    v_mfma_f32_16x16x32_bf16 v[136:139], a[128:131], a[32:35], v[200:203]
    ds_read_b64_tr_b16 a[206:207], v243 offset:12296
    v_mul_f32 v234, s47, v234
    v_mul_f32 v235, s47, v235
    v_mfma_f32_16x16x32_bf16 v[136:139], a[132:135], a[36:39], v[136:139]
    v_exp_f32_e64 v156, v156
    v_mfma_f32_16x16x32_bf16 v[136:139], a[136:139], a[40:43], v[136:139]
    ds_read_b64_tr_b16 a[208:209], v244 offset:8192
    v_cvt_pk_bf16_f32 v229, v234, v235
    v_cvt_pk_bf16_f32 v186, v152, v153
    v_mfma_f32_16x16x32_bf16 v[136:139], a[140:143], a[44:47], v[136:139]
    v_exp_f32_e64 v157, v157
    v_cvt_pk_bf16_f32 v187, v154, v155
    v_lshlrev_b32_e64 v236, 16, v230
    v_mfma_f32_16x16x32_bf16 v[152:155], a[144:147], a[32:35], v[200:203]
    ds_read_b64_tr_b16 a[210:211], v244 offset:12288
    v_and_b32 v237, 0xffff0000, v230
    v_mul_f32 v236, s47, v236
    v_mfma_f32_16x16x32_bf16 v[152:155], a[148:151], a[36:39], v[152:155]
    v_exp_f32 v158, v158
    v_mfma_f32_16x16x32_bf16 v[152:155], a[152:155], a[40:43], v[152:155]
    ds_read_b64_tr_b16 a[212:213], v244 offset:8200
    v_mul_f32 v237, s47, v237
    v_cvt_pk_bf16_f32 v188, v140, v141
    v_mfma_f32_16x16x32_bf16 v[152:155], a[156:159], a[44:47], v[152:155]
    v_exp_f32 v159, v159
    v_cvt_pk_bf16_f32 v189, v142, v143
    v_cvt_pk_bf16_f32 v230, v236, v237
    v_mfma_f32_16x16x32_bf16 v[140:143], a[128:131], a[48:51], v[204:207]
    ds_read_b64_tr_b16 a[214:215], v244 offset:12296
    v_lshlrev_b32_e64 v238, 16, v231
    v_and_b32 v239, 0xffff0000, v231
    v_mfma_f32_16x16x32_bf16 v[140:143], a[132:135], a[52:55], v[140:143]
    v_exp_f32_e64 v128, v128
    v_mfma_f32_16x16x32_bf16 v[140:143], a[136:139], a[56:59], v[140:143]
    ds_read_b64_tr_b16 a[216:217], v245 offset:8192
    v_mul_f32 v238, s47, v238
    v_mfma_f32_16x16x32_bf16 v[140:143], a[140:143], a[60:63], v[140:143]
    v_exp_f32 v129, v129
    v_cvt_pk_bf16_f32 v190, v156, v157
    v_cvt_pk_bf16_f32 v191, v158, v159
    v_mul_f32 v239, s47, v239
    v_mfma_f32_16x16x32_bf16 v[156:159], a[144:147], a[48:51], v[204:207]
    ds_read_b64_tr_b16 a[218:219], v245 offset:12288
    v_cvt_pk_bf16_f32 v231, v238, v239
    v_mfma_f32_16x16x32_bf16 v[156:159], a[148:151], a[52:55], v[156:159]
    s_waitcnt lgkmcnt(10)
    v_exp_f32_e64 v130, v130
    ds_write_b128 v248, v[228:231] offset:33792
    v_mfma_f32_16x16x32_bf16 v[156:159], a[152:155], a[56:59], v[156:159]
    ds_read_b128 v[228:231], v248 offset:41984
    v_lshlrev_b32_e64 v220, 16, v216
    v_and_b32 v221, 0xffff0000, v216
    v_mfma_f32_16x16x32_bf16 v[156:159], a[156:159], a[60:63], v[156:159]
    v_exp_f32_e64 v131, v131
    v_mfma_f32_16x16x32_bf16 a[224:227], a[240:243], v[176:179], a[224:227]
    ds_read_b64_tr_b16 a[220:221], v245 offset:8200
    v_mul_f32 v220, s47, v220
    v_mul_f32 v221, s47, v221
    v_mfma_f32_16x16x32_bf16 a[228:231], a[240:243], v[180:183], a[228:231]
    s_waitcnt lgkmcnt(15)
    v_exp_f32 v144, v144
    v_mfma_f32_16x16x32_bf16 a[232:235], a[240:243], v[184:187], a[232:235]
    ds_read_b64_tr_b16 a[222:223], v245 offset:12296
    v_cvt_pk_bf16_f32 v216, v220, v221
    v_lshlrev_b32_e64 v222, 16, v217
    v_mfma_f32_16x16x32_bf16 a[236:239], a[240:243], v[188:191], a[236:239]
    v_exp_f32_e64 v145, v145
    v_mfma_f32_16x16x32_bf16 v[0:3], a[192:195], v[176:179], v[0:3]
    ds_read_b128 a[160:163], v240 offset:24576
    v_and_b32 v223, 0xffff0000, v217
    v_mul_f32 v222, s47, v222
    v_mfma_f32_16x16x32_bf16 v[4:7], a[192:195], v[180:183], v[4:7]
    s_waitcnt lgkmcnt(15)
    v_exp_f32_e64 v146, v146
    v_mfma_f32_16x16x32_bf16 v[8:11], a[192:195], v[184:187], v[8:11]
    ds_read_b128 a[164:167], v240 offset:25600
    v_mul_f32 v223, s47, v223
    v_cvt_pk_bf16_f32 v217, v222, v223
    v_mfma_f32_16x16x32_bf16 v[12:15], a[192:195], v[188:191], v[12:15]
    v_exp_f32 v147, v147
    v_mfma_f32_16x16x32_bf16 v[16:19], a[196:199], v[176:179], v[16:19]
    ds_read_b128 a[168:171], v240 offset:26624
    v_lshlrev_b32_e64 v224, 16, v218
    v_and_b32 v225, 0xffff0000, v218
    v_mfma_f32_16x16x32_bf16 v[20:23], a[196:199], v[180:183], v[20:23]
    s_waitcnt lgkmcnt(15)
    v_exp_f32 v132, v132
    v_mfma_f32_16x16x32_bf16 v[24:27], a[196:199], v[184:187], v[24:27]
    ds_read_b128 a[172:175], v240 offset:27648
    v_mul_f32 v224, s47, v224
    v_mfma_f32_16x16x32_bf16 v[28:31], a[196:199], v[188:191], v[28:31]
    v_exp_f32 v133, v133
    v_mfma_f32_16x16x32_bf16 v[32:35], a[200:203], v[176:179], v[32:35]
    ds_read_b128 a[176:179], v240 offset:28672
    v_mul_f32 v225, s47, v225
    v_cvt_pk_bf16_f32 v218, v224, v225
    v_mfma_f32_16x16x32_bf16 v[36:39], a[200:203], v[180:183], v[36:39]
    s_waitcnt lgkmcnt(15)
    v_exp_f32 v134, v134
    v_lshlrev_b32 v226, 16, v219
    v_mfma_f32_16x16x32_bf16 v[40:43], a[200:203], v[184:187], v[40:43]
    ds_read_b128 a[180:183], v240 offset:29696
    v_and_b32 v227, 0xffff0000, v219
    v_mfma_f32_16x16x32_bf16 v[44:47], a[200:203], v[188:191], v[44:47]
    v_exp_f32 v135, v135
    v_mul_f32 v226, s47, v226
    v_mfma_f32_16x16x32_bf16 v[48:51], a[204:207], v[176:179], v[48:51]
    ds_read_b128 a[184:187], v240 offset:30720
    v_mul_f32 v227, s47, v227
    v_mfma_f32_16x16x32_bf16 v[52:55], a[204:207], v[180:183], v[52:55]
    s_waitcnt lgkmcnt(15)
    v_exp_f32_e64 v148, v148
    v_cvt_pk_bf16_f32 v219, v226, v227
    v_mfma_f32_16x16x32_bf16 v[56:59], a[204:207], v[184:187], v[56:59]
    ds_write_b128 v248, v[216:219] offset:40960
    v_cvt_pk_bf16_f32 v160, v128, v129
    v_mfma_f32_16x16x32_bf16 v[60:63], a[204:207], v[188:191], v[60:63]
    s_waitcnt lgkmcnt(10)
    v_exp_f32 v149, v149
    v_mfma_f32_16x16x32_bf16 v[64:67], a[208:211], v[176:179], v[64:67]
    ds_read_b128 a[188:191], v240 offset:31744
    v_lshlrev_b32_e64 v232, 16, v228
    v_and_b32 v233, 0xffff0000, v228
    v_mfma_f32_16x16x32_bf16 v[68:71], a[208:211], v[180:183], v[68:71]
    s_waitcnt lgkmcnt(15)
    v_exp_f32 v150, v150
    v_mfma_f32_16x16x32_bf16 v[72:75], a[208:211], v[184:187], v[72:75]
    v_mul_f32 v232, s47, v232
    v_mul_f32 v233, s47, v233
    v_cvt_pk_bf16_f32 v228, v232, v233
    v_mfma_f32_16x16x32_bf16 v[76:79], a[208:211], v[188:191], v[76:79]
    v_exp_f32_e64 v151, v151
    v_mfma_f32_16x16x32_bf16 v[80:83], a[212:215], v[176:179], v[80:83]
    v_lshlrev_b32_e64 v234, 16, v229
    v_and_b32 v235, 0xffff0000, v229
    v_mul_f32 v234, s47, v234
    v_mfma_f32_16x16x32_bf16 v[84:87], a[212:215], v[180:183], v[84:87]
    s_waitcnt lgkmcnt(15)
    v_exp_f32_e64 v136, v136
    v_mfma_f32_16x16x32_bf16 v[88:91], a[212:215], v[184:187], v[88:91]
    v_mul_f32 v235, s47, v235
    v_cvt_pk_bf16_f32 v229, v234, v235
    v_lshlrev_b32 v236, 16, v230
    v_mfma_f32_16x16x32_bf16 v[92:95], a[212:215], v[188:191], v[92:95]
    v_exp_f32_e64 v137, v137
    v_mfma_f32_16x16x32_bf16 v[96:99], a[216:219], v[176:179], v[96:99]
    v_and_b32 v237, 0xffff0000, v230
    v_mul_f32 v236, s47, v236
    v_mul_f32 v237, s47, v237
    v_mfma_f32_16x16x32_bf16 v[100:103], a[216:219], v[180:183], v[100:103]
    s_waitcnt lgkmcnt(9)
    v_exp_f32 v138, v138
    v_mfma_f32_16x16x32_bf16 v[104:107], a[216:219], v[184:187], v[104:107]
    v_cvt_pk_bf16_f32 v230, v236, v237
    v_cvt_pk_bf16_f32 v161, v130, v131
    v_lshlrev_b32_e64 v238, 16, v231
    v_mfma_f32_16x16x32_bf16 v[108:111], a[216:219], v[188:191], v[108:111]
    v_exp_f32_e64 v139, v139
    v_mfma_f32_16x16x32_bf16 v[112:115], a[220:223], v[176:179], v[112:115]
    v_and_b32 v239, 0xffff0000, v231
    v_mul_f32 v238, s47, v238
    v_mul_f32 v239, s47, v239
    v_mfma_f32_16x16x32_bf16 v[116:119], a[220:223], v[180:183], v[116:119]
    s_waitcnt lgkmcnt(5)
    v_exp_f32 v152, v152
    v_mfma_f32_16x16x32_bf16 v[120:123], a[220:223], v[184:187], v[120:123]
    v_cvt_pk_bf16_f32 v162, v144, v145
    v_cvt_pk_bf16_f32 v163, v146, v147
    v_mfma_f32_16x16x32_bf16 v[124:127], a[220:223], v[188:191], v[124:127]
    v_exp_f32_e64 v153, v153
    v_mfma_f32_16x16x32_bf16 v[128:131], a[160:163], a[0:3], v[192:195]
    v_cvt_pk_bf16_f32 v231, v238, v239
    v_cvt_pk_bf16_f32 v164, v132, v133
    v_mfma_f32_16x16x32_bf16 v[128:131], a[164:167], a[4:7], v[128:131]
    s_waitcnt lgkmcnt(0)
    v_exp_f32 v154, v154
    v_mfma_f32_16x16x32_bf16 v[128:131], a[168:171], a[8:11], v[128:131]
    ds_write_b128 v248, v[228:231] offset:41984
    v_cvt_pk_bf16_f32 v165, v134, v135
    v_mfma_f32_16x16x32_bf16 v[128:131], a[172:175], a[12:15], v[128:131]
    v_exp_f32_e64 v155, v155
    v_mfma_f32_16x16x32_bf16 v[144:147], a[176:179], a[0:3], v[192:195]
    v_cvt_pk_bf16_f32 v166, v148, v149
    v_cvt_pk_bf16_f32 v167, v150, v151
    v_mfma_f32_16x16x32_bf16 v[144:147], a[180:183], a[4:7], v[144:147]
    v_exp_f32_e64 v140, v140
    v_mfma_f32_16x16x32_bf16 v[144:147], a[184:187], a[8:11], v[144:147]
    v_cvt_pk_bf16_f32 v168, v136, v137
    v_cvt_pk_bf16_f32 v169, v138, v139
    v_mfma_f32_16x16x32_bf16 v[144:147], a[188:191], a[12:15], v[144:147]
    v_exp_f32_e64 v141, v141
    v_mfma_f32_16x16x32_bf16 v[132:135], a[160:163], a[16:19], v[196:199]
    s_waitcnt vmcnt(5)
    v_cvt_pk_bf16_f32 v170, v152, v153
    v_cvt_pk_bf16_f32 v171, v154, v155
    v_mfma_f32_16x16x32_bf16 v[132:135], a[164:167], a[20:23], v[132:135]
    s_waitcnt lgkmcnt(0)
    v_exp_f32_e64 v142, v142
    v_mfma_f32_16x16x32_bf16 v[132:135], a[168:171], a[24:27], v[132:135]
    s_barrier
    v_cvt_pk_bf16_f32 v172, v140, v141
    v_mfma_f32_16x16x32_bf16 v[132:135], a[172:175], a[28:31], v[132:135]
    s_add_u32 s77, s75, 81920
    v_exp_f32 v143, v143
    v_mfma_f32_16x16x32_bf16 v[148:151], a[176:179], a[16:19], v[196:199]
    buffer_load_dwordx4 v247, s[20:23], s39 offen offset:0 lds
    v_cvt_pk_bf16_f32 v173, v142, v143
    v_mfma_f32_16x16x32_bf16 v[148:151], a[180:183], a[20:23], v[148:151]
    s_waitcnt vmcnt(63)
    v_exp_f32 v156, v156
    v_mfma_f32_16x16x32_bf16 v[148:151], a[184:187], a[24:27], v[148:151]
    buffer_load_dwordx4 v247, s[20:23], s39 offen offset:1024 lds
    v_mfma_f32_16x16x32_bf16 v[148:151], a[188:191], a[28:31], v[148:151]
    s_add_u32 m0, s40, 8192
    v_exp_f32_e64 v157, v157
    v_mfma_f32_16x16x32_bf16 v[136:139], a[160:163], a[32:35], v[200:203]
    buffer_load_dwordx4 v247, s[20:23], s51 offen offset:0 lds
    v_cvt_pk_bf16_f32 v174, v156, v157
    v_mfma_f32_16x16x32_bf16 v[136:139], a[164:167], a[36:39], v[136:139]
    s_add_u32 s39, s38, 49152
    v_exp_f32_e64 v158, v158
    v_mfma_f32_16x16x32_bf16 v[136:139], a[168:171], a[40:43], v[136:139]
    buffer_load_dwordx4 v247, s[20:23], s51 offen offset:1024 lds
    v_mfma_f32_16x16x32_bf16 v[136:139], a[172:175], a[44:47], v[136:139]
    s_add_u32 m0, s73, 81920
    v_exp_f32_e64 v159, v159
    v_mfma_f32_16x16x32_bf16 v[152:155], a[176:179], a[32:35], v[200:203]
    ds_read_b64_tr_b16 a[192:193], v242 offset:16384
    v_cvt_pk_bf16_f32 v175, v158, v159
    v_mfma_f32_16x16x32_bf16 v[152:155], a[180:183], a[36:39], v[152:155]
    s_add_u32 s51, s38, 57344
    v_exp_f32_e64 v128, v128
    v_mfma_f32_16x16x32_bf16 v[152:155], a[184:187], a[40:43], v[152:155]
    ds_read_b64_tr_b16 a[194:195], v242 offset:20480
    v_mfma_f32_16x16x32_bf16 v[152:155], a[188:191], a[44:47], v[152:155]
    v_exp_f32_e64 v129, v129
    v_mfma_f32_16x16x32_bf16 v[140:143], a[160:163], a[48:51], v[204:207]
    ds_read_b64_tr_b16 a[196:197], v242 offset:16392
    v_cvt_pk_bf16_f32 v176, v128, v129
    v_mfma_f32_16x16x32_bf16 v[140:143], a[164:167], a[52:55], v[140:143]
    v_exp_f32_e64 v130, v130
    v_mfma_f32_16x16x32_bf16 v[140:143], a[168:171], a[56:59], v[140:143]
    ds_read_b64_tr_b16 a[198:199], v242 offset:20488
    v_mfma_f32_16x16x32_bf16 v[140:143], a[172:175], a[60:63], v[140:143]
    v_exp_f32_e64 v131, v131
    v_mfma_f32_16x16x32_bf16 v[156:159], a[176:179], a[48:51], v[204:207]
    buffer_load_dwordx4 v252, s[16:19], s74 offen lds
    v_cvt_pk_bf16_f32 v177, v130, v131
    v_mfma_f32_16x16x32_bf16 v[156:159], a[180:183], a[52:55], v[156:159]
    s_add_u32 m0, s73, 82944
    v_exp_f32_e64 v144, v144
    v_mfma_f32_16x16x32_bf16 v[156:159], a[184:187], a[56:59], v[156:159]
    ds_read_b64_tr_b16 a[200:201], v243 offset:16384
    v_mfma_f32_16x16x32_bf16 v[156:159], a[188:191], a[60:63], v[156:159]
    s_add_u32 s74, s71, 81984
    v_exp_f32_e64 v145, v145
    v_mfma_f32_16x16x32_bf16 a[224:227], a[240:243], v[160:163], a[224:227]
    ds_read_b64_tr_b16 a[202:203], v243 offset:20480
    v_cvt_pk_bf16_f32 v178, v144, v145
    v_mfma_f32_16x16x32_bf16 a[228:231], a[240:243], v[164:167], a[228:231]
    s_waitcnt lgkmcnt(4)
    v_exp_f32 v146, v146
    v_mfma_f32_16x16x32_bf16 a[232:235], a[240:243], v[168:171], a[232:235]
    buffer_load_dwordx4 v252, s[16:19], s74 offen lds
    v_mfma_f32_16x16x32_bf16 a[236:239], a[240:243], v[172:175], a[236:239]
    s_add_u32 m0, s73, 90112
    v_exp_f32_e64 v147, v147
    v_mfma_f32_16x16x32_bf16 v[0:3], a[192:195], v[160:163], v[0:3]
    ds_read_b64_tr_b16 a[204:205], v243 offset:16392
    v_cvt_pk_bf16_f32 v179, v146, v147
    v_mfma_f32_16x16x32_bf16 v[4:7], a[192:195], v[164:167], v[4:7]
    s_waitcnt lgkmcnt(3)
    v_exp_f32 v132, v132
    v_mfma_f32_16x16x32_bf16 v[8:11], a[192:195], v[168:171], v[8:11]
    ds_read_b64_tr_b16 a[206:207], v243 offset:20488
    v_mfma_f32_16x16x32_bf16 v[12:15], a[192:195], v[172:175], v[12:15]
    s_add_u32 s74, s71, 90112
    v_exp_f32_e64 v133, v133
    v_mfma_f32_16x16x32_bf16 v[16:19], a[196:199], v[160:163], v[16:19]
    ds_read_b64_tr_b16 a[208:209], v244 offset:16384
    v_cvt_pk_bf16_f32 v180, v132, v133
    v_mfma_f32_16x16x32_bf16 v[20:23], a[196:199], v[164:167], v[20:23]
    s_waitcnt lgkmcnt(3)
    v_exp_f32 v134, v134
    v_mfma_f32_16x16x32_bf16 v[24:27], a[196:199], v[168:171], v[24:27]
    ds_read_b64_tr_b16 a[210:211], v244 offset:20480
    v_mfma_f32_16x16x32_bf16 v[28:31], a[196:199], v[172:175], v[28:31]
    v_exp_f32_e64 v135, v135
    v_mfma_f32_16x16x32_bf16 v[32:35], a[200:203], v[160:163], v[32:35]
    buffer_load_dwordx4 v252, s[16:19], s74 offen lds
    v_cvt_pk_bf16_f32 v181, v134, v135
    v_mfma_f32_16x16x32_bf16 v[36:39], a[200:203], v[164:167], v[36:39]
    s_add_u32 m0, s73, 91136
    v_exp_f32_e64 v148, v148
    v_mfma_f32_16x16x32_bf16 v[40:43], a[200:203], v[168:171], v[40:43]
    ds_read_b64_tr_b16 a[212:213], v244 offset:16392
    v_mfma_f32_16x16x32_bf16 v[44:47], a[200:203], v[172:175], v[44:47]
    s_waitcnt lgkmcnt(3)
    v_exp_f32 v149, v149
    v_mfma_f32_16x16x32_bf16 v[48:51], a[204:207], v[160:163], v[48:51]
    ds_read_b64_tr_b16 a[214:215], v244 offset:20488
    v_cvt_pk_bf16_f32 v182, v148, v149
    ds_read_b128 v[216:219], v248 offset:49152
    v_mfma_f32_16x16x32_bf16 v[52:55], a[204:207], v[164:167], v[52:55]
    s_add_u32 s74, s71, 90176
    v_exp_f32_e64 v150, v150
    v_mfma_f32_16x16x32_bf16 v[56:59], a[204:207], v[168:171], v[56:59]
    buffer_load_dwordx4 v252, s[16:19], s74 offen lds
    v_mfma_f32_16x16x32_bf16 v[60:63], a[204:207], v[172:175], v[60:63]
    s_waitcnt lgkmcnt(3)
    v_exp_f32 v151, v151
    v_mfma_f32_16x16x32_bf16 v[64:67], a[208:211], v[160:163], v[64:67]
    ds_read_b64_tr_b16 a[216:217], v245 offset:16384
    v_cvt_pk_bf16_f32 v183, v150, v151
    ds_read_b64_tr_b16 a[218:219], v245 offset:20480
    v_mfma_f32_16x16x32_bf16 v[68:71], a[208:211], v[164:167], v[68:71]
    s_add_u32 m0, s40, 16384
    v_exp_f32_e64 v136, v136
    v_mfma_f32_16x16x32_bf16 v[72:75], a[208:211], v[168:171], v[72:75]
    buffer_load_dword v250, v253, s[20:23], s77 offen
    v_mfma_f32_16x16x32_bf16 v[76:79], a[208:211], v[172:175], v[76:79]
    s_waitcnt lgkmcnt(3)
    v_exp_f32 v137, v137
    s_waitcnt lgkmcnt(2)
    v_mfma_f32_16x16x32_bf16 v[80:83], a[212:215], v[160:163], v[80:83]
    ds_read_b64_tr_b16 a[220:221], v245 offset:16392
    v_lshlrev_b32 v220, 16, v216
    v_and_b32 v221, 0xffff0000, v216
    ds_read_b64_tr_b16 a[222:223], v245 offset:20488
    v_mfma_f32_16x16x32_bf16 v[84:87], a[212:215], v[164:167], v[84:87]
    s_add_u32 s74, s71, 98304
    v_exp_f32_e64 v138, v138
    v_mfma_f32_16x16x32_bf16 v[88:91], a[212:215], v[168:171], v[88:91]
    ds_read_b128 a[128:131], v240 offset:32768
    v_mul_f32 v220, s47, v220
    v_mul_f32 v221, s47, v221
    v_mfma_f32_16x16x32_bf16 v[92:95], a[212:215], v[172:175], v[92:95]
    s_waitcnt lgkmcnt(3)
    v_exp_f32 v139, v139
    v_mfma_f32_16x16x32_bf16 v[96:99], a[216:219], v[160:163], v[96:99]
    ds_read_b128 a[132:135], v240 offset:33792
    v_cvt_pk_bf16_f32 v216, v220, v221
    v_lshlrev_b32_e64 v222, 16, v217
    ds_read_b128 a[136:139], v240 offset:34816
    ds_read_b128 a[140:143], v240 offset:35840
    v_mfma_f32_16x16x32_bf16 v[100:103], a[216:219], v[164:167], v[100:103]
    v_exp_f32_e64 v152, v152
    v_mfma_f32_16x16x32_bf16 v[104:107], a[216:219], v[168:171], v[104:107]
    ds_read_b128 a[144:147], v240 offset:36864
    v_and_b32 v223, 0xffff0000, v217
    v_mul_f32 v222, s47, v222
    v_mfma_f32_16x16x32_bf16 v[108:111], a[216:219], v[172:175], v[108:111]
    s_waitcnt lgkmcnt(5)
    v_exp_f32_e64 v153, v153
    v_mfma_f32_16x16x32_bf16 v[112:115], a[220:223], v[160:163], v[112:115]
    ds_read_b128 a[148:151], v240 offset:37888
    v_mul_f32 v223, s47, v223
    v_cvt_pk_bf16_f32 v217, v222, v223
    ds_read_b128 a[152:155], v240 offset:38912
    ds_read_b128 a[156:159], v240 offset:39936
    v_mfma_f32_16x16x32_bf16 v[116:119], a[220:223], v[164:167], v[116:119]
    v_exp_f32 v154, v154
    v_mfma_f32_16x16x32_bf16 v[120:123], a[220:223], v[168:171], v[120:123]
    ds_read_b128 v[228:231], v248 offset:50176
    v_lshlrev_b32_e64 v224, 16, v218
    v_and_b32 v225, 0xffff0000, v218
    v_mfma_f32_16x16x32_bf16 v[124:127], a[220:223], v[172:175], v[124:127]
    s_waitcnt lgkmcnt(5)
    v_exp_f32 v155, v155
    v_mfma_f32_16x16x32_bf16 v[128:131], a[128:131], a[0:3], v[192:195]
    ds_read_b64_tr_b16 a[192:193], v242 offset:24576
    v_mul_f32 v224, s47, v224
    v_mfma_f32_16x16x32_bf16 v[128:131], a[132:135], a[4:7], v[128:131]
    v_exp_f32 v140, v140
    v_mul_f32 v225, s47, v225
    v_cvt_pk_bf16_f32 v218, v224, v225
    v_mfma_f32_16x16x32_bf16 v[128:131], a[136:139], a[8:11], v[128:131]
    ds_read_b64_tr_b16 a[194:195], v242 offset:28672
    v_lshlrev_b32 v226, 16, v219
    v_mfma_f32_16x16x32_bf16 v[128:131], a[140:143], a[12:15], v[128:131]
    s_waitcnt lgkmcnt(3)
    v_exp_f32 v141, v141
    v_and_b32 v227, 0xffff0000, v219
    v_mfma_f32_16x16x32_bf16 v[144:147], a[144:147], a[0:3], v[192:195]
    ds_read_b64_tr_b16 a[196:197], v242 offset:24584
    v_mul_f32 v226, s47, v226
    v_mfma_f32_16x16x32_bf16 v[144:147], a[148:151], a[4:7], v[144:147]
    v_exp_f32 v142, v142
    v_mul_f32 v227, s47, v227
    v_mfma_f32_16x16x32_bf16 v[144:147], a[152:155], a[8:11], v[144:147]
    ds_read_b64_tr_b16 a[198:199], v242 offset:28680
    v_cvt_pk_bf16_f32 v219, v226, v227
    v_mfma_f32_16x16x32_bf16 v[144:147], a[156:159], a[12:15], v[144:147]
    s_waitcnt lgkmcnt(4)
    v_exp_f32_e64 v143, v143
    ds_write_b128 v248, v[216:219] offset:49152
    v_mfma_f32_16x16x32_bf16 v[132:135], a[128:131], a[16:19], v[196:199]
    ds_read_b128 v[216:219], v248 offset:57344
    v_lshlrev_b32_e64 v232, 16, v228
    v_and_b32 v233, 0xffff0000, v228
    v_mfma_f32_16x16x32_bf16 v[132:135], a[132:135], a[20:23], v[132:135]
    v_exp_f32_e64 v156, v156
    v_mfma_f32_16x16x32_bf16 v[132:135], a[136:139], a[24:27], v[132:135]
    ds_read_b64_tr_b16 a[200:201], v243 offset:24576
    v_mul_f32 v232, s47, v232
    v_mul_f32 v233, s47, v233
    v_mfma_f32_16x16x32_bf16 v[132:135], a[140:143], a[28:31], v[132:135]
    v_exp_f32_e64 v157, v157
    v_mfma_f32_16x16x32_bf16 v[148:151], a[144:147], a[16:19], v[196:199]
    ds_read_b64_tr_b16 a[202:203], v243 offset:28672
    v_cvt_pk_bf16_f32 v228, v232, v233
    v_cvt_pk_bf16_f32 v184, v136, v137
    v_mfma_f32_16x16x32_bf16 v[148:151], a[148:151], a[20:23], v[148:151]
    v_exp_f32_e64 v158, v158
    v_mfma_f32_16x16x32_bf16 v[148:151], a[152:155], a[24:27], v[148:151]
    ds_read_b64_tr_b16 a[204:205], v243 offset:24584
    v_cvt_pk_bf16_f32 v185, v138, v139
    v_lshlrev_b32_e64 v234, 16, v229
    v_mfma_f32_16x16x32_bf16 v[148:151], a[156:159], a[28:31], v[148:151]
    v_exp_f32_e64 v159, v159
    v_and_b32 v235, 0xffff0000, v229
    v_mfma_f32_16x16x32_bf16 v[136:139], a[128:131], a[32:35], v[200:203]
    ds_read_b64_tr_b16 a[206:207], v243 offset:28680
    v_mul_f32 v234, s47, v234
    v_mul_f32 v235, s47, v235
    v_mfma_f32_16x16x32_bf16 v[136:139], a[132:135], a[36:39], v[136:139]
    v_exp_f32_e64 v128, v128
    v_mfma_f32_16x16x32_bf16 v[136:139], a[136:139], a[40:43], v[136:139]
    ds_read_b64_tr_b16 a[208:209], v244 offset:24576
    v_cvt_pk_bf16_f32 v229, v234, v235
    v_cvt_pk_bf16_f32 v186, v152, v153
    v_mfma_f32_16x16x32_bf16 v[136:139], a[140:143], a[44:47], v[136:139]
    v_exp_f32_e64 v129, v129
    v_cvt_pk_bf16_f32 v187, v154, v155
    v_lshlrev_b32_e64 v236, 16, v230
    v_mfma_f32_16x16x32_bf16 v[152:155], a[144:147], a[32:35], v[200:203]
    ds_read_b64_tr_b16 a[210:211], v244 offset:28672
    v_and_b32 v237, 0xffff0000, v230
    v_mul_f32 v236, s47, v236
    v_mfma_f32_16x16x32_bf16 v[152:155], a[148:151], a[36:39], v[152:155]
    v_exp_f32 v130, v130
    v_mfma_f32_16x16x32_bf16 v[152:155], a[152:155], a[40:43], v[152:155]
    ds_read_b64_tr_b16 a[212:213], v244 offset:24584
    v_mul_f32 v237, s47, v237
    v_cvt_pk_bf16_f32 v188, v140, v141
    v_mfma_f32_16x16x32_bf16 v[152:155], a[156:159], a[44:47], v[152:155]
    v_exp_f32 v131, v131
    v_cvt_pk_bf16_f32 v189, v142, v143
    v_cvt_pk_bf16_f32 v230, v236, v237
    v_mfma_f32_16x16x32_bf16 v[140:143], a[128:131], a[48:51], v[204:207]
    ds_read_b64_tr_b16 a[214:215], v244 offset:28680
    v_lshlrev_b32_e64 v238, 16, v231
    v_and_b32 v239, 0xffff0000, v231
    v_mfma_f32_16x16x32_bf16 v[140:143], a[132:135], a[52:55], v[140:143]
    v_exp_f32_e64 v144, v144
    v_mfma_f32_16x16x32_bf16 v[140:143], a[136:139], a[56:59], v[140:143]
    ds_read_b64_tr_b16 a[216:217], v245 offset:24576
    v_mul_f32 v238, s47, v238
    v_mfma_f32_16x16x32_bf16 v[140:143], a[140:143], a[60:63], v[140:143]
    v_exp_f32 v145, v145
    v_cvt_pk_bf16_f32 v190, v156, v157
    v_cvt_pk_bf16_f32 v191, v158, v159
    v_mul_f32 v239, s47, v239
    v_mfma_f32_16x16x32_bf16 v[156:159], a[144:147], a[48:51], v[204:207]
    ds_read_b64_tr_b16 a[218:219], v245 offset:28672
    v_cvt_pk_bf16_f32 v231, v238, v239
    v_mfma_f32_16x16x32_bf16 v[156:159], a[148:151], a[52:55], v[156:159]
    s_waitcnt lgkmcnt(10)
    v_exp_f32_e64 v146, v146
    ds_write_b128 v248, v[228:231] offset:50176
    v_mfma_f32_16x16x32_bf16 v[156:159], a[152:155], a[56:59], v[156:159]
    ds_read_b128 v[228:231], v248 offset:58368
    v_lshlrev_b32_e64 v220, 16, v216
    v_and_b32 v221, 0xffff0000, v216
    v_mfma_f32_16x16x32_bf16 v[156:159], a[156:159], a[60:63], v[156:159]
    v_exp_f32_e64 v147, v147
    v_mfma_f32_16x16x32_bf16 a[224:227], a[240:243], v[176:179], a[224:227]
    ds_read_b64_tr_b16 a[220:221], v245 offset:24584
    v_mul_f32 v220, s47, v220
    v_mul_f32 v221, s47, v221
    v_mfma_f32_16x16x32_bf16 a[228:231], a[240:243], v[180:183], a[228:231]
    s_waitcnt lgkmcnt(15)
    v_exp_f32 v132, v132
    v_mfma_f32_16x16x32_bf16 a[232:235], a[240:243], v[184:187], a[232:235]
    ds_read_b64_tr_b16 a[222:223], v245 offset:28680
    v_cvt_pk_bf16_f32 v216, v220, v221
    v_lshlrev_b32_e64 v222, 16, v217
    v_mfma_f32_16x16x32_bf16 a[236:239], a[240:243], v[188:191], a[236:239]
    v_exp_f32_e64 v133, v133
    v_mfma_f32_16x16x32_bf16 v[0:3], a[192:195], v[176:179], v[0:3]
    ds_read_b128 a[160:163], v240 offset:40960
    v_and_b32 v223, 0xffff0000, v217
    v_mul_f32 v222, s47, v222
    v_mfma_f32_16x16x32_bf16 v[4:7], a[192:195], v[180:183], v[4:7]
    s_waitcnt lgkmcnt(15)
    v_exp_f32_e64 v134, v134
    v_mfma_f32_16x16x32_bf16 v[8:11], a[192:195], v[184:187], v[8:11]
    ds_read_b128 a[164:167], v240 offset:41984
    v_mul_f32 v223, s47, v223
    v_cvt_pk_bf16_f32 v217, v222, v223
    v_mfma_f32_16x16x32_bf16 v[12:15], a[192:195], v[188:191], v[12:15]
    v_exp_f32 v135, v135
    v_mfma_f32_16x16x32_bf16 v[16:19], a[196:199], v[176:179], v[16:19]
    ds_read_b128 a[168:171], v240 offset:43008
    v_lshlrev_b32_e64 v224, 16, v218
    v_and_b32 v225, 0xffff0000, v218
    v_mfma_f32_16x16x32_bf16 v[20:23], a[196:199], v[180:183], v[20:23]
    s_waitcnt lgkmcnt(15)
    v_exp_f32 v148, v148
    v_mfma_f32_16x16x32_bf16 v[24:27], a[196:199], v[184:187], v[24:27]
    ds_read_b128 a[172:175], v240 offset:44032
    v_mul_f32 v224, s47, v224
    v_mfma_f32_16x16x32_bf16 v[28:31], a[196:199], v[188:191], v[28:31]
    v_exp_f32 v149, v149
    v_mfma_f32_16x16x32_bf16 v[32:35], a[200:203], v[176:179], v[32:35]
    ds_read_b128 a[176:179], v240 offset:45056
    v_mul_f32 v225, s47, v225
    v_cvt_pk_bf16_f32 v218, v224, v225
    v_mfma_f32_16x16x32_bf16 v[36:39], a[200:203], v[180:183], v[36:39]
    s_waitcnt lgkmcnt(15)
    v_exp_f32 v150, v150
    v_lshlrev_b32 v226, 16, v219
    v_mfma_f32_16x16x32_bf16 v[40:43], a[200:203], v[184:187], v[40:43]
    ds_read_b128 a[180:183], v240 offset:46080
    v_and_b32 v227, 0xffff0000, v219
    v_mfma_f32_16x16x32_bf16 v[44:47], a[200:203], v[188:191], v[44:47]
    v_exp_f32 v151, v151
    v_mul_f32 v226, s47, v226
    v_mfma_f32_16x16x32_bf16 v[48:51], a[204:207], v[176:179], v[48:51]
    ds_read_b128 a[184:187], v240 offset:47104
    v_mul_f32 v227, s47, v227
    v_mfma_f32_16x16x32_bf16 v[52:55], a[204:207], v[180:183], v[52:55]
    s_waitcnt lgkmcnt(15)
    v_exp_f32_e64 v136, v136
    v_cvt_pk_bf16_f32 v219, v226, v227
    v_mfma_f32_16x16x32_bf16 v[56:59], a[204:207], v[184:187], v[56:59]
    ds_write_b128 v248, v[216:219] offset:57344
    v_cvt_pk_bf16_f32 v160, v128, v129
    v_mfma_f32_16x16x32_bf16 v[60:63], a[204:207], v[188:191], v[60:63]
    s_waitcnt lgkmcnt(10)
    v_exp_f32 v137, v137
    v_mfma_f32_16x16x32_bf16 v[64:67], a[208:211], v[176:179], v[64:67]
    ds_read_b128 a[188:191], v240 offset:48128
    v_lshlrev_b32_e64 v232, 16, v228
    v_and_b32 v233, 0xffff0000, v228
    v_mfma_f32_16x16x32_bf16 v[68:71], a[208:211], v[180:183], v[68:71]
    s_waitcnt lgkmcnt(15)
    v_exp_f32 v138, v138
    v_mfma_f32_16x16x32_bf16 v[72:75], a[208:211], v[184:187], v[72:75]
    v_mul_f32 v232, s47, v232
    v_mul_f32 v233, s47, v233
    v_cvt_pk_bf16_f32 v228, v232, v233
    v_mfma_f32_16x16x32_bf16 v[76:79], a[208:211], v[188:191], v[76:79]
    v_exp_f32_e64 v139, v139
    v_mfma_f32_16x16x32_bf16 v[80:83], a[212:215], v[176:179], v[80:83]
    v_lshlrev_b32_e64 v234, 16, v229
    v_and_b32 v235, 0xffff0000, v229
    v_mul_f32 v234, s47, v234
    v_mfma_f32_16x16x32_bf16 v[84:87], a[212:215], v[180:183], v[84:87]
    s_waitcnt lgkmcnt(15)
    v_exp_f32_e64 v152, v152
    v_mfma_f32_16x16x32_bf16 v[88:91], a[212:215], v[184:187], v[88:91]
    v_mul_f32 v235, s47, v235
    v_cvt_pk_bf16_f32 v229, v234, v235
    v_lshlrev_b32 v236, 16, v230
    v_mfma_f32_16x16x32_bf16 v[92:95], a[212:215], v[188:191], v[92:95]
    v_exp_f32_e64 v153, v153
    v_mfma_f32_16x16x32_bf16 v[96:99], a[216:219], v[176:179], v[96:99]
    v_and_b32 v237, 0xffff0000, v230
    v_mul_f32 v236, s47, v236
    v_mul_f32 v237, s47, v237
    v_mfma_f32_16x16x32_bf16 v[100:103], a[216:219], v[180:183], v[100:103]
    s_waitcnt lgkmcnt(9)
    v_exp_f32 v154, v154
    v_mfma_f32_16x16x32_bf16 v[104:107], a[216:219], v[184:187], v[104:107]
    v_cvt_pk_bf16_f32 v230, v236, v237
    v_cvt_pk_bf16_f32 v161, v130, v131
    v_lshlrev_b32_e64 v238, 16, v231
    v_mfma_f32_16x16x32_bf16 v[108:111], a[216:219], v[188:191], v[108:111]
    v_exp_f32_e64 v155, v155
    v_mfma_f32_16x16x32_bf16 v[112:115], a[220:223], v[176:179], v[112:115]
    v_and_b32 v239, 0xffff0000, v231
    v_mul_f32 v238, s47, v238
    v_mul_f32 v239, s47, v239
    v_mfma_f32_16x16x32_bf16 v[116:119], a[220:223], v[180:183], v[116:119]
    s_waitcnt lgkmcnt(5)
    v_exp_f32 v140, v140
    v_mfma_f32_16x16x32_bf16 v[120:123], a[220:223], v[184:187], v[120:123]
    v_cvt_pk_bf16_f32 v162, v144, v145
    v_cvt_pk_bf16_f32 v163, v146, v147
    v_mfma_f32_16x16x32_bf16 v[124:127], a[220:223], v[188:191], v[124:127]
    v_exp_f32_e64 v141, v141
    v_mfma_f32_16x16x32_bf16 v[128:131], a[160:163], a[0:3], v[192:195]
    v_cvt_pk_bf16_f32 v231, v238, v239
    v_cvt_pk_bf16_f32 v164, v132, v133
    v_mfma_f32_16x16x32_bf16 v[128:131], a[164:167], a[4:7], v[128:131]
    s_waitcnt lgkmcnt(0)
    v_exp_f32 v142, v142
    v_mfma_f32_16x16x32_bf16 v[128:131], a[168:171], a[8:11], v[128:131]
    ds_write_b128 v248, v[228:231] offset:58368
    v_cvt_pk_bf16_f32 v165, v134, v135
    v_mfma_f32_16x16x32_bf16 v[128:131], a[172:175], a[12:15], v[128:131]
    v_exp_f32_e64 v143, v143
    v_mfma_f32_16x16x32_bf16 v[144:147], a[176:179], a[0:3], v[192:195]
    v_cvt_pk_bf16_f32 v166, v148, v149
    v_cvt_pk_bf16_f32 v167, v150, v151
    v_mfma_f32_16x16x32_bf16 v[144:147], a[180:183], a[4:7], v[144:147]
    v_exp_f32_e64 v156, v156
    v_mfma_f32_16x16x32_bf16 v[144:147], a[184:187], a[8:11], v[144:147]
    v_cvt_pk_bf16_f32 v168, v136, v137
    v_cvt_pk_bf16_f32 v169, v138, v139
    v_mfma_f32_16x16x32_bf16 v[144:147], a[188:191], a[12:15], v[144:147]
    v_exp_f32_e64 v157, v157
    v_mfma_f32_16x16x32_bf16 v[132:135], a[160:163], a[16:19], v[196:199]
    s_waitcnt vmcnt(5)
    v_cvt_pk_bf16_f32 v170, v152, v153
    v_cvt_pk_bf16_f32 v171, v154, v155
    v_mfma_f32_16x16x32_bf16 v[132:135], a[164:167], a[20:23], v[132:135]
    s_waitcnt lgkmcnt(0)
    v_exp_f32_e64 v158, v158
    v_mfma_f32_16x16x32_bf16 v[132:135], a[168:171], a[24:27], v[132:135]
    s_barrier
    v_cvt_pk_bf16_f32 v172, v140, v141
    v_mfma_f32_16x16x32_bf16 v[132:135], a[172:175], a[28:31], v[132:135]
    s_add_u32 s77, s75, 98304
    v_exp_f32 v159, v159
    v_mfma_f32_16x16x32_bf16 v[148:151], a[176:179], a[16:19], v[196:199]
    buffer_load_dwordx4 v247, s[20:23], s39 offen offset:0 lds
    v_cvt_pk_bf16_f32 v173, v142, v143
    v_mfma_f32_16x16x32_bf16 v[148:151], a[180:183], a[20:23], v[148:151]
    s_waitcnt vmcnt(63)
    v_exp_f32 v128, v128
    v_mfma_f32_16x16x32_bf16 v[148:151], a[184:187], a[24:27], v[148:151]
    buffer_load_dwordx4 v247, s[20:23], s39 offen offset:1024 lds
    v_cvt_pk_bf16_f32 v174, v156, v157
    v_mfma_f32_16x16x32_bf16 v[148:151], a[188:191], a[28:31], v[148:151]
    s_add_u32 m0, s40, 24576
    v_exp_f32_e64 v129, v129
    v_mfma_f32_16x16x32_bf16 v[136:139], a[160:163], a[32:35], v[200:203]
    buffer_load_dwordx4 v247, s[20:23], s51 offen offset:0 lds
    v_cvt_pk_bf16_f32 v175, v158, v159
    v_mfma_f32_16x16x32_bf16 v[136:139], a[164:167], a[36:39], v[136:139]
    s_add_u32 s39, s38, 65536
    v_exp_f32_e64 v130, v130
    v_mfma_f32_16x16x32_bf16 v[136:139], a[168:171], a[40:43], v[136:139]
    buffer_load_dwordx4 v247, s[20:23], s51 offen offset:1024 lds
    v_cvt_pk_bf16_f32 v176, v128, v129
    v_mfma_f32_16x16x32_bf16 v[136:139], a[172:175], a[44:47], v[136:139]
    s_add_u32 m0, s73, 98304
    v_exp_f32_e64 v131, v131
    v_mfma_f32_16x16x32_bf16 v[152:155], a[176:179], a[32:35], v[200:203]
    ds_read_b64_tr_b16 a[192:193], v242 offset:0
    v_cvt_pk_bf16_f32 v177, v130, v131
    v_mfma_f32_16x16x32_bf16 v[152:155], a[180:183], a[36:39], v[152:155]
    s_add_u32 s51, s38, 73728
    v_exp_f32_e64 v144, v144
    v_mfma_f32_16x16x32_bf16 v[152:155], a[184:187], a[40:43], v[152:155]
    ds_read_b64_tr_b16 a[194:195], v242 offset:4096
    v_mfma_f32_16x16x32_bf16 v[152:155], a[188:191], a[44:47], v[152:155]
    v_exp_f32_e64 v145, v145
    v_mfma_f32_16x16x32_bf16 v[140:143], a[160:163], a[48:51], v[204:207]
    ds_read_b64_tr_b16 a[196:197], v242 offset:8
    v_cvt_pk_bf16_f32 v178, v144, v145
    v_mfma_f32_16x16x32_bf16 v[140:143], a[164:167], a[52:55], v[140:143]
    v_exp_f32_e64 v146, v146
    v_mfma_f32_16x16x32_bf16 v[140:143], a[168:171], a[56:59], v[140:143]
    ds_read_b64_tr_b16 a[198:199], v242 offset:4104
    v_mfma_f32_16x16x32_bf16 v[140:143], a[172:175], a[60:63], v[140:143]
    v_exp_f32_e64 v147, v147
    v_mfma_f32_16x16x32_bf16 v[156:159], a[176:179], a[48:51], v[204:207]
    buffer_load_dwordx4 v252, s[16:19], s74 offen lds
    v_cvt_pk_bf16_f32 v179, v146, v147
    v_mfma_f32_16x16x32_bf16 v[156:159], a[180:183], a[52:55], v[156:159]
    s_add_u32 m0, s73, 99328
    v_exp_f32_e64 v132, v132
    v_mfma_f32_16x16x32_bf16 v[156:159], a[184:187], a[56:59], v[156:159]
    ds_read_b64_tr_b16 a[200:201], v243 offset:0
    v_mfma_f32_16x16x32_bf16 v[156:159], a[188:191], a[60:63], v[156:159]
    s_add_u32 s74, s71, 98368
    v_exp_f32_e64 v133, v133
    v_mfma_f32_16x16x32_bf16 a[224:227], a[240:243], v[160:163], a[224:227]
    ds_read_b64_tr_b16 a[202:203], v243 offset:4096
    v_cvt_pk_bf16_f32 v180, v132, v133
    v_mfma_f32_16x16x32_bf16 a[228:231], a[240:243], v[164:167], a[228:231]
    s_waitcnt lgkmcnt(4)
    v_exp_f32 v134, v134
    v_mfma_f32_16x16x32_bf16 a[232:235], a[240:243], v[168:171], a[232:235]
    buffer_load_dwordx4 v252, s[16:19], s74 offen lds
    v_mfma_f32_16x16x32_bf16 a[236:239], a[240:243], v[172:175], a[236:239]
    s_add_u32 m0, s73, 106496
    v_exp_f32_e64 v135, v135
    v_mfma_f32_16x16x32_bf16 v[0:3], a[192:195], v[160:163], v[0:3]
    ds_read_b64_tr_b16 a[204:205], v243 offset:8
    v_cvt_pk_bf16_f32 v181, v134, v135
    v_mfma_f32_16x16x32_bf16 v[4:7], a[192:195], v[164:167], v[4:7]
    s_waitcnt lgkmcnt(3)
    v_exp_f32 v148, v148
    v_mfma_f32_16x16x32_bf16 v[8:11], a[192:195], v[168:171], v[8:11]
    ds_read_b64_tr_b16 a[206:207], v243 offset:4104
    v_mfma_f32_16x16x32_bf16 v[12:15], a[192:195], v[172:175], v[12:15]
    s_add_u32 s74, s71, 106496
    v_exp_f32_e64 v149, v149
    v_mfma_f32_16x16x32_bf16 v[16:19], a[196:199], v[160:163], v[16:19]
    ds_read_b64_tr_b16 a[208:209], v244 offset:0
    v_cvt_pk_bf16_f32 v182, v148, v149
    v_mfma_f32_16x16x32_bf16 v[20:23], a[196:199], v[164:167], v[20:23]
    s_waitcnt lgkmcnt(3)
    v_exp_f32 v150, v150
    v_mfma_f32_16x16x32_bf16 v[24:27], a[196:199], v[168:171], v[24:27]
    ds_read_b64_tr_b16 a[210:211], v244 offset:4096
    v_mfma_f32_16x16x32_bf16 v[28:31], a[196:199], v[172:175], v[28:31]
    v_exp_f32_e64 v151, v151
    v_mfma_f32_16x16x32_bf16 v[32:35], a[200:203], v[160:163], v[32:35]
    buffer_load_dwordx4 v252, s[16:19], s74 offen lds
    v_cvt_pk_bf16_f32 v183, v150, v151
    v_mfma_f32_16x16x32_bf16 v[36:39], a[200:203], v[164:167], v[36:39]
    s_add_u32 m0, s73, 107520
    v_exp_f32_e64 v136, v136
    v_mfma_f32_16x16x32_bf16 v[40:43], a[200:203], v[168:171], v[40:43]
    ds_read_b64_tr_b16 a[212:213], v244 offset:8
    v_mfma_f32_16x16x32_bf16 v[44:47], a[200:203], v[172:175], v[44:47]
    s_waitcnt lgkmcnt(3)
    v_exp_f32 v137, v137
    v_mfma_f32_16x16x32_bf16 v[48:51], a[204:207], v[160:163], v[48:51]
    ds_read_b64_tr_b16 a[214:215], v244 offset:4104
    v_cvt_pk_bf16_f32 v184, v136, v137
    ds_read_b128 v[216:219], v249 offset:0
    v_mfma_f32_16x16x32_bf16 v[52:55], a[204:207], v[164:167], v[52:55]
    s_add_u32 s74, s71, 106560
    v_exp_f32_e64 v138, v138
    v_mfma_f32_16x16x32_bf16 v[56:59], a[204:207], v[168:171], v[56:59]
    buffer_load_dwordx4 v252, s[16:19], s74 offen lds
    v_mfma_f32_16x16x32_bf16 v[60:63], a[204:207], v[172:175], v[60:63]
    s_waitcnt lgkmcnt(3)
    v_exp_f32 v139, v139
    v_mfma_f32_16x16x32_bf16 v[64:67], a[208:211], v[160:163], v[64:67]
    ds_read_b64_tr_b16 a[216:217], v245 offset:0
    v_cvt_pk_bf16_f32 v185, v138, v139
    ds_read_b64_tr_b16 a[218:219], v245 offset:4096
    v_mfma_f32_16x16x32_bf16 v[68:71], a[208:211], v[164:167], v[68:71]
    s_add_u32 m0, s40, 0
    v_exp_f32 v152, v152
    v_mfma_f32_16x16x32_bf16 v[72:75], a[208:211], v[168:171], v[72:75]
    buffer_load_dword v250, v253, s[20:23], s77 offen
    v_mfma_f32_16x16x32_bf16 v[76:79], a[208:211], v[172:175], v[76:79]
    s_waitcnt lgkmcnt(3)
    v_exp_f32 v153, v153
    s_waitcnt lgkmcnt(2)
    v_mfma_f32_16x16x32_bf16 v[80:83], a[212:215], v[160:163], v[80:83]
    ds_read_b64_tr_b16 a[220:221], v245 offset:8
    v_lshlrev_b32 v220, 16, v216
    v_and_b32 v221, 0xffff0000, v216
    ds_read_b64_tr_b16 a[222:223], v245 offset:4104
    v_mfma_f32_16x16x32_bf16 v[84:87], a[212:215], v[164:167], v[84:87]
    s_add_u32 s74, s71, 114688
    v_exp_f32_e64 v154, v154
    v_mfma_f32_16x16x32_bf16 v[88:91], a[212:215], v[168:171], v[88:91]
    ds_read_b128 a[128:131], v240 offset:49152
    v_mul_f32 v220, s47, v220
    v_mul_f32 v221, s47, v221
    v_mfma_f32_16x16x32_bf16 v[92:95], a[212:215], v[172:175], v[92:95]
    s_waitcnt lgkmcnt(3)
    v_exp_f32 v155, v155
    v_mfma_f32_16x16x32_bf16 v[96:99], a[216:219], v[160:163], v[96:99]
    ds_read_b128 a[132:135], v240 offset:50176
    v_cvt_pk_bf16_f32 v216, v220, v221
    v_lshlrev_b32_e64 v222, 16, v217
    ds_read_b128 a[136:139], v240 offset:51200
    ds_read_b128 a[140:143], v240 offset:52224
    v_mfma_f32_16x16x32_bf16 v[100:103], a[216:219], v[164:167], v[100:103]
    v_exp_f32_e64 v140, v140
    v_mfma_f32_16x16x32_bf16 v[104:107], a[216:219], v[168:171], v[104:107]
    ds_read_b128 a[144:147], v240 offset:53248
    v_and_b32 v223, 0xffff0000, v217
    v_mul_f32 v222, s47, v222
    v_mfma_f32_16x16x32_bf16 v[108:111], a[216:219], v[172:175], v[108:111]
    s_waitcnt lgkmcnt(5)
    v_exp_f32_e64 v141, v141
    v_mfma_f32_16x16x32_bf16 v[112:115], a[220:223], v[160:163], v[112:115]
    ds_read_b128 a[148:151], v240 offset:54272
    v_mul_f32 v223, s47, v223
    v_cvt_pk_bf16_f32 v217, v222, v223
    ds_read_b128 a[152:155], v240 offset:55296
    ds_read_b128 a[156:159], v240 offset:56320
    v_mfma_f32_16x16x32_bf16 v[116:119], a[220:223], v[164:167], v[116:119]
    v_exp_f32 v142, v142
    v_mfma_f32_16x16x32_bf16 v[120:123], a[220:223], v[168:171], v[120:123]
    ds_read_b128 v[228:231], v249 offset:1024
    v_lshlrev_b32_e64 v224, 16, v218
    v_and_b32 v225, 0xffff0000, v218
    v_mfma_f32_16x16x32_bf16 v[124:127], a[220:223], v[172:175], v[124:127]
    s_waitcnt lgkmcnt(5)
    v_exp_f32 v143, v143
    v_mfma_f32_16x16x32_bf16 v[128:131], a[128:131], a[0:3], v[192:195]
    ds_read_b64_tr_b16 a[192:193], v242 offset:8192
    v_mul_f32 v224, s47, v224
    v_mfma_f32_16x16x32_bf16 v[128:131], a[132:135], a[4:7], v[128:131]
    v_exp_f32 v156, v156
    v_mul_f32 v225, s47, v225
    v_cvt_pk_bf16_f32 v218, v224, v225
    v_mfma_f32_16x16x32_bf16 v[128:131], a[136:139], a[8:11], v[128:131]
    ds_read_b64_tr_b16 a[194:195], v242 offset:12288
    v_lshlrev_b32 v226, 16, v219
    v_mfma_f32_16x16x32_bf16 v[128:131], a[140:143], a[12:15], v[128:131]
    s_waitcnt lgkmcnt(3)
    v_exp_f32 v157, v157
    v_and_b32 v227, 0xffff0000, v219
    v_mfma_f32_16x16x32_bf16 v[144:147], a[144:147], a[0:3], v[192:195]
    ds_read_b64_tr_b16 a[196:197], v242 offset:8200
    v_mul_f32 v226, s47, v226
    v_mfma_f32_16x16x32_bf16 v[144:147], a[148:151], a[4:7], v[144:147]
    v_exp_f32 v158, v158
    v_mul_f32 v227, s47, v227
    v_mfma_f32_16x16x32_bf16 v[144:147], a[152:155], a[8:11], v[144:147]
    ds_read_b64_tr_b16 a[198:199], v242 offset:12296
    v_cvt_pk_bf16_f32 v219, v226, v227
    v_mfma_f32_16x16x32_bf16 v[144:147], a[156:159], a[12:15], v[144:147]
    s_waitcnt lgkmcnt(4)
    v_exp_f32_e64 v159, v159
    ds_write_b128 v249, v[216:219] offset:0
    v_mfma_f32_16x16x32_bf16 v[132:135], a[128:131], a[16:19], v[196:199]
    ds_read_b128 v[216:219], v249 offset:8192
    v_lshlrev_b32_e64 v232, 16, v228
    v_and_b32 v233, 0xffff0000, v228
    v_mfma_f32_16x16x32_bf16 v[132:135], a[132:135], a[20:23], v[132:135]
    v_exp_f32_e64 v128, v128
    v_mfma_f32_16x16x32_bf16 v[132:135], a[136:139], a[24:27], v[132:135]
    ds_read_b64_tr_b16 a[200:201], v243 offset:8192
    v_mul_f32 v232, s47, v232
    v_mul_f32 v233, s47, v233
    v_mfma_f32_16x16x32_bf16 v[132:135], a[140:143], a[28:31], v[132:135]
    v_exp_f32_e64 v129, v129
    v_mfma_f32_16x16x32_bf16 v[148:151], a[144:147], a[16:19], v[196:199]
    ds_read_b64_tr_b16 a[202:203], v243 offset:12288
    v_cvt_pk_bf16_f32 v228, v232, v233
    v_lshlrev_b32_e64 v234, 16, v229
    v_mfma_f32_16x16x32_bf16 v[148:151], a[148:151], a[20:23], v[148:151]
    v_exp_f32_e64 v130, v130
    v_mfma_f32_16x16x32_bf16 v[148:151], a[152:155], a[24:27], v[148:151]
    ds_read_b64_tr_b16 a[204:205], v243 offset:8200
    v_and_b32 v235, 0xffff0000, v229
    v_mul_f32 v234, s47, v234
    v_mfma_f32_16x16x32_bf16 v[148:151], a[156:159], a[28:31], v[148:151]
    v_exp_f32 v131, v131
    v_mfma_f32_16x16x32_bf16 v[136:139], a[128:131], a[32:35], v[200:203]
    ds_read_b64_tr_b16 a[206:207], v243 offset:12296
    v_mul_f32 v235, s47, v235
    v_cvt_pk_bf16_f32 v229, v234, v235
    v_mfma_f32_16x16x32_bf16 v[136:139], a[132:135], a[36:39], v[136:139]
    v_exp_f32 v144, v144
    v_mfma_f32_16x16x32_bf16 v[136:139], a[136:139], a[40:43], v[136:139]
    ds_read_b64_tr_b16 a[208:209], v244 offset:8192
    v_cvt_pk_bf16_f32 v186, v152, v153
    v_cvt_pk_bf16_f32 v187, v154, v155
    v_mfma_f32_16x16x32_bf16 v[136:139], a[140:143], a[44:47], v[136:139]
    v_exp_f32 v145, v145
    v_lshlrev_b32 v236, 16, v230
    v_mfma_f32_16x16x32_bf16 v[152:155], a[144:147], a[32:35], v[200:203]
    ds_read_b64_tr_b16 a[210:211], v244 offset:12288
    v_and_b32 v237, 0xffff0000, v230
    v_mul_f32 v236, s47, v236
    v_mfma_f32_16x16x32_bf16 v[152:155], a[148:151], a[36:39], v[152:155]
    v_exp_f32 v146, v146
    v_mfma_f32_16x16x32_bf16 v[152:155], a[152:155], a[40:43], v[152:155]
    ds_read_b64_tr_b16 a[212:213], v244 offset:8200
    v_mul_f32 v237, s47, v237
    v_cvt_pk_bf16_f32 v188, v140, v141
    v_mfma_f32_16x16x32_bf16 v[152:155], a[156:159], a[44:47], v[152:155]
    v_exp_f32 v147, v147
    v_cvt_pk_bf16_f32 v189, v142, v143
    v_cvt_pk_bf16_f32 v230, v236, v237
    v_mfma_f32_16x16x32_bf16 v[140:143], a[128:131], a[48:51], v[204:207]
    ds_read_b64_tr_b16 a[214:215], v244 offset:12296
    v_lshlrev_b32_e64 v238, 16, v231
    v_and_b32 v239, 0xffff0000, v231
    v_mfma_f32_16x16x32_bf16 v[140:143], a[132:135], a[52:55], v[140:143]
    v_exp_f32_e64 v132, v132
    v_mfma_f32_16x16x32_bf16 v[140:143], a[136:139], a[56:59], v[140:143]
    ds_read_b64_tr_b16 a[216:217], v245 offset:8192
    v_mul_f32 v238, s47, v238
    v_mfma_f32_16x16x32_bf16 v[140:143], a[140:143], a[60:63], v[140:143]
    v_exp_f32 v133, v133
    v_cvt_pk_bf16_f32 v190, v156, v157
    v_cvt_pk_bf16_f32 v191, v158, v159
    v_mul_f32 v239, s47, v239
    v_mfma_f32_16x16x32_bf16 v[156:159], a[144:147], a[48:51], v[204:207]
    ds_read_b64_tr_b16 a[218:219], v245 offset:12288
    v_cvt_pk_bf16_f32 v231, v238, v239
    v_mfma_f32_16x16x32_bf16 v[156:159], a[148:151], a[52:55], v[156:159]
    s_waitcnt lgkmcnt(10)
    v_exp_f32_e64 v134, v134
    ds_write_b128 v249, v[228:231] offset:1024
    v_mfma_f32_16x16x32_bf16 v[156:159], a[152:155], a[56:59], v[156:159]
    ds_read_b128 v[228:231], v249 offset:9216
    v_lshlrev_b32_e64 v220, 16, v216
    v_and_b32 v221, 0xffff0000, v216
    v_mfma_f32_16x16x32_bf16 v[156:159], a[156:159], a[60:63], v[156:159]
    v_exp_f32_e64 v135, v135
    v_mfma_f32_16x16x32_bf16 a[224:227], a[240:243], v[176:179], a[224:227]
    ds_read_b64_tr_b16 a[220:221], v245 offset:8200
    v_mul_f32 v220, s47, v220
    v_mul_f32 v221, s47, v221
    v_mfma_f32_16x16x32_bf16 a[228:231], a[240:243], v[180:183], a[228:231]
    s_waitcnt lgkmcnt(15)
    v_exp_f32 v148, v148
    v_mfma_f32_16x16x32_bf16 a[232:235], a[240:243], v[184:187], a[232:235]
    ds_read_b64_tr_b16 a[222:223], v245 offset:12296
    v_cvt_pk_bf16_f32 v216, v220, v221
    v_lshlrev_b32_e64 v222, 16, v217
    v_mfma_f32_16x16x32_bf16 a[236:239], a[240:243], v[188:191], a[236:239]
    v_exp_f32_e64 v149, v149
    v_mfma_f32_16x16x32_bf16 v[0:3], a[192:195], v[176:179], v[0:3]
    ds_read_b128 a[160:163], v240 offset:57344
    v_and_b32 v223, 0xffff0000, v217
    v_mul_f32 v222, s47, v222
    v_mfma_f32_16x16x32_bf16 v[4:7], a[192:195], v[180:183], v[4:7]
    s_waitcnt lgkmcnt(15)
    v_exp_f32_e64 v150, v150
    v_mfma_f32_16x16x32_bf16 v[8:11], a[192:195], v[184:187], v[8:11]
    ds_read_b128 a[164:167], v240 offset:58368
    v_mul_f32 v223, s47, v223
    v_cvt_pk_bf16_f32 v217, v222, v223
    v_mfma_f32_16x16x32_bf16 v[12:15], a[192:195], v[188:191], v[12:15]
    v_exp_f32 v151, v151
    v_mfma_f32_16x16x32_bf16 v[16:19], a[196:199], v[176:179], v[16:19]
    ds_read_b128 a[168:171], v240 offset:59392
    v_lshlrev_b32_e64 v224, 16, v218
    v_and_b32 v225, 0xffff0000, v218
    v_mfma_f32_16x16x32_bf16 v[20:23], a[196:199], v[180:183], v[20:23]
    s_waitcnt lgkmcnt(15)
    v_exp_f32 v136, v136
    v_mfma_f32_16x16x32_bf16 v[24:27], a[196:199], v[184:187], v[24:27]
    ds_read_b128 a[172:175], v240 offset:60416
    v_mul_f32 v224, s47, v224
    v_mfma_f32_16x16x32_bf16 v[28:31], a[196:199], v[188:191], v[28:31]
    v_exp_f32 v137, v137
    v_mfma_f32_16x16x32_bf16 v[32:35], a[200:203], v[176:179], v[32:35]
    ds_read_b128 a[176:179], v240 offset:61440
    v_mul_f32 v225, s47, v225
    v_cvt_pk_bf16_f32 v218, v224, v225
    v_mfma_f32_16x16x32_bf16 v[36:39], a[200:203], v[180:183], v[36:39]
    s_waitcnt lgkmcnt(15)
    v_exp_f32 v138, v138
    v_lshlrev_b32 v226, 16, v219
    v_mfma_f32_16x16x32_bf16 v[40:43], a[200:203], v[184:187], v[40:43]
    ds_read_b128 a[180:183], v240 offset:62464
    v_and_b32 v227, 0xffff0000, v219
    v_mfma_f32_16x16x32_bf16 v[44:47], a[200:203], v[188:191], v[44:47]
    v_exp_f32 v139, v139
    v_mul_f32 v226, s47, v226
    v_mfma_f32_16x16x32_bf16 v[48:51], a[204:207], v[176:179], v[48:51]
    ds_read_b128 a[184:187], v240 offset:63488
    v_mul_f32 v227, s47, v227
    v_mfma_f32_16x16x32_bf16 v[52:55], a[204:207], v[180:183], v[52:55]
    s_waitcnt lgkmcnt(15)
    v_exp_f32_e64 v152, v152
    v_cvt_pk_bf16_f32 v219, v226, v227
    v_mfma_f32_16x16x32_bf16 v[56:59], a[204:207], v[184:187], v[56:59]
    ds_write_b128 v249, v[216:219] offset:8192
    v_cvt_pk_bf16_f32 v160, v128, v129
    v_mfma_f32_16x16x32_bf16 v[60:63], a[204:207], v[188:191], v[60:63]
    s_waitcnt lgkmcnt(10)
    v_exp_f32 v153, v153
    v_mfma_f32_16x16x32_bf16 v[64:67], a[208:211], v[176:179], v[64:67]
    ds_read_b128 a[188:191], v240 offset:64512
    v_lshlrev_b32_e64 v232, 16, v228
    v_and_b32 v233, 0xffff0000, v228
    v_mfma_f32_16x16x32_bf16 v[68:71], a[208:211], v[180:183], v[68:71]
    s_waitcnt lgkmcnt(15)
    v_exp_f32 v154, v154
    v_mfma_f32_16x16x32_bf16 v[72:75], a[208:211], v[184:187], v[72:75]
    v_mul_f32 v232, s47, v232
    v_mul_f32 v233, s47, v233
    v_cvt_pk_bf16_f32 v228, v232, v233
    v_mfma_f32_16x16x32_bf16 v[76:79], a[208:211], v[188:191], v[76:79]
    v_exp_f32_e64 v155, v155
    v_mfma_f32_16x16x32_bf16 v[80:83], a[212:215], v[176:179], v[80:83]
    v_lshlrev_b32_e64 v234, 16, v229
    v_and_b32 v235, 0xffff0000, v229
    v_mul_f32 v234, s47, v234
    v_mfma_f32_16x16x32_bf16 v[84:87], a[212:215], v[180:183], v[84:87]
    s_waitcnt lgkmcnt(15)
    v_exp_f32_e64 v140, v140
    v_mfma_f32_16x16x32_bf16 v[88:91], a[212:215], v[184:187], v[88:91]
    v_mul_f32 v235, s47, v235
    v_cvt_pk_bf16_f32 v229, v234, v235
    v_lshlrev_b32 v236, 16, v230
    v_mfma_f32_16x16x32_bf16 v[92:95], a[212:215], v[188:191], v[92:95]
    v_exp_f32_e64 v141, v141
    v_mfma_f32_16x16x32_bf16 v[96:99], a[216:219], v[176:179], v[96:99]
    v_and_b32 v237, 0xffff0000, v230
    v_mul_f32 v236, s47, v236
    v_mul_f32 v237, s47, v237
    v_mfma_f32_16x16x32_bf16 v[100:103], a[216:219], v[180:183], v[100:103]
    s_waitcnt lgkmcnt(9)
    v_exp_f32 v142, v142
    v_mfma_f32_16x16x32_bf16 v[104:107], a[216:219], v[184:187], v[104:107]
    v_cvt_pk_bf16_f32 v230, v236, v237
    v_cvt_pk_bf16_f32 v161, v130, v131
    v_lshlrev_b32_e64 v238, 16, v231
    v_mfma_f32_16x16x32_bf16 v[108:111], a[216:219], v[188:191], v[108:111]
    v_exp_f32_e64 v143, v143
    v_mfma_f32_16x16x32_bf16 v[112:115], a[220:223], v[176:179], v[112:115]
    v_and_b32 v239, 0xffff0000, v231
    v_mul_f32 v238, s47, v238
    v_mul_f32 v239, s47, v239
    v_mfma_f32_16x16x32_bf16 v[116:119], a[220:223], v[180:183], v[116:119]
    s_waitcnt lgkmcnt(5)
    v_exp_f32 v156, v156
    v_mfma_f32_16x16x32_bf16 v[120:123], a[220:223], v[184:187], v[120:123]
    v_cvt_pk_bf16_f32 v162, v144, v145
    v_cvt_pk_bf16_f32 v163, v146, v147
    v_mfma_f32_16x16x32_bf16 v[124:127], a[220:223], v[188:191], v[124:127]
    v_exp_f32_e64 v157, v157
    v_mfma_f32_16x16x32_bf16 v[128:131], a[160:163], a[0:3], v[192:195]
    v_cvt_pk_bf16_f32 v231, v238, v239
    v_cvt_pk_bf16_f32 v164, v132, v133
    v_mfma_f32_16x16x32_bf16 v[128:131], a[164:167], a[4:7], v[128:131]
    s_waitcnt lgkmcnt(0)
    v_exp_f32 v158, v158
    v_mfma_f32_16x16x32_bf16 v[128:131], a[168:171], a[8:11], v[128:131]
    ds_write_b128 v249, v[228:231] offset:9216
    v_cvt_pk_bf16_f32 v165, v134, v135
    v_mfma_f32_16x16x32_bf16 v[128:131], a[172:175], a[12:15], v[128:131]
    v_exp_f32_e64 v159, v159
    v_mfma_f32_16x16x32_bf16 v[144:147], a[176:179], a[0:3], v[192:195]
    v_cvt_pk_bf16_f32 v166, v148, v149
    v_cvt_pk_bf16_f32 v167, v150, v151
    v_mfma_f32_16x16x32_bf16 v[144:147], a[180:183], a[4:7], v[144:147]
    v_cvt_pk_bf16_f32 v168, v136, v137
    v_cvt_pk_bf16_f32 v169, v138, v139
    v_mfma_f32_16x16x32_bf16 v[144:147], a[184:187], a[8:11], v[144:147]
    v_exp_f32_e64 v128, v128
    v_mfma_f32_16x16x32_bf16 v[144:147], a[188:191], a[12:15], v[144:147]
    v_cvt_pk_bf16_f32 v170, v152, v153
    v_cvt_pk_bf16_f32 v171, v154, v155
    v_mfma_f32_16x16x32_bf16 v[132:135], a[160:163], a[16:19], v[196:199]
    s_waitcnt vmcnt(5)
    v_exp_f32 v129, v129
    v_mfma_f32_16x16x32_bf16 v[132:135], a[164:167], a[20:23], v[132:135]
    s_waitcnt lgkmcnt(0)
    v_cvt_pk_bf16_f32 v172, v140, v141
    v_cvt_pk_bf16_f32 v173, v142, v143
    v_mfma_f32_16x16x32_bf16 v[132:135], a[168:171], a[24:27], v[132:135]
    v_exp_f32 v130, v130
    v_mfma_f32_16x16x32_bf16 v[132:135], a[172:175], a[28:31], v[132:135]
    s_barrier
    v_cvt_pk_bf16_f32 v174, v156, v157
    v_mfma_f32_16x16x32_bf16 v[148:151], a[176:179], a[16:19], v[196:199]
    s_add_u32 s77, s75, 114688
    v_exp_f32 v131, v131
    v_mfma_f32_16x16x32_bf16 v[148:151], a[180:183], a[20:23], v[148:151]
    buffer_load_dwordx4 v247, s[20:23], s39 offen offset:0 lds
    v_cvt_pk_bf16_f32 v175, v158, v159
    s_waitcnt vmcnt(63)
    v_mfma_f32_16x16x32_bf16 v[148:151], a[184:187], a[24:27], v[148:151]
    v_exp_f32 v144, v144
    v_mfma_f32_16x16x32_bf16 v[148:151], a[188:191], a[28:31], v[148:151]
    buffer_load_dwordx4 v247, s[20:23], s39 offen offset:1024 lds
    v_cvt_pk_bf16_f32 v176, v128, v129
    v_mfma_f32_16x16x32_bf16 v[136:139], a[160:163], a[32:35], v[200:203]
    s_add_u32 m0, s40, 8192
    v_exp_f32_e64 v145, v145
    v_mfma_f32_16x16x32_bf16 v[136:139], a[164:167], a[36:39], v[136:139]
    buffer_load_dwordx4 v247, s[20:23], s51 offen offset:0 lds
    v_cvt_pk_bf16_f32 v177, v130, v131
    v_mfma_f32_16x16x32_bf16 v[136:139], a[168:171], a[40:43], v[136:139]
    s_add_u32 s39, s38, 81920
    v_exp_f32_e64 v146, v146
    v_mfma_f32_16x16x32_bf16 v[136:139], a[172:175], a[44:47], v[136:139]
    buffer_load_dwordx4 v247, s[20:23], s51 offen offset:1024 lds
    v_cvt_pk_bf16_f32 v178, v144, v145
    v_mfma_f32_16x16x32_bf16 v[152:155], a[176:179], a[32:35], v[200:203]
    s_add_u32 m0, s73, 114688
    v_exp_f32_e64 v147, v147
    v_mfma_f32_16x16x32_bf16 v[152:155], a[180:183], a[36:39], v[152:155]
    ds_read_b64_tr_b16 a[192:193], v242 offset:16384
    v_cvt_pk_bf16_f32 v179, v146, v147
    v_mfma_f32_16x16x32_bf16 v[152:155], a[184:187], a[40:43], v[152:155]
    s_add_u32 s51, s38, 90112
    v_exp_f32_e64 v132, v132
    v_mfma_f32_16x16x32_bf16 v[152:155], a[188:191], a[44:47], v[152:155]
    buffer_load_dwordx4 a[64:67], v246, s[12:15], s30 offen offset:0
    v_mfma_f32_16x16x32_bf16 v[140:143], a[160:163], a[48:51], v[204:207]
    v_exp_f32_e64 v133, v133
    v_mfma_f32_16x16x32_bf16 v[140:143], a[164:167], a[52:55], v[140:143]
    ds_read_b64_tr_b16 a[194:195], v242 offset:20480
    v_cvt_pk_bf16_f32 v180, v132, v133
    v_mfma_f32_16x16x32_bf16 v[140:143], a[168:171], a[56:59], v[140:143]
    v_exp_f32_e64 v134, v134
    v_mfma_f32_16x16x32_bf16 v[140:143], a[172:175], a[60:63], v[140:143]
    ds_read_b64_tr_b16 a[196:197], v242 offset:16392
    v_mfma_f32_16x16x32_bf16 v[156:159], a[176:179], a[48:51], v[204:207]
    v_exp_f32_e64 v135, v135
    v_mfma_f32_16x16x32_bf16 v[156:159], a[180:183], a[52:55], v[156:159]
    ds_read_b64_tr_b16 a[198:199], v242 offset:20488
    v_cvt_pk_bf16_f32 v181, v134, v135
    v_mfma_f32_16x16x32_bf16 v[156:159], a[184:187], a[56:59], v[156:159]
    v_exp_f32_e64 v148, v148
    v_mfma_f32_16x16x32_bf16 v[156:159], a[188:191], a[60:63], v[156:159]
    buffer_load_dwordx4 v252, s[16:19], s74 offen lds
    v_mfma_f32_16x16x32_bf16 a[224:227], a[240:243], v[160:163], a[224:227]
    s_add_u32 m0, s73, 115712
    v_exp_f32_e64 v149, v149
    v_mfma_f32_16x16x32_bf16 a[228:231], a[240:243], v[164:167], a[228:231]
    ds_read_b64_tr_b16 a[200:201], v243 offset:16384
    v_cvt_pk_bf16_f32 v182, v148, v149
    v_mfma_f32_16x16x32_bf16 a[232:235], a[240:243], v[168:171], a[232:235]
    s_waitcnt lgkmcnt(3)
    v_exp_f32 v150, v150
    v_mfma_f32_16x16x32_bf16 a[236:239], a[240:243], v[172:175], a[236:239]
    ds_read_b64_tr_b16 a[202:203], v243 offset:20480
    v_mfma_f32_16x16x32_bf16 v[0:3], a[192:195], v[160:163], v[0:3]
    s_add_u32 s74, s71, 114752
    v_exp_f32_e64 v151, v151
    v_mfma_f32_16x16x32_bf16 v[4:7], a[192:195], v[164:167], v[4:7]
    buffer_load_dwordx4 a[68:71], v246, s[12:15], s30 offen offset:64
    v_cvt_pk_bf16_f32 v183, v150, v151
    v_mfma_f32_16x16x32_bf16 v[8:11], a[192:195], v[168:171], v[8:11]
    s_waitcnt lgkmcnt(2)
    v_exp_f32 v136, v136
    v_mfma_f32_16x16x32_bf16 v[12:15], a[192:195], v[172:175], v[12:15]
    buffer_load_dwordx4 v252, s[16:19], s74 offen lds
    v_mfma_f32_16x16x32_bf16 v[16:19], a[196:199], v[160:163], v[16:19]
    s_add_u32 m0, s73, 122880
    v_exp_f32_e64 v137, v137
    ds_read_b64_tr_b16 a[204:205], v243 offset:16392
    ds_read_b64_tr_b16 a[206:207], v243 offset:20488
    v_mfma_f32_16x16x32_bf16 v[20:23], a[196:199], v[164:167], v[20:23]
    ds_read_b64_tr_b16 a[208:209], v244 offset:16384
    v_cvt_pk_bf16_f32 v184, v136, v137
    v_mfma_f32_16x16x32_bf16 v[24:27], a[196:199], v[168:171], v[24:27]
    s_add_u32 s74, s71, 122880
    v_exp_f32_e64 v138, v138
    v_mfma_f32_16x16x32_bf16 v[28:31], a[196:199], v[172:175], v[28:31]
    ds_read_b64_tr_b16 a[210:211], v244 offset:20480
    s_waitcnt lgkmcnt(4)
    v_mfma_f32_16x16x32_bf16 v[32:35], a[200:203], v[160:163], v[32:35]
    v_exp_f32 v139, v139
    v_mfma_f32_16x16x32_bf16 v[36:39], a[200:203], v[164:167], v[36:39]
    buffer_load_dwordx4 v252, s[16:19], s74 offen lds
    v_cvt_pk_bf16_f32 v185, v138, v139
    v_mfma_f32_16x16x32_bf16 v[40:43], a[200:203], v[168:171], v[40:43]
    s_add_u32 m0, s73, 123904
    v_exp_f32_e64 v152, v152
    v_mfma_f32_16x16x32_bf16 v[44:47], a[200:203], v[172:175], v[44:47]
    ds_read_b64_tr_b16 a[212:213], v244 offset:16392
    s_waitcnt lgkmcnt(3)
    v_mfma_f32_16x16x32_bf16 v[48:51], a[204:207], v[160:163], v[48:51]
    s_add_u32 s74, s71, 122944
    v_exp_f32 v153, v153
    ds_read_b64_tr_b16 a[214:215], v244 offset:20488
    ds_read_b128 v[216:219], v249 offset:16384
    v_mfma_f32_16x16x32_bf16 v[52:55], a[204:207], v[164:167], v[52:55]
    buffer_load_dwordx4 a[72:75], v246, s[12:15], s30 offen offset:128
    v_cvt_pk_bf16_f32 v186, v152, v153
    v_mfma_f32_16x16x32_bf16 v[56:59], a[204:207], v[168:171], v[56:59]
    s_waitcnt lgkmcnt(3)
    v_exp_f32 v154, v154
    v_mfma_f32_16x16x32_bf16 v[60:63], a[204:207], v[172:175], v[60:63]
    buffer_load_dwordx4 v252, s[16:19], s74 offen lds
    v_mfma_f32_16x16x32_bf16 v[64:67], a[208:211], v[160:163], v[64:67]
    s_add_u32 m0, s40, 16384
    v_exp_f32_e64 v155, v155
    ds_read_b64_tr_b16 a[216:217], v245 offset:16384
    ds_read_b64_tr_b16 a[218:219], v245 offset:20480
    v_mfma_f32_16x16x32_bf16 v[68:71], a[208:211], v[164:167], v[68:71]
    buffer_load_dword v250, v253, s[20:23], s77 offen
    v_cvt_pk_bf16_f32 v187, v154, v155
    v_mfma_f32_16x16x32_bf16 v[72:75], a[208:211], v[168:171], v[72:75]
    v_exp_f32_e64 v140, v140
    v_mfma_f32_16x16x32_bf16 v[76:79], a[208:211], v[172:175], v[76:79]
    ds_read_b64_tr_b16 a[220:221], v245 offset:16392
    s_waitcnt lgkmcnt(4)
    s_waitcnt lgkmcnt(3)
    v_mfma_f32_16x16x32_bf16 v[80:83], a[212:215], v[160:163], v[80:83]
    v_exp_f32_e64 v141, v141
    ds_read_b64_tr_b16 a[222:223], v245 offset:20488
    v_lshlrev_b32_e64 v220, 16, v216
    v_mfma_f32_16x16x32_bf16 v[84:87], a[212:215], v[164:167], v[84:87]
    buffer_load_dwordx4 a[76:79], v246, s[12:15], s30 offen offset:192
    v_and_b32 v221, 0xffff0000, v216
    v_mul_f32 v220, s47, v220
    v_mfma_f32_16x16x32_bf16 v[88:91], a[212:215], v[168:171], v[88:91]
    s_add_u32 s45, s44, 0
    s_lshl_b32 s46, s45, 8
    s_add_u32 s46, s46, s41
    s_cmp_lt_u32 s45, 992
    s_cselect_b32 s30, s46, s50
    v_exp_f32 v142, v142
    v_mfma_f32_16x16x32_bf16 v[92:95], a[212:215], v[172:175], v[92:95]
    ds_read_b128 a[128:131], v241 offset:0
    v_mul_f32 v221, s47, v221
    v_cvt_pk_bf16_f32 v216, v220, v221
    s_waitcnt lgkmcnt(3)
    v_mfma_f32_16x16x32_bf16 v[96:99], a[216:219], v[160:163], v[96:99]
    v_exp_f32_e64 v143, v143
    ds_read_b128 a[132:135], v241 offset:1024
    ds_read_b128 a[136:139], v241 offset:2048
    ds_read_b128 a[140:143], v241 offset:3072
    v_mfma_f32_16x16x32_bf16 v[100:103], a[216:219], v[164:167], v[100:103]
    ds_read_b128 a[144:147], v241 offset:4096
    v_lshlrev_b32_e64 v222, 16, v217
    v_and_b32 v223, 0xffff0000, v217
    v_mfma_f32_16x16x32_bf16 v[104:107], a[216:219], v[168:171], v[104:107]
    v_exp_f32_e64 v156, v156
    v_mfma_f32_16x16x32_bf16 v[108:111], a[216:219], v[172:175], v[108:111]
    ds_read_b128 a[148:151], v241 offset:5120
    v_mul_f32 v222, s47, v222
    v_mul_f32 v223, s47, v223
    s_waitcnt lgkmcnt(6)
    v_mfma_f32_16x16x32_bf16 v[112:115], a[220:223], v[160:163], v[112:115]
    v_exp_f32 v157, v157
    ds_read_b128 a[152:155], v241 offset:6144
    ds_read_b128 a[156:159], v241 offset:7168
    v_mfma_f32_16x16x32_bf16 v[116:119], a[220:223], v[164:167], v[116:119]
    ds_read_b128 v[228:231], v249 offset:17408
    v_cvt_pk_bf16_f32 v217, v222, v223
    v_lshlrev_b32_e64 v224, 16, v218
    v_mfma_f32_16x16x32_bf16 v[120:123], a[220:223], v[168:171], v[120:123]
    v_exp_f32_e64 v158, v158
    v_mfma_f32_16x16x32_bf16 v[124:127], a[220:223], v[172:175], v[124:127]
    buffer_load_dwordx4 a[80:83], v246, s[12:15], s31 offen offset:0
    v_and_b32 v225, 0xffff0000, v218
    v_mul_f32 v224, s47, v224
    s_waitcnt lgkmcnt(5)
    v_mfma_f32_16x16x32_bf16 v[128:131], a[128:131], a[0:3], v[192:195]
    v_exp_f32_e64 v159, v159
    v_mfma_f32_16x16x32_bf16 v[128:131], a[132:135], a[4:7], v[128:131]
    ds_read_b64_tr_b16 a[192:193], v242 offset:24576
    v_mul_f32 v225, s47, v225
    v_cvt_pk_bf16_f32 v218, v224, v225
    v_mfma_f32_16x16x32_bf16 v[128:131], a[136:139], a[8:11], v[128:131]
    ds_read_b64_tr_b16 a[194:195], v242 offset:28672
    v_lshlrev_b32 v226, 16, v219
    v_mfma_f32_16x16x32_bf16 v[128:131], a[140:143], a[12:15], v[128:131]
    ds_read_b64_tr_b16 a[196:197], v242 offset:24584
    v_and_b32 v227, 0xffff0000, v219
    s_waitcnt lgkmcnt(4)
    v_mfma_f32_16x16x32_bf16 v[144:147], a[144:147], a[0:3], v[192:195]
    ds_read_b64_tr_b16 a[198:199], v242 offset:28680
    v_mul_f32 v226, s47, v226
    v_mfma_f32_16x16x32_bf16 v[144:147], a[148:151], a[4:7], v[144:147]
    ds_read_b64_tr_b16 a[200:201], v243 offset:24576
    v_mul_f32 v227, s47, v227
    v_mfma_f32_16x16x32_bf16 v[144:147], a[152:155], a[8:11], v[144:147]
    v_exp_f32 v128, v128
    v_cvt_pk_bf16_f32 v219, v226, v227
    v_mfma_f32_16x16x32_bf16 v[144:147], a[156:159], a[12:15], v[144:147]
    ds_write_b128 v249, v[216:219] offset:16384
    v_cvt_pk_bf16_f32 v188, v140, v141
    v_mfma_f32_16x16x32_bf16 v[132:135], a[128:131], a[16:19], v[196:199]
    s_waitcnt lgkmcnt(6)
    v_exp_f32 v129, v129
    v_mfma_f32_16x16x32_bf16 v[132:135], a[132:135], a[20:23], v[132:135]
    ds_read_b128 v[216:219], v249 offset:24576
    v_lshlrev_b32_e64 v232, 16, v228
    v_and_b32 v233, 0xffff0000, v228
    v_mfma_f32_16x16x32_bf16 v[132:135], a[136:139], a[24:27], v[132:135]
    v_exp_f32_e64 v130, v130
    v_mfma_f32_16x16x32_bf16 v[132:135], a[140:143], a[28:31], v[132:135]
    buffer_load_dwordx4 a[84:87], v246, s[12:15], s31 offen offset:64
    v_mul_f32 v232, s47, v232
    v_mul_f32 v233, s47, v233
    v_mfma_f32_16x16x32_bf16 v[148:151], a[144:147], a[16:19], v[196:199]
    v_exp_f32_e64 v131, v131
    v_mfma_f32_16x16x32_bf16 v[148:151], a[148:151], a[20:23], v[148:151]
    ds_read_b64_tr_b16 a[202:203], v243 offset:28672
    v_cvt_pk_bf16_f32 v228, v232, v233
    v_lshlrev_b32_e64 v234, 16, v229
    v_mfma_f32_16x16x32_bf16 v[148:151], a[152:155], a[24:27], v[148:151]
    v_exp_f32_e64 v144, v144
    v_mfma_f32_16x16x32_bf16 v[148:151], a[156:159], a[28:31], v[148:151]
    ds_read_b64_tr_b16 a[204:205], v243 offset:24584
    v_and_b32 v235, 0xffff0000, v229
    v_mul_f32 v234, s47, v234
    v_mfma_f32_16x16x32_bf16 v[136:139], a[128:131], a[32:35], v[200:203]
    v_exp_f32 v145, v145
    v_mfma_f32_16x16x32_bf16 v[136:139], a[132:135], a[36:39], v[136:139]
    ds_read_b64_tr_b16 a[206:207], v243 offset:28680
    v_mul_f32 v235, s47, v235
    v_cvt_pk_bf16_f32 v229, v234, v235
    v_mfma_f32_16x16x32_bf16 v[136:139], a[136:139], a[40:43], v[136:139]
    v_exp_f32 v146, v146
    v_mfma_f32_16x16x32_bf16 v[136:139], a[140:143], a[44:47], v[136:139]
    ds_read_b64_tr_b16 a[208:209], v244 offset:24576
    v_lshlrev_b32_e64 v236, 16, v230
    v_and_b32 v237, 0xffff0000, v230
    v_mfma_f32_16x16x32_bf16 v[152:155], a[144:147], a[32:35], v[200:203]
    v_exp_f32_e64 v147, v147
    v_mfma_f32_16x16x32_bf16 v[152:155], a[148:151], a[36:39], v[152:155]
    ds_read_b64_tr_b16 a[210:211], v244 offset:28672
    v_mul_f32 v236, s47, v236
    v_mul_f32 v237, s47, v237
    v_mfma_f32_16x16x32_bf16 v[152:155], a[152:155], a[40:43], v[152:155]
    v_exp_f32_e64 v132, v132
    v_mfma_f32_16x16x32_bf16 v[152:155], a[156:159], a[44:47], v[152:155]
    ds_read_b64_tr_b16 a[212:213], v244 offset:24584
    v_cvt_pk_bf16_f32 v189, v142, v143
    v_cvt_pk_bf16_f32 v230, v236, v237
    v_mfma_f32_16x16x32_bf16 v[140:143], a[128:131], a[48:51], v[204:207]
    v_exp_f32 v133, v133
    v_lshlrev_b32 v238, 16, v231
    v_mfma_f32_16x16x32_bf16 v[140:143], a[132:135], a[52:55], v[140:143]
    ds_read_b64_tr_b16 a[214:215], v244 offset:28680
    v_and_b32 v239, 0xffff0000, v231
    v_mul_f32 v238, s47, v238
    v_mfma_f32_16x16x32_bf16 v[140:143], a[136:139], a[56:59], v[140:143]
    v_exp_f32 v134, v134
    v_mfma_f32_16x16x32_bf16 v[140:143], a[140:143], a[60:63], v[140:143]
    ds_read_b64_tr_b16 a[216:217], v245 offset:24576
    v_cvt_pk_bf16_f32 v190, v156, v157
    v_cvt_pk_bf16_f32 v191, v158, v159
    v_mul_f32 v239, s47, v239
    v_mfma_f32_16x16x32_bf16 v[156:159], a[144:147], a[48:51], v[204:207]
    s_waitcnt lgkmcnt(8)
    v_exp_f32_e64 v135, v135
    v_cvt_pk_bf16_f32 v231, v238, v239
    v_mfma_f32_16x16x32_bf16 v[156:159], a[148:151], a[52:55], v[156:159]
    ds_write_b128 v249, v[228:231] offset:17408
    v_lshlrev_b32_e64 v220, 16, v216
    v_and_b32 v221, 0xffff0000, v216
    v_mfma_f32_16x16x32_bf16 v[156:159], a[152:155], a[56:59], v[156:159]
    v_exp_f32_e64 v148, v148
    v_mfma_f32_16x16x32_bf16 v[156:159], a[156:159], a[60:63], v[156:159]
    ds_read_b128 v[228:231], v249 offset:25600
    v_mul_f32 v220, s47, v220
    v_mul_f32 v221, s47, v221
    v_mfma_f32_16x16x32_bf16 a[224:227], a[240:243], v[176:179], a[224:227]
    v_exp_f32_e64 v149, v149
    v_mfma_f32_16x16x32_bf16 a[228:231], a[240:243], v[180:183], a[228:231]
    ds_read_b64_tr_b16 a[218:219], v245 offset:28672
    v_cvt_pk_bf16_f32 v216, v220, v221
    v_lshlrev_b32_e64 v222, 16, v217
    v_mfma_f32_16x16x32_bf16 a[232:235], a[240:243], v[184:187], a[232:235]
    s_waitcnt lgkmcnt(15)
    v_exp_f32 v150, v150
    v_mfma_f32_16x16x32_bf16 a[236:239], a[240:243], v[188:191], a[236:239]
    ds_read_b64_tr_b16 a[220:221], v245 offset:24584
    v_and_b32 v223, 0xffff0000, v217
    v_mul_f32 v222, s47, v222
    v_mfma_f32_16x16x32_bf16 v[0:3], a[192:195], v[176:179], v[0:3]
    v_exp_f32 v151, v151
    v_mfma_f32_16x16x32_bf16 v[4:7], a[192:195], v[180:183], v[4:7]
    ds_read_b64_tr_b16 a[222:223], v245 offset:28680
    v_mul_f32 v223, s47, v223
    v_cvt_pk_bf16_f32 v217, v222, v223
    v_mfma_f32_16x16x32_bf16 v[8:11], a[192:195], v[184:187], v[8:11]
    s_waitcnt lgkmcnt(15)
    v_exp_f32_e64 v136, v136
    v_mfma_f32_16x16x32_bf16 v[12:15], a[192:195], v[188:191], v[12:15]
    ds_read_b128 a[160:163], v241 offset:8192
    v_lshlrev_b32_e64 v224, 16, v218
    v_and_b32 v225, 0xffff0000, v218
    v_mfma_f32_16x16x32_bf16 v[16:19], a[196:199], v[176:179], v[16:19]
    v_exp_f32_e64 v137, v137
    v_mfma_f32_16x16x32_bf16 v[20:23], a[196:199], v[180:183], v[20:23]
    ds_read_b128 a[164:167], v241 offset:9216
    v_mul_f32 v224, s47, v224
    v_mfma_f32_16x16x32_bf16 v[24:27], a[196:199], v[184:187], v[24:27]
    s_waitcnt lgkmcnt(14)
    v_exp_f32_e64 v138, v138
    v_mfma_f32_16x16x32_bf16 v[28:31], a[196:199], v[188:191], v[28:31]
    ds_read_b128 a[168:171], v241 offset:10240
    v_mul_f32 v225, s47, v225
    v_mfma_f32_16x16x32_bf16 v[32:35], a[200:203], v[176:179], v[32:35]
    v_exp_f32 v139, v139
    v_cvt_pk_bf16_f32 v218, v224, v225
    v_mfma_f32_16x16x32_bf16 v[36:39], a[200:203], v[180:183], v[36:39]
    ds_read_b128 a[172:175], v241 offset:11264
    v_lshlrev_b32_e64 v226, 16, v219
    v_mfma_f32_16x16x32_bf16 v[40:43], a[200:203], v[184:187], v[40:43]
    s_waitcnt lgkmcnt(14)
    v_exp_f32 v152, v152
    v_and_b32 v227, 0xffff0000, v219
    v_mfma_f32_16x16x32_bf16 v[44:47], a[200:203], v[188:191], v[44:47]
    ds_read_b128 a[176:179], v241 offset:12288
    v_mul_f32 v226, s47, v226
    v_mfma_f32_16x16x32_bf16 v[48:51], a[204:207], v[176:179], v[48:51]
    v_exp_f32 v153, v153
    v_mul_f32 v227, s47, v227
    v_mfma_f32_16x16x32_bf16 v[52:55], a[204:207], v[180:183], v[52:55]
    ds_read_b128 a[180:183], v241 offset:13312
    v_cvt_pk_bf16_f32 v219, v226, v227
    v_mfma_f32_16x16x32_bf16 v[56:59], a[204:207], v[184:187], v[56:59]
    s_waitcnt lgkmcnt(14)
    v_exp_f32_e64 v154, v154
    ds_write_b128 v249, v[216:219] offset:24576
    v_mfma_f32_16x16x32_bf16 v[60:63], a[204:207], v[188:191], v[60:63]
    ds_read_b128 a[184:187], v241 offset:14336
    v_cvt_pk_bf16_f32 v160, v128, v129
    v_mfma_f32_16x16x32_bf16 v[64:67], a[208:211], v[176:179], v[64:67]
    s_waitcnt lgkmcnt(11)
    v_exp_f32 v155, v155
    v_mfma_f32_16x16x32_bf16 v[68:71], a[208:211], v[180:183], v[68:71]
    ds_read_b128 a[188:191], v241 offset:15360
    v_lshlrev_b32_e64 v232, 16, v228
    v_and_b32 v233, 0xffff0000, v228
    v_mfma_f32_16x16x32_bf16 v[72:75], a[208:211], v[184:187], v[72:75]
    s_waitcnt lgkmcnt(15)
    v_exp_f32 v140, v140
    v_mfma_f32_16x16x32_bf16 v[76:79], a[208:211], v[188:191], v[76:79]
    v_mul_f32 v232, s47, v232
    v_mul_f32 v233, s47, v233
    v_cvt_pk_bf16_f32 v228, v232, v233
    v_mfma_f32_16x16x32_bf16 v[80:83], a[212:215], v[176:179], v[80:83]
    v_exp_f32_e64 v141, v141
    v_mfma_f32_16x16x32_bf16 v[84:87], a[212:215], v[180:183], v[84:87]
    s_waitcnt lgkmcnt(11)
    v_lshlrev_b32 v234, 16, v229
    v_and_b32 v235, 0xffff0000, v229
    v_mul_f32 v234, s47, v234
    v_mfma_f32_16x16x32_bf16 v[88:91], a[212:215], v[184:187], v[88:91]
    v_exp_f32 v142, v142
    v_mfma_f32_16x16x32_bf16 v[92:95], a[212:215], v[188:191], v[92:95]
    v_mul_f32 v235, s47, v235
    v_cvt_pk_bf16_f32 v229, v234, v235
    v_lshlrev_b32 v236, 16, v230
    v_mfma_f32_16x16x32_bf16 v[96:99], a[216:219], v[176:179], v[96:99]
    v_exp_f32_e64 v143, v143
    v_mfma_f32_16x16x32_bf16 v[100:103], a[216:219], v[180:183], v[100:103]
    s_waitcnt lgkmcnt(9)
    v_and_b32 v237, 0xffff0000, v230
    v_mul_f32 v236, s47, v236
    v_mul_f32 v237, s47, v237
    v_mfma_f32_16x16x32_bf16 v[104:107], a[216:219], v[184:187], v[104:107]
    v_exp_f32 v156, v156
    v_mfma_f32_16x16x32_bf16 v[108:111], a[216:219], v[188:191], v[108:111]
    v_cvt_pk_bf16_f32 v230, v236, v237
    v_cvt_pk_bf16_f32 v161, v130, v131
    v_lshlrev_b32_e64 v238, 16, v231
    v_mfma_f32_16x16x32_bf16 v[112:115], a[220:223], v[176:179], v[112:115]
    v_exp_f32_e64 v157, v157
    v_mfma_f32_16x16x32_bf16 v[116:119], a[220:223], v[180:183], v[116:119]
    s_waitcnt lgkmcnt(5)
    v_and_b32 v239, 0xffff0000, v231
    v_mul_f32 v238, s47, v238
    v_mul_f32 v239, s47, v239
    v_mfma_f32_16x16x32_bf16 v[120:123], a[220:223], v[184:187], v[120:123]
    v_exp_f32 v158, v158
    v_mfma_f32_16x16x32_bf16 v[124:127], a[220:223], v[188:191], v[124:127]
    v_cvt_pk_bf16_f32 v162, v144, v145
    v_cvt_pk_bf16_f32 v163, v146, v147
    v_cvt_pk_bf16_f32 v231, v238, v239
    v_mfma_f32_16x16x32_bf16 v[128:131], a[160:163], a[0:3], v[192:195]
    v_exp_f32_e64 v159, v159
    v_mfma_f32_16x16x32_bf16 v[128:131], a[164:167], a[4:7], v[128:131]
    ds_write_b128 v249, v[228:231] offset:25600
    v_cvt_pk_bf16_f32 v164, v132, v133
    v_mfma_f32_16x16x32_bf16 v[128:131], a[168:171], a[8:11], v[128:131]
    s_waitcnt lgkmcnt(1)
    v_cvt_pk_bf16_f32 v165, v134, v135
    v_cvt_pk_bf16_f32 v166, v148, v149
    v_mfma_f32_16x16x32_bf16 v[128:131], a[172:175], a[12:15], v[128:131]
    v_cvt_pk_bf16_f32 v167, v150, v151
    v_cvt_pk_bf16_f32 v168, v136, v137
    v_mfma_f32_16x16x32_bf16 v[144:147], a[176:179], a[0:3], v[192:195]
    v_cvt_pk_bf16_f32 v169, v138, v139
    v_cvt_pk_bf16_f32 v170, v152, v153
    v_mfma_f32_16x16x32_bf16 v[144:147], a[180:183], a[4:7], v[144:147]
    v_cvt_pk_bf16_f32 v171, v154, v155
    v_cvt_pk_bf16_f32 v172, v140, v141
    v_mfma_f32_16x16x32_bf16 v[144:147], a[184:187], a[8:11], v[144:147]
    v_exp_f32 v128, v128
    v_mfma_f32_16x16x32_bf16 v[144:147], a[188:191], a[12:15], v[144:147]
    v_cvt_pk_bf16_f32 v173, v142, v143
    v_cvt_pk_bf16_f32 v174, v156, v157
    v_mfma_f32_16x16x32_bf16 v[132:135], a[160:163], a[16:19], v[196:199]
    s_waitcnt vmcnt(11)
    v_exp_f32 v129, v129
    v_mfma_f32_16x16x32_bf16 v[132:135], a[164:167], a[20:23], v[132:135]
    s_waitcnt lgkmcnt(0)
    v_cvt_pk_bf16_f32 v175, v158, v159
    v_cvt_pk_bf16_f32 v176, v128, v129
    v_mfma_f32_16x16x32_bf16 v[132:135], a[168:171], a[24:27], v[132:135]
    v_exp_f32 v130, v130
    v_mfma_f32_16x16x32_bf16 v[132:135], a[172:175], a[28:31], v[132:135]
    s_barrier
    v_mfma_f32_16x16x32_bf16 v[148:151], a[176:179], a[16:19], v[196:199]
    v_exp_f32 v131, v131
    v_mfma_f32_16x16x32_bf16 v[148:151], a[180:183], a[20:23], v[148:151]
    buffer_load_dwordx4 v247, s[20:23], s39 offen offset:0 lds
    v_cvt_pk_bf16_f32 v177, v130, v131
    s_waitcnt vmcnt(63)
    v_mfma_f32_16x16x32_bf16 v[148:151], a[184:187], a[24:27], v[148:151]
    v_exp_f32 v144, v144
    v_mfma_f32_16x16x32_bf16 v[148:151], a[188:191], a[28:31], v[148:151]
    buffer_load_dwordx4 v247, s[20:23], s39 offen offset:1024 lds
    v_mfma_f32_16x16x32_bf16 v[136:139], a[160:163], a[32:35], v[200:203]
    s_add_u32 m0, s40, 24576
    v_exp_f32_e64 v145, v145
    v_mfma_f32_16x16x32_bf16 v[136:139], a[164:167], a[36:39], v[136:139]
    buffer_load_dwordx4 v247, s[20:23], s51 offen offset:0 lds
    v_cvt_pk_bf16_f32 v178, v144, v145
    v_mfma_f32_16x16x32_bf16 v[136:139], a[168:171], a[40:43], v[136:139]
    s_add_u32 s39, s38, 98304
    v_exp_f32_e64 v146, v146
    v_mfma_f32_16x16x32_bf16 v[136:139], a[172:175], a[44:47], v[136:139]
    buffer_load_dwordx4 v247, s[20:23], s51 offen offset:1024 lds
    v_mfma_f32_16x16x32_bf16 v[152:155], a[176:179], a[32:35], v[200:203]
    s_add_u32 m0, s40, 0
    v_exp_f32 v147, v147
    v_mfma_f32_16x16x32_bf16 v[152:155], a[180:183], a[36:39], v[152:155]
    ds_read_b64_tr_b16 a[192:193], v242 offset:0
    v_cvt_pk_bf16_f32 v179, v146, v147
    v_mfma_f32_16x16x32_bf16 v[152:155], a[184:187], a[40:43], v[152:155]
    s_add_u32 s51, s38, 106496
    v_exp_f32_e64 v132, v132
    v_mfma_f32_16x16x32_bf16 v[152:155], a[188:191], a[44:47], v[152:155]
    buffer_load_dwordx4 a[88:91], v246, s[12:15], s31 offen offset:128
    v_mfma_f32_16x16x32_bf16 v[140:143], a[160:163], a[48:51], v[204:207]
    v_exp_f32_e64 v133, v133
    v_mfma_f32_16x16x32_bf16 v[140:143], a[164:167], a[52:55], v[140:143]
    ds_read_b64_tr_b16 a[194:195], v242 offset:4096
    v_cvt_pk_bf16_f32 v180, v132, v133
    v_mfma_f32_16x16x32_bf16 v[140:143], a[168:171], a[56:59], v[140:143]
    v_exp_f32_e64 v134, v134
    v_mfma_f32_16x16x32_bf16 v[140:143], a[172:175], a[60:63], v[140:143]
    ds_read_b64_tr_b16 a[196:197], v242 offset:8
    v_mfma_f32_16x16x32_bf16 v[156:159], a[176:179], a[48:51], v[204:207]
    v_exp_f32_e64 v135, v135
    v_mfma_f32_16x16x32_bf16 v[156:159], a[180:183], a[52:55], v[156:159]
    ds_read_b64_tr_b16 a[198:199], v242 offset:4104
    v_cvt_pk_bf16_f32 v181, v134, v135
    v_mfma_f32_16x16x32_bf16 v[156:159], a[184:187], a[56:59], v[156:159]
    v_exp_f32_e64 v148, v148
    v_mfma_f32_16x16x32_bf16 v[156:159], a[188:191], a[60:63], v[156:159]
    ds_read_b64_tr_b16 a[200:201], v243 offset:0
    v_mfma_f32_16x16x32_bf16 a[224:227], a[240:243], v[160:163], a[224:227]
    v_exp_f32_e64 v149, v149
    v_mfma_f32_16x16x32_bf16 a[228:231], a[240:243], v[164:167], a[228:231]
    ds_read_b64_tr_b16 a[202:203], v243 offset:4096
    v_cvt_pk_bf16_f32 v182, v148, v149
    v_mfma_f32_16x16x32_bf16 a[232:235], a[240:243], v[168:171], a[232:235]
    s_waitcnt lgkmcnt(4)
    v_exp_f32 v150, v150
    v_mfma_f32_16x16x32_bf16 a[236:239], a[240:243], v[172:175], a[236:239]
    buffer_load_dwordx4 a[92:95], v246, s[12:15], s31 offen offset:192
    v_mfma_f32_16x16x32_bf16 v[0:3], a[192:195], v[160:163], v[0:3]
    s_add_u32 s45, s44, 16
    s_lshl_b32 s46, s45, 8
    s_add_u32 s46, s46, s41
    s_cmp_lt_u32 s45, 992
    s_cselect_b32 s31, s46, s50
    v_exp_f32_e64 v151, v151
    v_mfma_f32_16x16x32_bf16 v[4:7], a[192:195], v[164:167], v[4:7]
    ds_read_b64_tr_b16 a[204:205], v243 offset:8
    v_cvt_pk_bf16_f32 v183, v150, v151
    v_mfma_f32_16x16x32_bf16 v[8:11], a[192:195], v[168:171], v[8:11]
    s_waitcnt lgkmcnt(3)
    v_exp_f32 v136, v136
    v_mfma_f32_16x16x32_bf16 v[12:15], a[192:195], v[172:175], v[12:15]
    ds_read_b64_tr_b16 a[206:207], v243 offset:4104
    v_mfma_f32_16x16x32_bf16 v[16:19], a[196:199], v[160:163], v[16:19]
    v_exp_f32_e64 v137, v137
    v_mfma_f32_16x16x32_bf16 v[20:23], a[196:199], v[164:167], v[20:23]
    ds_read_b64_tr_b16 a[208:209], v244 offset:0
    v_cvt_pk_bf16_f32 v184, v136, v137
    v_mfma_f32_16x16x32_bf16 v[24:27], a[196:199], v[168:171], v[24:27]
    s_waitcnt lgkmcnt(3)
    v_exp_f32 v138, v138
    v_mfma_f32_16x16x32_bf16 v[28:31], a[196:199], v[172:175], v[28:31]
    ds_read_b64_tr_b16 a[210:211], v244 offset:4096
    v_mfma_f32_16x16x32_bf16 v[32:35], a[200:203], v[160:163], v[32:35]
    v_exp_f32_e64 v139, v139
    v_mfma_f32_16x16x32_bf16 v[36:39], a[200:203], v[164:167], v[36:39]
    ds_read_b64_tr_b16 a[212:213], v244 offset:8
    v_cvt_pk_bf16_f32 v185, v138, v139
    v_mfma_f32_16x16x32_bf16 v[40:43], a[200:203], v[168:171], v[40:43]
    s_waitcnt lgkmcnt(3)
    v_exp_f32 v152, v152
    v_mfma_f32_16x16x32_bf16 v[44:47], a[200:203], v[172:175], v[44:47]
    ds_read_b64_tr_b16 a[214:215], v244 offset:4104
    v_mfma_f32_16x16x32_bf16 v[48:51], a[204:207], v[160:163], v[48:51]
    v_exp_f32_e64 v153, v153
    ds_read_b128 v[216:219], v249 offset:32768
    v_mfma_f32_16x16x32_bf16 v[52:55], a[204:207], v[164:167], v[52:55]
    buffer_load_dwordx4 a[96:99], v246, s[12:15], s32 offen offset:0
    v_cvt_pk_bf16_f32 v186, v152, v153
    v_mfma_f32_16x16x32_bf16 v[56:59], a[204:207], v[168:171], v[56:59]
    s_waitcnt lgkmcnt(3)
    v_exp_f32 v154, v154
    v_mfma_f32_16x16x32_bf16 v[60:63], a[204:207], v[172:175], v[60:63]
    ds_read_b64_tr_b16 a[216:217], v245 offset:0
    v_mfma_f32_16x16x32_bf16 v[64:67], a[208:211], v[160:163], v[64:67]
    v_exp_f32_e64 v155, v155
    ds_read_b64_tr_b16 a[218:219], v245 offset:4096
    v_mfma_f32_16x16x32_bf16 v[68:71], a[208:211], v[164:167], v[68:71]
    ds_read_b64_tr_b16 a[220:221], v245 offset:8
    v_cvt_pk_bf16_f32 v187, v154, v155
    v_mfma_f32_16x16x32_bf16 v[72:75], a[208:211], v[168:171], v[72:75]
    s_waitcnt lgkmcnt(4)
    v_exp_f32 v140, v140
    v_mfma_f32_16x16x32_bf16 v[76:79], a[208:211], v[172:175], v[76:79]
    ds_read_b64_tr_b16 a[222:223], v245 offset:4104
    s_waitcnt lgkmcnt(4)
    v_mfma_f32_16x16x32_bf16 v[80:83], a[212:215], v[160:163], v[80:83]
    v_exp_f32 v141, v141
    v_lshlrev_b32_e64 v220, 16, v216
    v_mfma_f32_16x16x32_bf16 v[84:87], a[212:215], v[164:167], v[84:87]
    buffer_load_dwordx4 a[100:103], v246, s[12:15], s32 offen offset:64
    v_and_b32 v221, 0xffff0000, v216
    v_mul_f32 v220, s47, v220
    v_mfma_f32_16x16x32_bf16 v[88:91], a[212:215], v[168:171], v[88:91]
    v_exp_f32 v142, v142
    v_mfma_f32_16x16x32_bf16 v[92:95], a[212:215], v[172:175], v[92:95]
    ds_read_b128 a[128:131], v241 offset:16384
    v_mul_f32 v221, s47, v221
    v_cvt_pk_bf16_f32 v216, v220, v221
    s_waitcnt lgkmcnt(3)
    v_mfma_f32_16x16x32_bf16 v[96:99], a[216:219], v[160:163], v[96:99]
    v_exp_f32_e64 v143, v143
    ds_read_b128 a[132:135], v241 offset:17408
    ds_read_b128 a[136:139], v241 offset:18432
    ds_read_b128 a[140:143], v241 offset:19456
    v_mfma_f32_16x16x32_bf16 v[100:103], a[216:219], v[164:167], v[100:103]
    ds_read_b128 a[144:147], v241 offset:20480
    v_lshlrev_b32_e64 v222, 16, v217
    v_and_b32 v223, 0xffff0000, v217
    v_mfma_f32_16x16x32_bf16 v[104:107], a[216:219], v[168:171], v[104:107]
    s_waitcnt lgkmcnt(5)
    v_exp_f32 v156, v156
    v_mfma_f32_16x16x32_bf16 v[108:111], a[216:219], v[172:175], v[108:111]
    ds_read_b128 a[148:151], v241 offset:21504
    v_mul_f32 v222, s47, v222
    v_mul_f32 v223, s47, v223
    v_mfma_f32_16x16x32_bf16 v[112:115], a[220:223], v[160:163], v[112:115]
    v_exp_f32_e64 v157, v157
    ds_read_b128 a[152:155], v241 offset:22528
    ds_read_b128 a[156:159], v241 offset:23552
    v_mfma_f32_16x16x32_bf16 v[116:119], a[220:223], v[164:167], v[116:119]
    ds_read_b128 v[228:231], v249 offset:33792
    v_cvt_pk_bf16_f32 v217, v222, v223
    v_lshlrev_b32_e64 v224, 16, v218
    v_mfma_f32_16x16x32_bf16 v[120:123], a[220:223], v[168:171], v[120:123]
    v_exp_f32_e64 v158, v158
    v_mfma_f32_16x16x32_bf16 v[124:127], a[220:223], v[172:175], v[124:127]
    buffer_load_dwordx4 a[104:107], v246, s[12:15], s32 offen offset:128
    v_and_b32 v225, 0xffff0000, v218
    v_mul_f32 v224, s47, v224
    s_waitcnt lgkmcnt(5)
    v_mfma_f32_16x16x32_bf16 v[128:131], a[128:131], a[0:3], v[192:195]
    v_exp_f32_e64 v159, v159
    v_mfma_f32_16x16x32_bf16 v[128:131], a[132:135], a[4:7], v[128:131]
    ds_read_b64_tr_b16 a[192:193], v242 offset:8192
    v_mul_f32 v225, s47, v225
    v_cvt_pk_bf16_f32 v218, v224, v225
    v_mfma_f32_16x16x32_bf16 v[128:131], a[136:139], a[8:11], v[128:131]
    ds_read_b64_tr_b16 a[194:195], v242 offset:12288
    v_lshlrev_b32 v226, 16, v219
    v_mfma_f32_16x16x32_bf16 v[128:131], a[140:143], a[12:15], v[128:131]
    ds_read_b64_tr_b16 a[196:197], v242 offset:8200
    v_and_b32 v227, 0xffff0000, v219
    s_waitcnt lgkmcnt(4)
    v_mfma_f32_16x16x32_bf16 v[144:147], a[144:147], a[0:3], v[192:195]
    ds_read_b64_tr_b16 a[198:199], v242 offset:12296
    v_mul_f32 v226, s47, v226
    v_mfma_f32_16x16x32_bf16 v[144:147], a[148:151], a[4:7], v[144:147]
    ds_read_b64_tr_b16 a[200:201], v243 offset:8192
    v_mul_f32 v227, s47, v227
    v_mfma_f32_16x16x32_bf16 v[144:147], a[152:155], a[8:11], v[144:147]
    v_exp_f32 v128, v128
    v_cvt_pk_bf16_f32 v219, v226, v227
    v_mfma_f32_16x16x32_bf16 v[144:147], a[156:159], a[12:15], v[144:147]
    ds_write_b128 v249, v[216:219] offset:32768
    v_cvt_pk_bf16_f32 v188, v140, v141
    v_mfma_f32_16x16x32_bf16 v[132:135], a[128:131], a[16:19], v[196:199]
    s_waitcnt lgkmcnt(6)
    v_exp_f32 v129, v129
    v_mfma_f32_16x16x32_bf16 v[132:135], a[132:135], a[20:23], v[132:135]
    ds_read_b128 v[216:219], v249 offset:40960
    v_lshlrev_b32_e64 v232, 16, v228
    v_and_b32 v233, 0xffff0000, v228
    v_mfma_f32_16x16x32_bf16 v[132:135], a[136:139], a[24:27], v[132:135]
    v_exp_f32_e64 v130, v130
    v_mfma_f32_16x16x32_bf16 v[132:135], a[140:143], a[28:31], v[132:135]
    buffer_load_dwordx4 a[108:111], v246, s[12:15], s32 offen offset:192
    v_mul_f32 v232, s47, v232
    v_mul_f32 v233, s47, v233
    v_mfma_f32_16x16x32_bf16 v[148:151], a[144:147], a[16:19], v[196:199]
    s_add_u32 s45, s44, 32
    s_lshl_b32 s46, s45, 8
    s_add_u32 s46, s46, s41
    s_cmp_lt_u32 s45, 992
    s_cselect_b32 s32, s46, s50
    v_exp_f32_e64 v131, v131
    v_mfma_f32_16x16x32_bf16 v[148:151], a[148:151], a[20:23], v[148:151]
    ds_read_b64_tr_b16 a[202:203], v243 offset:12288
    v_cvt_pk_bf16_f32 v228, v232, v233
    v_lshlrev_b32_e64 v234, 16, v229
    v_mfma_f32_16x16x32_bf16 v[148:151], a[152:155], a[24:27], v[148:151]
    v_exp_f32_e64 v144, v144
    v_mfma_f32_16x16x32_bf16 v[148:151], a[156:159], a[28:31], v[148:151]
    ds_read_b64_tr_b16 a[204:205], v243 offset:8200
    v_and_b32 v235, 0xffff0000, v229
    v_mul_f32 v234, s47, v234
    v_mfma_f32_16x16x32_bf16 v[136:139], a[128:131], a[32:35], v[200:203]
    v_exp_f32 v145, v145
    v_mfma_f32_16x16x32_bf16 v[136:139], a[132:135], a[36:39], v[136:139]
    ds_read_b64_tr_b16 a[206:207], v243 offset:12296
    v_mul_f32 v235, s47, v235
    v_cvt_pk_bf16_f32 v229, v234, v235
    v_mfma_f32_16x16x32_bf16 v[136:139], a[136:139], a[40:43], v[136:139]
    v_exp_f32 v146, v146
    v_mfma_f32_16x16x32_bf16 v[136:139], a[140:143], a[44:47], v[136:139]
    ds_read_b64_tr_b16 a[208:209], v244 offset:8192
    v_lshlrev_b32_e64 v236, 16, v230
    v_and_b32 v237, 0xffff0000, v230
    v_mfma_f32_16x16x32_bf16 v[152:155], a[144:147], a[32:35], v[200:203]
    v_exp_f32_e64 v147, v147
    v_mfma_f32_16x16x32_bf16 v[152:155], a[148:151], a[36:39], v[152:155]
    ds_read_b64_tr_b16 a[210:211], v244 offset:12288
    v_mul_f32 v236, s47, v236
    v_mul_f32 v237, s47, v237
    v_mfma_f32_16x16x32_bf16 v[152:155], a[152:155], a[40:43], v[152:155]
    v_exp_f32_e64 v132, v132
    v_mfma_f32_16x16x32_bf16 v[152:155], a[156:159], a[44:47], v[152:155]
    ds_read_b64_tr_b16 a[212:213], v244 offset:8200
    v_cvt_pk_bf16_f32 v189, v142, v143
    v_cvt_pk_bf16_f32 v230, v236, v237
    v_mfma_f32_16x16x32_bf16 v[140:143], a[128:131], a[48:51], v[204:207]
    v_exp_f32 v133, v133
    v_lshlrev_b32 v238, 16, v231
    v_mfma_f32_16x16x32_bf16 v[140:143], a[132:135], a[52:55], v[140:143]
    ds_read_b64_tr_b16 a[214:215], v244 offset:12296
    v_and_b32 v239, 0xffff0000, v231
    v_mul_f32 v238, s47, v238
    v_mfma_f32_16x16x32_bf16 v[140:143], a[136:139], a[56:59], v[140:143]
    v_exp_f32 v134, v134
    v_mfma_f32_16x16x32_bf16 v[140:143], a[140:143], a[60:63], v[140:143]
    ds_read_b64_tr_b16 a[216:217], v245 offset:8192
    v_cvt_pk_bf16_f32 v190, v156, v157
    v_cvt_pk_bf16_f32 v191, v158, v159
    v_mul_f32 v239, s47, v239
    v_mfma_f32_16x16x32_bf16 v[156:159], a[144:147], a[48:51], v[204:207]
    s_waitcnt lgkmcnt(8)
    v_exp_f32_e64 v135, v135
    v_cvt_pk_bf16_f32 v231, v238, v239
    v_mfma_f32_16x16x32_bf16 v[156:159], a[148:151], a[52:55], v[156:159]
    ds_write_b128 v249, v[228:231] offset:33792
    v_lshlrev_b32_e64 v220, 16, v216
    v_and_b32 v221, 0xffff0000, v216
    v_mfma_f32_16x16x32_bf16 v[156:159], a[152:155], a[56:59], v[156:159]
    v_exp_f32_e64 v148, v148
    v_mfma_f32_16x16x32_bf16 v[156:159], a[156:159], a[60:63], v[156:159]
    ds_read_b128 v[228:231], v249 offset:41984
    v_mul_f32 v220, s47, v220
    v_mul_f32 v221, s47, v221
    v_mfma_f32_16x16x32_bf16 a[224:227], a[240:243], v[176:179], a[224:227]
    v_exp_f32_e64 v149, v149
    v_mfma_f32_16x16x32_bf16 a[228:231], a[240:243], v[180:183], a[228:231]
    ds_read_b64_tr_b16 a[218:219], v245 offset:12288
    v_cvt_pk_bf16_f32 v216, v220, v221
    v_lshlrev_b32_e64 v222, 16, v217
    v_mfma_f32_16x16x32_bf16 a[232:235], a[240:243], v[184:187], a[232:235]
    s_waitcnt lgkmcnt(15)
    v_exp_f32 v150, v150
    v_mfma_f32_16x16x32_bf16 a[236:239], a[240:243], v[188:191], a[236:239]
    ds_read_b64_tr_b16 a[220:221], v245 offset:8200
    v_and_b32 v223, 0xffff0000, v217
    v_mul_f32 v222, s47, v222
    v_mfma_f32_16x16x32_bf16 v[0:3], a[192:195], v[176:179], v[0:3]
    v_exp_f32 v151, v151
    v_mfma_f32_16x16x32_bf16 v[4:7], a[192:195], v[180:183], v[4:7]
    ds_read_b64_tr_b16 a[222:223], v245 offset:12296
    v_mul_f32 v223, s47, v223
    v_cvt_pk_bf16_f32 v217, v222, v223
    v_mfma_f32_16x16x32_bf16 v[8:11], a[192:195], v[184:187], v[8:11]
    s_waitcnt lgkmcnt(15)
    v_exp_f32_e64 v136, v136
    v_mfma_f32_16x16x32_bf16 v[12:15], a[192:195], v[188:191], v[12:15]
    ds_read_b128 a[160:163], v241 offset:24576
    v_lshlrev_b32_e64 v224, 16, v218
    v_and_b32 v225, 0xffff0000, v218
    v_mfma_f32_16x16x32_bf16 v[16:19], a[196:199], v[176:179], v[16:19]
    v_exp_f32_e64 v137, v137
    v_mfma_f32_16x16x32_bf16 v[20:23], a[196:199], v[180:183], v[20:23]
    ds_read_b128 a[164:167], v241 offset:25600
    v_mul_f32 v224, s47, v224
    v_mfma_f32_16x16x32_bf16 v[24:27], a[196:199], v[184:187], v[24:27]
    s_waitcnt lgkmcnt(14)
    v_exp_f32_e64 v138, v138
    v_mfma_f32_16x16x32_bf16 v[28:31], a[196:199], v[188:191], v[28:31]
    ds_read_b128 a[168:171], v241 offset:26624
    v_mul_f32 v225, s47, v225
    v_mfma_f32_16x16x32_bf16 v[32:35], a[200:203], v[176:179], v[32:35]
    v_exp_f32 v139, v139
    v_cvt_pk_bf16_f32 v218, v224, v225
    v_mfma_f32_16x16x32_bf16 v[36:39], a[200:203], v[180:183], v[36:39]
    ds_read_b128 a[172:175], v241 offset:27648
    v_lshlrev_b32_e64 v226, 16, v219
    v_mfma_f32_16x16x32_bf16 v[40:43], a[200:203], v[184:187], v[40:43]
    s_waitcnt lgkmcnt(14)
    v_exp_f32 v152, v152
    v_and_b32 v227, 0xffff0000, v219
    v_mfma_f32_16x16x32_bf16 v[44:47], a[200:203], v[188:191], v[44:47]
    ds_read_b128 a[176:179], v241 offset:28672
    v_mul_f32 v226, s47, v226
    v_mfma_f32_16x16x32_bf16 v[48:51], a[204:207], v[176:179], v[48:51]
    v_exp_f32 v153, v153
    v_mul_f32 v227, s47, v227
    v_mfma_f32_16x16x32_bf16 v[52:55], a[204:207], v[180:183], v[52:55]
    ds_read_b128 a[180:183], v241 offset:29696
    v_cvt_pk_bf16_f32 v219, v226, v227
    v_mfma_f32_16x16x32_bf16 v[56:59], a[204:207], v[184:187], v[56:59]
    s_waitcnt lgkmcnt(14)
    v_exp_f32_e64 v154, v154
    ds_write_b128 v249, v[216:219] offset:40960
    v_mfma_f32_16x16x32_bf16 v[60:63], a[204:207], v[188:191], v[60:63]
    ds_read_b128 a[184:187], v241 offset:30720
    v_cvt_pk_bf16_f32 v160, v128, v129
    v_mfma_f32_16x16x32_bf16 v[64:67], a[208:211], v[176:179], v[64:67]
    s_waitcnt lgkmcnt(11)
    v_exp_f32 v155, v155
    v_mfma_f32_16x16x32_bf16 v[68:71], a[208:211], v[180:183], v[68:71]
    ds_read_b128 a[188:191], v241 offset:31744
    v_lshlrev_b32_e64 v232, 16, v228
    v_and_b32 v233, 0xffff0000, v228
    v_mfma_f32_16x16x32_bf16 v[72:75], a[208:211], v[184:187], v[72:75]
    s_waitcnt lgkmcnt(15)
    v_exp_f32 v140, v140
    v_mfma_f32_16x16x32_bf16 v[76:79], a[208:211], v[188:191], v[76:79]
    v_mul_f32 v232, s47, v232
    v_mul_f32 v233, s47, v233
    v_cvt_pk_bf16_f32 v228, v232, v233
    v_mfma_f32_16x16x32_bf16 v[80:83], a[212:215], v[176:179], v[80:83]
    v_exp_f32_e64 v141, v141
    v_mfma_f32_16x16x32_bf16 v[84:87], a[212:215], v[180:183], v[84:87]
    s_waitcnt lgkmcnt(11)
    v_lshlrev_b32 v234, 16, v229
    v_and_b32 v235, 0xffff0000, v229
    v_mul_f32 v234, s47, v234
    v_mfma_f32_16x16x32_bf16 v[88:91], a[212:215], v[184:187], v[88:91]
    v_exp_f32 v142, v142
    v_mfma_f32_16x16x32_bf16 v[92:95], a[212:215], v[188:191], v[92:95]
    v_mul_f32 v235, s47, v235
    v_cvt_pk_bf16_f32 v229, v234, v235
    v_lshlrev_b32 v236, 16, v230
    v_mfma_f32_16x16x32_bf16 v[96:99], a[216:219], v[176:179], v[96:99]
    v_exp_f32_e64 v143, v143
    v_mfma_f32_16x16x32_bf16 v[100:103], a[216:219], v[180:183], v[100:103]
    s_waitcnt lgkmcnt(9)
    v_and_b32 v237, 0xffff0000, v230
    v_mul_f32 v236, s47, v236
    v_mul_f32 v237, s47, v237
    v_mfma_f32_16x16x32_bf16 v[104:107], a[216:219], v[184:187], v[104:107]
    v_exp_f32 v156, v156
    v_mfma_f32_16x16x32_bf16 v[108:111], a[216:219], v[188:191], v[108:111]
    v_cvt_pk_bf16_f32 v230, v236, v237
    v_cvt_pk_bf16_f32 v161, v130, v131
    v_lshlrev_b32_e64 v238, 16, v231
    v_mfma_f32_16x16x32_bf16 v[112:115], a[220:223], v[176:179], v[112:115]
    v_exp_f32_e64 v157, v157
    v_mfma_f32_16x16x32_bf16 v[116:119], a[220:223], v[180:183], v[116:119]
    s_waitcnt lgkmcnt(5)
    v_and_b32 v239, 0xffff0000, v231
    v_mul_f32 v238, s47, v238
    v_mul_f32 v239, s47, v239
    v_mfma_f32_16x16x32_bf16 v[120:123], a[220:223], v[184:187], v[120:123]
    v_exp_f32 v158, v158
    v_mfma_f32_16x16x32_bf16 v[124:127], a[220:223], v[188:191], v[124:127]
    v_cvt_pk_bf16_f32 v162, v144, v145
    v_cvt_pk_bf16_f32 v163, v146, v147
    v_cvt_pk_bf16_f32 v231, v238, v239
    v_mfma_f32_16x16x32_bf16 v[128:131], a[160:163], a[0:3], v[192:195]
    v_exp_f32_e64 v159, v159
    v_mfma_f32_16x16x32_bf16 v[128:131], a[164:167], a[4:7], v[128:131]
    ds_write_b128 v249, v[228:231] offset:41984
    v_cvt_pk_bf16_f32 v164, v132, v133
    v_mfma_f32_16x16x32_bf16 v[128:131], a[168:171], a[8:11], v[128:131]
    s_waitcnt lgkmcnt(1)
    v_cvt_pk_bf16_f32 v165, v134, v135
    v_cvt_pk_bf16_f32 v166, v148, v149
    v_mfma_f32_16x16x32_bf16 v[128:131], a[172:175], a[12:15], v[128:131]
    v_cvt_pk_bf16_f32 v167, v150, v151
    v_cvt_pk_bf16_f32 v168, v136, v137
    v_mfma_f32_16x16x32_bf16 v[144:147], a[176:179], a[0:3], v[192:195]
    v_cvt_pk_bf16_f32 v169, v138, v139
    v_cvt_pk_bf16_f32 v170, v152, v153
    v_mfma_f32_16x16x32_bf16 v[144:147], a[180:183], a[4:7], v[144:147]
    v_cvt_pk_bf16_f32 v171, v154, v155
    v_cvt_pk_bf16_f32 v172, v140, v141
    v_mfma_f32_16x16x32_bf16 v[144:147], a[184:187], a[8:11], v[144:147]
    v_exp_f32 v128, v128
    v_mfma_f32_16x16x32_bf16 v[144:147], a[188:191], a[12:15], v[144:147]
    v_cvt_pk_bf16_f32 v173, v142, v143
    v_cvt_pk_bf16_f32 v174, v156, v157
    v_mfma_f32_16x16x32_bf16 v[132:135], a[160:163], a[16:19], v[196:199]
    s_waitcnt vmcnt(6)
    v_exp_f32 v129, v129
    v_mfma_f32_16x16x32_bf16 v[132:135], a[164:167], a[20:23], v[132:135]
    s_waitcnt lgkmcnt(0)
    v_cvt_pk_bf16_f32 v175, v158, v159
    v_cvt_pk_bf16_f32 v176, v128, v129
    v_mfma_f32_16x16x32_bf16 v[132:135], a[168:171], a[24:27], v[132:135]
    v_exp_f32 v130, v130
    v_mfma_f32_16x16x32_bf16 v[132:135], a[172:175], a[28:31], v[132:135]
    s_barrier
    v_mfma_f32_16x16x32_bf16 v[148:151], a[176:179], a[16:19], v[196:199]
    v_exp_f32 v131, v131
    v_mfma_f32_16x16x32_bf16 v[148:151], a[180:183], a[20:23], v[148:151]
    buffer_load_dwordx4 v247, s[20:23], s39 offen offset:0 lds
    v_cvt_pk_bf16_f32 v177, v130, v131
    s_waitcnt vmcnt(63)
    v_mfma_f32_16x16x32_bf16 v[148:151], a[184:187], a[24:27], v[148:151]
    v_exp_f32 v144, v144
    v_mfma_f32_16x16x32_bf16 v[148:151], a[188:191], a[28:31], v[148:151]
    buffer_load_dwordx4 v247, s[20:23], s39 offen offset:1024 lds
    v_mfma_f32_16x16x32_bf16 v[136:139], a[160:163], a[32:35], v[200:203]
    s_add_u32 m0, s40, 8192
    v_exp_f32_e64 v145, v145
    v_mfma_f32_16x16x32_bf16 v[136:139], a[164:167], a[36:39], v[136:139]
    buffer_load_dwordx4 v247, s[20:23], s51 offen offset:0 lds
    v_cvt_pk_bf16_f32 v178, v144, v145
    v_mfma_f32_16x16x32_bf16 v[136:139], a[168:171], a[40:43], v[136:139]
    s_add_u32 s39, s38, 114688
    v_exp_f32_e64 v146, v146
    v_mfma_f32_16x16x32_bf16 v[136:139], a[172:175], a[44:47], v[136:139]
    buffer_load_dwordx4 v247, s[20:23], s51 offen offset:1024 lds
    v_mfma_f32_16x16x32_bf16 v[152:155], a[176:179], a[32:35], v[200:203]
    s_add_u32 m0, s40, 16384
    v_exp_f32_e64 v147, v147
    v_mfma_f32_16x16x32_bf16 v[152:155], a[180:183], a[36:39], v[152:155]
    ds_read_b64_tr_b16 a[192:193], v242 offset:16384
    v_cvt_pk_bf16_f32 v179, v146, v147
    v_mfma_f32_16x16x32_bf16 v[152:155], a[184:187], a[40:43], v[152:155]
    s_add_u32 s51, s38, 122880
    v_exp_f32_e64 v132, v132
    v_mfma_f32_16x16x32_bf16 v[152:155], a[188:191], a[44:47], v[152:155]
    buffer_load_dwordx4 a[112:115], v246, s[12:15], s33 offen offset:0
    v_mfma_f32_16x16x32_bf16 v[140:143], a[160:163], a[48:51], v[204:207]
    v_exp_f32_e64 v133, v133
    v_mfma_f32_16x16x32_bf16 v[140:143], a[164:167], a[52:55], v[140:143]
    ds_read_b64_tr_b16 a[194:195], v242 offset:20480
    v_cvt_pk_bf16_f32 v180, v132, v133
    v_mfma_f32_16x16x32_bf16 v[140:143], a[168:171], a[56:59], v[140:143]
    v_exp_f32_e64 v134, v134
    v_mfma_f32_16x16x32_bf16 v[140:143], a[172:175], a[60:63], v[140:143]
    ds_read_b64_tr_b16 a[196:197], v242 offset:16392
    v_mfma_f32_16x16x32_bf16 v[156:159], a[176:179], a[48:51], v[204:207]
    v_exp_f32_e64 v135, v135
    v_mfma_f32_16x16x32_bf16 v[156:159], a[180:183], a[52:55], v[156:159]
    ds_read_b64_tr_b16 a[198:199], v242 offset:20488
    v_cvt_pk_bf16_f32 v181, v134, v135
    v_mfma_f32_16x16x32_bf16 v[156:159], a[184:187], a[56:59], v[156:159]
    v_exp_f32_e64 v148, v148
    v_mfma_f32_16x16x32_bf16 v[156:159], a[188:191], a[60:63], v[156:159]
    ds_read_b64_tr_b16 a[200:201], v243 offset:16384
    v_mfma_f32_16x16x32_bf16 a[224:227], a[240:243], v[160:163], a[224:227]
    v_exp_f32_e64 v149, v149
    v_mfma_f32_16x16x32_bf16 a[228:231], a[240:243], v[164:167], a[228:231]
    ds_read_b64_tr_b16 a[202:203], v243 offset:20480
    v_cvt_pk_bf16_f32 v182, v148, v149
    v_mfma_f32_16x16x32_bf16 a[232:235], a[240:243], v[168:171], a[232:235]
    s_waitcnt lgkmcnt(4)
    v_exp_f32 v150, v150
    v_mfma_f32_16x16x32_bf16 a[236:239], a[240:243], v[172:175], a[236:239]
    buffer_load_dwordx4 a[116:119], v246, s[12:15], s33 offen offset:64
    v_mfma_f32_16x16x32_bf16 v[0:3], a[192:195], v[160:163], v[0:3]
    v_exp_f32_e64 v151, v151
    v_mfma_f32_16x16x32_bf16 v[4:7], a[192:195], v[164:167], v[4:7]
    ds_read_b64_tr_b16 a[204:205], v243 offset:16392
    v_cvt_pk_bf16_f32 v183, v150, v151
    v_mfma_f32_16x16x32_bf16 v[8:11], a[192:195], v[168:171], v[8:11]
    s_waitcnt lgkmcnt(3)
    v_exp_f32 v136, v136
    v_mfma_f32_16x16x32_bf16 v[12:15], a[192:195], v[172:175], v[12:15]
    ds_read_b64_tr_b16 a[206:207], v243 offset:20488
    v_mfma_f32_16x16x32_bf16 v[16:19], a[196:199], v[160:163], v[16:19]
    v_exp_f32_e64 v137, v137
    v_mfma_f32_16x16x32_bf16 v[20:23], a[196:199], v[164:167], v[20:23]
    ds_read_b64_tr_b16 a[208:209], v244 offset:16384
    v_cvt_pk_bf16_f32 v184, v136, v137
    v_mfma_f32_16x16x32_bf16 v[24:27], a[196:199], v[168:171], v[24:27]
    s_waitcnt lgkmcnt(3)
    v_exp_f32 v138, v138
    v_mfma_f32_16x16x32_bf16 v[28:31], a[196:199], v[172:175], v[28:31]
    ds_read_b64_tr_b16 a[210:211], v244 offset:20480
    v_mfma_f32_16x16x32_bf16 v[32:35], a[200:203], v[160:163], v[32:35]
    v_exp_f32_e64 v139, v139
    v_mfma_f32_16x16x32_bf16 v[36:39], a[200:203], v[164:167], v[36:39]
    ds_read_b64_tr_b16 a[212:213], v244 offset:16392
    v_cvt_pk_bf16_f32 v185, v138, v139
    v_mfma_f32_16x16x32_bf16 v[40:43], a[200:203], v[168:171], v[40:43]
    s_waitcnt lgkmcnt(3)
    v_exp_f32 v152, v152
    v_mfma_f32_16x16x32_bf16 v[44:47], a[200:203], v[172:175], v[44:47]
    ds_read_b64_tr_b16 a[214:215], v244 offset:20488
    v_mfma_f32_16x16x32_bf16 v[48:51], a[204:207], v[160:163], v[48:51]
    v_exp_f32_e64 v153, v153
    ds_read_b128 v[216:219], v249 offset:49152
    v_mfma_f32_16x16x32_bf16 v[52:55], a[204:207], v[164:167], v[52:55]
    buffer_load_dwordx4 a[120:123], v246, s[12:15], s33 offen offset:128
    v_cvt_pk_bf16_f32 v186, v152, v153
    v_mfma_f32_16x16x32_bf16 v[56:59], a[204:207], v[168:171], v[56:59]
    s_waitcnt lgkmcnt(3)
    v_exp_f32 v154, v154
    v_mfma_f32_16x16x32_bf16 v[60:63], a[204:207], v[172:175], v[60:63]
    ds_read_b64_tr_b16 a[216:217], v245 offset:16384
    v_mfma_f32_16x16x32_bf16 v[64:67], a[208:211], v[160:163], v[64:67]
    v_exp_f32_e64 v155, v155
    ds_read_b64_tr_b16 a[218:219], v245 offset:20480
    v_mfma_f32_16x16x32_bf16 v[68:71], a[208:211], v[164:167], v[68:71]
    ds_read_b64_tr_b16 a[220:221], v245 offset:16392
    v_cvt_pk_bf16_f32 v187, v154, v155
    v_mfma_f32_16x16x32_bf16 v[72:75], a[208:211], v[168:171], v[72:75]
    s_waitcnt lgkmcnt(4)
    v_exp_f32 v140, v140
    v_mfma_f32_16x16x32_bf16 v[76:79], a[208:211], v[172:175], v[76:79]
    ds_read_b64_tr_b16 a[222:223], v245 offset:20488
    s_waitcnt lgkmcnt(4)
    v_mfma_f32_16x16x32_bf16 v[80:83], a[212:215], v[160:163], v[80:83]
    v_exp_f32 v141, v141
    v_lshlrev_b32_e64 v220, 16, v216
    v_mfma_f32_16x16x32_bf16 v[84:87], a[212:215], v[164:167], v[84:87]
    buffer_load_dwordx4 a[124:127], v246, s[12:15], s33 offen offset:192
    v_and_b32 v221, 0xffff0000, v216
    v_mul_f32 v220, s47, v220
    v_mfma_f32_16x16x32_bf16 v[88:91], a[212:215], v[168:171], v[88:91]
    s_add_u32 s45, s44, 48
    s_lshl_b32 s46, s45, 8
    s_add_u32 s46, s46, s41
    s_cmp_lt_u32 s45, 992
    s_cselect_b32 s33, s46, s50
    v_exp_f32 v142, v142
    v_mfma_f32_16x16x32_bf16 v[92:95], a[212:215], v[172:175], v[92:95]
    ds_read_b128 a[128:131], v241 offset:32768
    v_mul_f32 v221, s47, v221
    v_cvt_pk_bf16_f32 v216, v220, v221
    s_waitcnt lgkmcnt(3)
    v_mfma_f32_16x16x32_bf16 v[96:99], a[216:219], v[160:163], v[96:99]
    v_exp_f32_e64 v143, v143
    ds_read_b128 a[132:135], v241 offset:33792
    ds_read_b128 a[136:139], v241 offset:34816
    ds_read_b128 a[140:143], v241 offset:35840
    v_mfma_f32_16x16x32_bf16 v[100:103], a[216:219], v[164:167], v[100:103]
    ds_read_b128 a[144:147], v241 offset:36864
    v_lshlrev_b32_e64 v222, 16, v217
    v_and_b32 v223, 0xffff0000, v217
    v_mfma_f32_16x16x32_bf16 v[104:107], a[216:219], v[168:171], v[104:107]
    s_waitcnt lgkmcnt(5)
    v_exp_f32 v156, v156
    v_mfma_f32_16x16x32_bf16 v[108:111], a[216:219], v[172:175], v[108:111]
    ds_read_b128 a[148:151], v241 offset:37888
    v_mul_f32 v222, s47, v222
    v_mul_f32 v223, s47, v223
    v_mfma_f32_16x16x32_bf16 v[112:115], a[220:223], v[160:163], v[112:115]
    v_exp_f32_e64 v157, v157
    ds_read_b128 a[152:155], v241 offset:38912
    ds_read_b128 a[156:159], v241 offset:39936
    v_mfma_f32_16x16x32_bf16 v[116:119], a[220:223], v[164:167], v[116:119]
    ds_read_b128 v[228:231], v249 offset:50176
    v_cvt_pk_bf16_f32 v217, v222, v223
    v_lshlrev_b32_e64 v224, 16, v218
    v_mfma_f32_16x16x32_bf16 v[120:123], a[220:223], v[168:171], v[120:123]
    v_exp_f32_e64 v158, v158
    v_mfma_f32_16x16x32_bf16 v[124:127], a[220:223], v[172:175], v[124:127]
    ds_read_b64_tr_b16 a[192:193], v242 offset:24576
    v_and_b32 v225, 0xffff0000, v218
    v_mul_f32 v224, s47, v224
    s_waitcnt lgkmcnt(6)
    v_mfma_f32_16x16x32_bf16 v[128:131], a[128:131], a[0:3], v[192:195]
    v_exp_f32_e64 v159, v159
    v_mfma_f32_16x16x32_bf16 v[128:131], a[132:135], a[4:7], v[128:131]
    ds_read_b64_tr_b16 a[194:195], v242 offset:28672
    v_mul_f32 v225, s47, v225
    v_cvt_pk_bf16_f32 v218, v224, v225
    v_mfma_f32_16x16x32_bf16 v[128:131], a[136:139], a[8:11], v[128:131]
    ds_read_b64_tr_b16 a[196:197], v242 offset:24584
    v_lshlrev_b32 v226, 16, v219
    v_mfma_f32_16x16x32_bf16 v[128:131], a[140:143], a[12:15], v[128:131]
    ds_read_b64_tr_b16 a[198:199], v242 offset:28680
    v_and_b32 v227, 0xffff0000, v219
    s_waitcnt lgkmcnt(5)
    v_mfma_f32_16x16x32_bf16 v[144:147], a[144:147], a[0:3], v[192:195]
    ds_read_b64_tr_b16 a[200:201], v243 offset:24576
    v_mul_f32 v226, s47, v226
    v_mfma_f32_16x16x32_bf16 v[144:147], a[148:151], a[4:7], v[144:147]
    ds_read_b64_tr_b16 a[202:203], v243 offset:28672
    v_mul_f32 v227, s47, v227
    v_mfma_f32_16x16x32_bf16 v[144:147], a[152:155], a[8:11], v[144:147]
    v_exp_f32 v128, v128
    v_cvt_pk_bf16_f32 v219, v226, v227
    v_mfma_f32_16x16x32_bf16 v[144:147], a[156:159], a[12:15], v[144:147]
    ds_write_b128 v249, v[216:219] offset:49152
    v_cvt_pk_bf16_f32 v188, v140, v141
    v_mfma_f32_16x16x32_bf16 v[132:135], a[128:131], a[16:19], v[196:199]
    s_waitcnt lgkmcnt(7)
    v_exp_f32 v129, v129
    v_mfma_f32_16x16x32_bf16 v[132:135], a[132:135], a[20:23], v[132:135]
    ds_read_b128 v[216:219], v249 offset:57344
    v_lshlrev_b32_e64 v232, 16, v228
    v_and_b32 v233, 0xffff0000, v228
    v_mfma_f32_16x16x32_bf16 v[132:135], a[136:139], a[24:27], v[132:135]
    v_exp_f32_e64 v130, v130
    v_mfma_f32_16x16x32_bf16 v[132:135], a[140:143], a[28:31], v[132:135]
    ds_read_b64_tr_b16 a[204:205], v243 offset:24584
    v_mul_f32 v232, s47, v232
    v_mul_f32 v233, s47, v233
    v_mfma_f32_16x16x32_bf16 v[148:151], a[144:147], a[16:19], v[196:199]
    v_exp_f32_e64 v131, v131
    v_mfma_f32_16x16x32_bf16 v[148:151], a[148:151], a[20:23], v[148:151]
    ds_read_b64_tr_b16 a[206:207], v243 offset:28680
    v_cvt_pk_bf16_f32 v228, v232, v233
    v_lshlrev_b32_e64 v234, 16, v229
    v_mfma_f32_16x16x32_bf16 v[148:151], a[152:155], a[24:27], v[148:151]
    v_exp_f32_e64 v144, v144
    v_mfma_f32_16x16x32_bf16 v[148:151], a[156:159], a[28:31], v[148:151]
    ds_read_b64_tr_b16 a[208:209], v244 offset:24576
    v_and_b32 v235, 0xffff0000, v229
    v_mul_f32 v234, s47, v234
    v_mfma_f32_16x16x32_bf16 v[136:139], a[128:131], a[32:35], v[200:203]
    v_exp_f32 v145, v145
    v_mfma_f32_16x16x32_bf16 v[136:139], a[132:135], a[36:39], v[136:139]
    ds_read_b64_tr_b16 a[210:211], v244 offset:28672
    v_mul_f32 v235, s47, v235
    v_cvt_pk_bf16_f32 v229, v234, v235
    v_mfma_f32_16x16x32_bf16 v[136:139], a[136:139], a[40:43], v[136:139]
    v_exp_f32 v146, v146
    v_mfma_f32_16x16x32_bf16 v[136:139], a[140:143], a[44:47], v[136:139]
    ds_read_b64_tr_b16 a[212:213], v244 offset:24584
    v_lshlrev_b32_e64 v236, 16, v230
    v_and_b32 v237, 0xffff0000, v230
    v_mfma_f32_16x16x32_bf16 v[152:155], a[144:147], a[32:35], v[200:203]
    v_exp_f32_e64 v147, v147
    v_mfma_f32_16x16x32_bf16 v[152:155], a[148:151], a[36:39], v[152:155]
    ds_read_b64_tr_b16 a[214:215], v244 offset:28680
    v_mul_f32 v236, s47, v236
    v_mul_f32 v237, s47, v237
    v_mfma_f32_16x16x32_bf16 v[152:155], a[152:155], a[40:43], v[152:155]
    v_exp_f32_e64 v132, v132
    v_mfma_f32_16x16x32_bf16 v[152:155], a[156:159], a[44:47], v[152:155]
    ds_read_b64_tr_b16 a[216:217], v245 offset:24576
    v_cvt_pk_bf16_f32 v189, v142, v143
    v_cvt_pk_bf16_f32 v230, v236, v237
    v_mfma_f32_16x16x32_bf16 v[140:143], a[128:131], a[48:51], v[204:207]
    v_exp_f32 v133, v133
    v_lshlrev_b32 v238, 16, v231
    v_mfma_f32_16x16x32_bf16 v[140:143], a[132:135], a[52:55], v[140:143]
    ds_read_b64_tr_b16 a[218:219], v245 offset:28672
    v_and_b32 v239, 0xffff0000, v231
    v_mul_f32 v238, s47, v238
    v_mfma_f32_16x16x32_bf16 v[140:143], a[136:139], a[56:59], v[140:143]
    v_exp_f32 v134, v134
    v_mfma_f32_16x16x32_bf16 v[140:143], a[140:143], a[60:63], v[140:143]
    ds_read_b64_tr_b16 a[220:221], v245 offset:24584
    v_cvt_pk_bf16_f32 v190, v156, v157
    v_cvt_pk_bf16_f32 v191, v158, v159
    v_mul_f32 v239, s47, v239
    v_mfma_f32_16x16x32_bf16 v[156:159], a[144:147], a[48:51], v[204:207]
    s_waitcnt lgkmcnt(9)
    v_exp_f32_e64 v135, v135
    v_cvt_pk_bf16_f32 v231, v238, v239
    v_mfma_f32_16x16x32_bf16 v[156:159], a[148:151], a[52:55], v[156:159]
    ds_write_b128 v249, v[228:231] offset:50176
    v_lshlrev_b32_e64 v220, 16, v216
    v_and_b32 v221, 0xffff0000, v216
    v_mfma_f32_16x16x32_bf16 v[156:159], a[152:155], a[56:59], v[156:159]
    v_exp_f32_e64 v148, v148
    v_mfma_f32_16x16x32_bf16 v[156:159], a[156:159], a[60:63], v[156:159]
    ds_read_b128 v[228:231], v249 offset:58368
    v_mul_f32 v220, s47, v220
    v_mul_f32 v221, s47, v221
    v_mfma_f32_16x16x32_bf16 a[224:227], a[240:243], v[176:179], a[224:227]
    v_exp_f32_e64 v149, v149
    v_mfma_f32_16x16x32_bf16 a[228:231], a[240:243], v[180:183], a[228:231]
    ds_read_b64_tr_b16 a[222:223], v245 offset:28680
    v_cvt_pk_bf16_f32 v216, v220, v221
    v_lshlrev_b32_e64 v222, 16, v217
    v_mfma_f32_16x16x32_bf16 a[232:235], a[240:243], v[184:187], a[232:235]
    s_waitcnt lgkmcnt(15)
    v_exp_f32 v150, v150
    v_mfma_f32_16x16x32_bf16 a[236:239], a[240:243], v[188:191], a[236:239]
    ds_read_b128 a[160:163], v241 offset:40960
    v_and_b32 v223, 0xffff0000, v217
    v_mul_f32 v222, s47, v222
    v_mfma_f32_16x16x32_bf16 v[0:3], a[192:195], v[176:179], v[0:3]
    v_exp_f32 v151, v151
    v_mfma_f32_16x16x32_bf16 v[4:7], a[192:195], v[180:183], v[4:7]
    ds_read_b128 a[164:167], v241 offset:41984
    v_mul_f32 v223, s47, v223
    v_cvt_pk_bf16_f32 v217, v222, v223
    v_mfma_f32_16x16x32_bf16 v[8:11], a[192:195], v[184:187], v[8:11]
    s_waitcnt lgkmcnt(15)
    v_exp_f32_e64 v136, v136
    v_mfma_f32_16x16x32_bf16 v[12:15], a[192:195], v[188:191], v[12:15]
    ds_read_b128 a[168:171], v241 offset:43008
    v_lshlrev_b32_e64 v224, 16, v218
    v_and_b32 v225, 0xffff0000, v218
    v_mfma_f32_16x16x32_bf16 v[16:19], a[196:199], v[176:179], v[16:19]
    v_exp_f32_e64 v137, v137
    v_mfma_f32_16x16x32_bf16 v[20:23], a[196:199], v[180:183], v[20:23]
    ds_read_b128 a[172:175], v241 offset:44032
    v_mul_f32 v224, s47, v224
    v_mfma_f32_16x16x32_bf16 v[24:27], a[196:199], v[184:187], v[24:27]
    s_waitcnt lgkmcnt(15)
    v_exp_f32_e64 v138, v138
    v_mfma_f32_16x16x32_bf16 v[28:31], a[196:199], v[188:191], v[28:31]
    ds_read_b128 a[176:179], v241 offset:45056
    v_mul_f32 v225, s47, v225
    v_mfma_f32_16x16x32_bf16 v[32:35], a[200:203], v[176:179], v[32:35]
    v_exp_f32 v139, v139
    v_cvt_pk_bf16_f32 v218, v224, v225
    v_mfma_f32_16x16x32_bf16 v[36:39], a[200:203], v[180:183], v[36:39]
    ds_read_b128 a[180:183], v241 offset:46080
    v_lshlrev_b32_e64 v226, 16, v219
    v_mfma_f32_16x16x32_bf16 v[40:43], a[200:203], v[184:187], v[40:43]
    s_waitcnt lgkmcnt(15)
    v_exp_f32 v152, v152
    v_and_b32 v227, 0xffff0000, v219
    v_mfma_f32_16x16x32_bf16 v[44:47], a[200:203], v[188:191], v[44:47]
    ds_read_b128 a[184:187], v241 offset:47104
    v_mul_f32 v226, s47, v226
    v_mfma_f32_16x16x32_bf16 v[48:51], a[204:207], v[176:179], v[48:51]
    v_exp_f32 v153, v153
    v_mul_f32 v227, s47, v227
    v_mfma_f32_16x16x32_bf16 v[52:55], a[204:207], v[180:183], v[52:55]
    ds_read_b128 a[188:191], v241 offset:48128
    v_cvt_pk_bf16_f32 v219, v226, v227
    v_mfma_f32_16x16x32_bf16 v[56:59], a[204:207], v[184:187], v[56:59]
    s_waitcnt lgkmcnt(15)
    v_exp_f32_e64 v154, v154
    ds_write_b128 v249, v[216:219] offset:57344
    v_mfma_f32_16x16x32_bf16 v[60:63], a[204:207], v[188:191], v[60:63]
    s_waitcnt lgkmcnt(10)
    v_lshlrev_b32 v232, 16, v228
    v_and_b32 v233, 0xffff0000, v228
    v_mul_f32 v232, s47, v232
    v_mfma_f32_16x16x32_bf16 v[64:67], a[208:211], v[176:179], v[64:67]
    v_exp_f32 v155, v155
    v_mfma_f32_16x16x32_bf16 v[68:71], a[208:211], v[180:183], v[68:71]
    s_waitcnt lgkmcnt(15)
    v_mul_f32 v233, s47, v233
    v_cvt_pk_bf16_f32 v228, v232, v233
    v_lshlrev_b32_e64 v234, 16, v229
    v_mfma_f32_16x16x32_bf16 v[72:75], a[208:211], v[184:187], v[72:75]
    v_exp_f32_e64 v140, v140
    v_mfma_f32_16x16x32_bf16 v[76:79], a[208:211], v[188:191], v[76:79]
    v_and_b32 v235, 0xffff0000, v229
    v_mul_f32 v234, s47, v234
    v_mul_f32 v235, s47, v235
    v_mfma_f32_16x16x32_bf16 v[80:83], a[212:215], v[176:179], v[80:83]
    v_exp_f32_e64 v141, v141
    v_mfma_f32_16x16x32_bf16 v[84:87], a[212:215], v[180:183], v[84:87]
    s_waitcnt lgkmcnt(15)
    v_cvt_pk_bf16_f32 v229, v234, v235
    v_lshlrev_b32 v236, 16, v230
    v_and_b32 v237, 0xffff0000, v230
    v_mfma_f32_16x16x32_bf16 v[88:91], a[212:215], v[184:187], v[88:91]
    v_exp_f32_e64 v142, v142
    v_mfma_f32_16x16x32_bf16 v[92:95], a[212:215], v[188:191], v[92:95]
    v_mul_f32 v236, s47, v236
    v_mul_f32 v237, s47, v237
    v_cvt_pk_bf16_f32 v230, v236, v237
    v_mfma_f32_16x16x32_bf16 v[96:99], a[216:219], v[176:179], v[96:99]
    v_exp_f32_e64 v143, v143
    v_mfma_f32_16x16x32_bf16 v[100:103], a[216:219], v[180:183], v[100:103]
    s_waitcnt lgkmcnt(9)
    v_cvt_pk_bf16_f32 v160, v128, v129
    v_cvt_pk_bf16_f32 v161, v130, v131
    v_lshlrev_b32 v238, 16, v231
    v_mfma_f32_16x16x32_bf16 v[104:107], a[216:219], v[184:187], v[104:107]
    v_exp_f32_e64 v156, v156
    v_mfma_f32_16x16x32_bf16 v[108:111], a[216:219], v[188:191], v[108:111]
    v_and_b32 v239, 0xffff0000, v231
    v_mul_f32 v238, s47, v238
    v_mul_f32 v239, s47, v239
    v_mfma_f32_16x16x32_bf16 v[112:115], a[220:223], v[176:179], v[112:115]
    v_exp_f32_e64 v157, v157
    v_mfma_f32_16x16x32_bf16 v[116:119], a[220:223], v[180:183], v[116:119]
    s_waitcnt lgkmcnt(5)
    v_cvt_pk_bf16_f32 v162, v144, v145
    v_cvt_pk_bf16_f32 v163, v146, v147
    v_mfma_f32_16x16x32_bf16 v[120:123], a[220:223], v[184:187], v[120:123]
    v_exp_f32 v158, v158
    v_mfma_f32_16x16x32_bf16 v[124:127], a[220:223], v[188:191], v[124:127]
    v_cvt_pk_bf16_f32 v231, v238, v239
    v_cvt_pk_bf16_f32 v164, v132, v133
    v_mfma_f32_16x16x32_bf16 v[128:131], a[160:163], a[0:3], v[192:195]
    v_exp_f32_e64 v159, v159
    v_mfma_f32_16x16x32_bf16 v[128:131], a[164:167], a[4:7], v[128:131]
    ds_write_b128 v249, v[228:231] offset:58368
    v_cvt_pk_bf16_f32 v165, v134, v135
    v_mfma_f32_16x16x32_bf16 v[128:131], a[168:171], a[8:11], v[128:131]
    s_waitcnt lgkmcnt(2)
    v_cvt_pk_bf16_f32 v166, v148, v149
    v_cvt_pk_bf16_f32 v167, v150, v151
    v_mfma_f32_16x16x32_bf16 v[128:131], a[172:175], a[12:15], v[128:131]
    v_cvt_pk_bf16_f32 v168, v136, v137
    v_cvt_pk_bf16_f32 v169, v138, v139
    v_mfma_f32_16x16x32_bf16 v[144:147], a[176:179], a[0:3], v[192:195]
    v_cvt_pk_bf16_f32 v170, v152, v153
    v_cvt_pk_bf16_f32 v171, v154, v155
    v_mfma_f32_16x16x32_bf16 v[144:147], a[180:183], a[4:7], v[144:147]
    v_cvt_pk_bf16_f32 v172, v140, v141
    v_cvt_pk_bf16_f32 v173, v142, v143
    v_mfma_f32_16x16x32_bf16 v[144:147], a[184:187], a[8:11], v[144:147]
    v_exp_f32 v128, v128
    v_mfma_f32_16x16x32_bf16 v[144:147], a[188:191], a[12:15], v[144:147]
    v_cvt_pk_bf16_f32 v174, v156, v157
    v_cvt_pk_bf16_f32 v175, v158, v159
    v_mfma_f32_16x16x32_bf16 v[132:135], a[160:163], a[16:19], v[196:199]
    s_waitcnt vmcnt(4)
    v_exp_f32 v129, v129
    v_mfma_f32_16x16x32_bf16 v[132:135], a[164:167], a[20:23], v[132:135]
    s_waitcnt lgkmcnt(0)
    v_cvt_pk_bf16_f32 v176, v128, v129
    v_mfma_f32_16x16x32_bf16 v[132:135], a[168:171], a[24:27], v[132:135]
    v_exp_f32 v130, v130
    v_mfma_f32_16x16x32_bf16 v[132:135], a[172:175], a[28:31], v[132:135]
    s_barrier
    v_mfma_f32_16x16x32_bf16 v[148:151], a[176:179], a[16:19], v[196:199]
    v_exp_f32 v131, v131
    v_mfma_f32_16x16x32_bf16 v[148:151], a[180:183], a[20:23], v[148:151]
    buffer_load_dwordx4 v247, s[20:23], s39 offen offset:0 lds
    v_cvt_pk_bf16_f32 v177, v130, v131
    v_mfma_f32_16x16x32_bf16 v[148:151], a[184:187], a[24:27], v[148:151]
    v_exp_f32_e64 v144, v144
    v_mfma_f32_16x16x32_bf16 v[148:151], a[188:191], a[28:31], v[148:151]
    buffer_load_dwordx4 v247, s[20:23], s39 offen offset:1024 lds
    v_mfma_f32_16x16x32_bf16 v[136:139], a[160:163], a[32:35], v[200:203]
    s_add_u32 m0, s40, 24576
    v_exp_f32_e64 v145, v145
    v_mfma_f32_16x16x32_bf16 v[136:139], a[164:167], a[36:39], v[136:139]
    buffer_load_dwordx4 v247, s[20:23], s51 offen offset:0 lds
    v_cvt_pk_bf16_f32 v178, v144, v145
    v_mfma_f32_16x16x32_bf16 v[136:139], a[168:171], a[40:43], v[136:139]
    s_add_u32 s39, s38, 0
    v_exp_f32 v146, v146
    v_mfma_f32_16x16x32_bf16 v[136:139], a[172:175], a[44:47], v[136:139]
    buffer_load_dwordx4 v247, s[20:23], s51 offen offset:1024 lds
    v_mfma_f32_16x16x32_bf16 v[152:155], a[176:179], a[32:35], v[200:203]
    s_add_u32 m0, s40, 0
    v_exp_f32 v147, v147
    v_mfma_f32_16x16x32_bf16 v[152:155], a[180:183], a[36:39], v[152:155]
    ds_read_b64_tr_b16 a[192:193], v242 offset:0
    v_cvt_pk_bf16_f32 v179, v146, v147
    v_mfma_f32_16x16x32_bf16 v[152:155], a[184:187], a[40:43], v[152:155]
    s_add_u32 s51, s38, 8192
    v_exp_f32_e64 v132, v132
    v_mfma_f32_16x16x32_bf16 v[152:155], a[188:191], a[44:47], v[152:155]
    ds_read_b64_tr_b16 a[194:195], v242 offset:4096
    v_mfma_f32_16x16x32_bf16 v[140:143], a[160:163], a[48:51], v[204:207]
    v_exp_f32_e64 v133, v133
    v_mfma_f32_16x16x32_bf16 v[140:143], a[164:167], a[52:55], v[140:143]
    ds_read_b64_tr_b16 a[196:197], v242 offset:8
    v_cvt_pk_bf16_f32 v180, v132, v133
    v_mfma_f32_16x16x32_bf16 v[140:143], a[168:171], a[56:59], v[140:143]
    v_exp_f32_e64 v134, v134
    v_mfma_f32_16x16x32_bf16 v[140:143], a[172:175], a[60:63], v[140:143]
    ds_read_b64_tr_b16 a[198:199], v242 offset:4104
    v_mfma_f32_16x16x32_bf16 v[156:159], a[176:179], a[48:51], v[204:207]
    v_exp_f32_e64 v135, v135
    v_mfma_f32_16x16x32_bf16 v[156:159], a[180:183], a[52:55], v[156:159]
    ds_read_b64_tr_b16 a[200:201], v243 offset:0
    v_cvt_pk_bf16_f32 v181, v134, v135
    v_mfma_f32_16x16x32_bf16 v[156:159], a[184:187], a[56:59], v[156:159]
    v_exp_f32_e64 v148, v148
    v_mfma_f32_16x16x32_bf16 v[156:159], a[188:191], a[60:63], v[156:159]
    ds_read_b64_tr_b16 a[202:203], v243 offset:4096
    v_mfma_f32_16x16x32_bf16 a[224:227], a[240:243], v[160:163], a[224:227]
    v_exp_f32_e64 v149, v149
    v_mfma_f32_16x16x32_bf16 a[228:231], a[240:243], v[164:167], a[228:231]
    ds_read_b64_tr_b16 a[204:205], v243 offset:8
    v_cvt_pk_bf16_f32 v182, v148, v149
    v_mfma_f32_16x16x32_bf16 a[232:235], a[240:243], v[168:171], a[232:235]
    s_waitcnt lgkmcnt(5)
    v_exp_f32 v150, v150
    v_mfma_f32_16x16x32_bf16 a[236:239], a[240:243], v[172:175], a[236:239]
    global_load_dword v250, v254, s[80:81] offset:0
    v_mfma_f32_16x16x32_bf16 v[0:3], a[192:195], v[160:163], v[0:3]
    v_exp_f32_e64 v151, v151
    v_mfma_f32_16x16x32_bf16 v[4:7], a[192:195], v[164:167], v[4:7]
    ds_read_b64_tr_b16 a[206:207], v243 offset:4104
    v_cvt_pk_bf16_f32 v183, v150, v151
    v_mfma_f32_16x16x32_bf16 v[8:11], a[192:195], v[168:171], v[8:11]
    s_waitcnt lgkmcnt(4)
    v_exp_f32 v136, v136
    v_mfma_f32_16x16x32_bf16 v[12:15], a[192:195], v[172:175], v[12:15]
    global_load_dword v250, v254, s[80:81] offset:64
    v_mfma_f32_16x16x32_bf16 v[16:19], a[196:199], v[160:163], v[16:19]
    v_exp_f32_e64 v137, v137
    v_mfma_f32_16x16x32_bf16 v[20:23], a[196:199], v[164:167], v[20:23]
    ds_read_b64_tr_b16 a[208:209], v244 offset:0
    v_cvt_pk_bf16_f32 v184, v136, v137
    v_mfma_f32_16x16x32_bf16 v[24:27], a[196:199], v[168:171], v[24:27]
    s_waitcnt lgkmcnt(3)
    v_exp_f32 v138, v138
    v_mfma_f32_16x16x32_bf16 v[28:31], a[196:199], v[172:175], v[28:31]
    ds_read_b64_tr_b16 a[210:211], v244 offset:4096
    v_mfma_f32_16x16x32_bf16 v[32:35], a[200:203], v[160:163], v[32:35]
    v_exp_f32_e64 v139, v139
    v_mfma_f32_16x16x32_bf16 v[36:39], a[200:203], v[164:167], v[36:39]
    ds_read_b64_tr_b16 a[212:213], v244 offset:8
    v_cvt_pk_bf16_f32 v185, v138, v139
    v_mfma_f32_16x16x32_bf16 v[40:43], a[200:203], v[168:171], v[40:43]
    s_waitcnt lgkmcnt(3)
    v_exp_f32 v152, v152
    v_mfma_f32_16x16x32_bf16 v[44:47], a[200:203], v[172:175], v[44:47]
    ds_read_b64_tr_b16 a[214:215], v244 offset:4104
    v_mfma_f32_16x16x32_bf16 v[48:51], a[204:207], v[160:163], v[48:51]
    v_exp_f32_e64 v153, v153
    v_mfma_f32_16x16x32_bf16 v[52:55], a[204:207], v[164:167], v[52:55]
    ds_read_b64_tr_b16 a[216:217], v245 offset:0
    v_cvt_pk_bf16_f32 v186, v152, v153
    v_mfma_f32_16x16x32_bf16 v[56:59], a[204:207], v[168:171], v[56:59]
    s_waitcnt lgkmcnt(3)
    v_exp_f32 v154, v154
    v_mfma_f32_16x16x32_bf16 v[60:63], a[204:207], v[172:175], v[60:63]
    ds_read_b64_tr_b16 a[218:219], v245 offset:4096
    v_mfma_f32_16x16x32_bf16 v[64:67], a[208:211], v[160:163], v[64:67]
    v_exp_f32_e64 v155, v155
    v_mfma_f32_16x16x32_bf16 v[68:71], a[208:211], v[164:167], v[68:71]
    ds_read_b64_tr_b16 a[220:221], v245 offset:8
    v_cvt_pk_bf16_f32 v187, v154, v155
    v_mfma_f32_16x16x32_bf16 v[72:75], a[208:211], v[168:171], v[72:75]
    s_waitcnt lgkmcnt(3)
    v_exp_f32 v140, v140
    v_mfma_f32_16x16x32_bf16 v[76:79], a[208:211], v[172:175], v[76:79]
    ds_read_b64_tr_b16 a[222:223], v245 offset:4104
    v_mfma_f32_16x16x32_bf16 v[80:83], a[212:215], v[160:163], v[80:83]
    v_exp_f32_e64 v141, v141
    v_mfma_f32_16x16x32_bf16 v[84:87], a[212:215], v[164:167], v[84:87]
    ds_read_b128 a[128:131], v241 offset:49152
    v_cvt_pk_bf16_f32 v188, v140, v141
    v_mfma_f32_16x16x32_bf16 v[88:91], a[212:215], v[168:171], v[88:91]
    s_waitcnt lgkmcnt(3)
    v_exp_f32 v142, v142
    v_mfma_f32_16x16x32_bf16 v[92:95], a[212:215], v[172:175], v[92:95]
    ds_read_b128 a[132:135], v241 offset:50176
    v_mfma_f32_16x16x32_bf16 v[96:99], a[216:219], v[160:163], v[96:99]
    v_exp_f32_e64 v143, v143
    ds_read_b128 a[136:139], v241 offset:51200
    ds_read_b128 a[140:143], v241 offset:52224
    v_mfma_f32_16x16x32_bf16 v[100:103], a[216:219], v[164:167], v[100:103]
    ds_read_b128 a[144:147], v241 offset:53248
    v_cvt_pk_bf16_f32 v189, v142, v143
    v_mfma_f32_16x16x32_bf16 v[104:107], a[216:219], v[168:171], v[104:107]
    s_waitcnt lgkmcnt(5)
    v_exp_f32 v156, v156
    v_mfma_f32_16x16x32_bf16 v[108:111], a[216:219], v[172:175], v[108:111]
    ds_read_b128 a[148:151], v241 offset:54272
    v_mfma_f32_16x16x32_bf16 v[112:115], a[220:223], v[160:163], v[112:115]
    v_exp_f32_e64 v157, v157
    ds_read_b128 a[152:155], v241 offset:55296
    ds_read_b128 a[156:159], v241 offset:56320
    v_mfma_f32_16x16x32_bf16 v[116:119], a[220:223], v[164:167], v[116:119]
    ds_read_b64_tr_b16 a[192:193], v242 offset:8192
    v_cvt_pk_bf16_f32 v190, v156, v157
    v_mfma_f32_16x16x32_bf16 v[120:123], a[220:223], v[168:171], v[120:123]
    v_exp_f32_e64 v158, v158
    v_mfma_f32_16x16x32_bf16 v[124:127], a[220:223], v[172:175], v[124:127]
    ds_read_b64_tr_b16 a[194:195], v242 offset:12288
    s_waitcnt lgkmcnt(6)
    v_mfma_f32_16x16x32_bf16 v[128:131], a[128:131], a[0:3], v[192:195]
    v_exp_f32 v159, v159
    v_mfma_f32_16x16x32_bf16 v[128:131], a[132:135], a[4:7], v[128:131]
    ds_read_b64_tr_b16 a[196:197], v242 offset:8200
    v_cvt_pk_bf16_f32 v191, v158, v159
    v_mfma_f32_16x16x32_bf16 v[128:131], a[136:139], a[8:11], v[128:131]
    ds_read_b64_tr_b16 a[198:199], v242 offset:12296
    v_mfma_f32_16x16x32_bf16 v[128:131], a[140:143], a[12:15], v[128:131]
    ds_read_b64_tr_b16 a[200:201], v243 offset:8192
    s_waitcnt lgkmcnt(5)
    v_mfma_f32_16x16x32_bf16 v[144:147], a[144:147], a[0:3], v[192:195]
    ds_read_b64_tr_b16 a[202:203], v243 offset:12288
    v_mfma_f32_16x16x32_bf16 v[144:147], a[148:151], a[4:7], v[144:147]
    ds_read_b64_tr_b16 a[204:205], v243 offset:8200
    v_mfma_f32_16x16x32_bf16 v[144:147], a[152:155], a[8:11], v[144:147]
    ds_read_b64_tr_b16 a[206:207], v243 offset:12296
    v_mfma_f32_16x16x32_bf16 v[144:147], a[156:159], a[12:15], v[144:147]
    v_exp_f32 v128, v128
    v_mfma_f32_16x16x32_bf16 v[132:135], a[128:131], a[16:19], v[196:199]
    ds_read_b64_tr_b16 a[208:209], v244 offset:8192
    v_mfma_f32_16x16x32_bf16 v[132:135], a[132:135], a[20:23], v[132:135]
    v_exp_f32_e64 v129, v129
    v_mfma_f32_16x16x32_bf16 v[132:135], a[136:139], a[24:27], v[132:135]
    ds_read_b64_tr_b16 a[210:211], v244 offset:12288
    v_cvt_pk_bf16_f32 v160, v128, v129
    v_mfma_f32_16x16x32_bf16 v[132:135], a[140:143], a[28:31], v[132:135]
    v_exp_f32_e64 v130, v130
    v_mfma_f32_16x16x32_bf16 v[148:151], a[144:147], a[16:19], v[196:199]
    ds_read_b64_tr_b16 a[212:213], v244 offset:8200
    v_mfma_f32_16x16x32_bf16 v[148:151], a[148:151], a[20:23], v[148:151]
    v_exp_f32_e64 v131, v131
    v_mfma_f32_16x16x32_bf16 v[148:151], a[152:155], a[24:27], v[148:151]
    ds_read_b64_tr_b16 a[214:215], v244 offset:12296
    v_cvt_pk_bf16_f32 v161, v130, v131
    v_mfma_f32_16x16x32_bf16 v[148:151], a[156:159], a[28:31], v[148:151]
    v_exp_f32_e64 v144, v144
    v_mfma_f32_16x16x32_bf16 v[136:139], a[128:131], a[32:35], v[200:203]
    ds_read_b64_tr_b16 a[216:217], v245 offset:8192
    v_mfma_f32_16x16x32_bf16 v[136:139], a[132:135], a[36:39], v[136:139]
    v_exp_f32_e64 v145, v145
    v_mfma_f32_16x16x32_bf16 v[136:139], a[136:139], a[40:43], v[136:139]
    ds_read_b64_tr_b16 a[218:219], v245 offset:12288
    v_cvt_pk_bf16_f32 v162, v144, v145
    v_mfma_f32_16x16x32_bf16 v[136:139], a[140:143], a[44:47], v[136:139]
    v_exp_f32_e64 v146, v146
    v_mfma_f32_16x16x32_bf16 v[152:155], a[144:147], a[32:35], v[200:203]
    ds_read_b64_tr_b16 a[220:221], v245 offset:8200
    v_mfma_f32_16x16x32_bf16 v[152:155], a[148:151], a[36:39], v[152:155]
    v_exp_f32_e64 v147, v147
    v_mfma_f32_16x16x32_bf16 v[152:155], a[152:155], a[40:43], v[152:155]
    ds_read_b64_tr_b16 a[222:223], v245 offset:12296
    v_cvt_pk_bf16_f32 v163, v146, v147
    v_mfma_f32_16x16x32_bf16 v[152:155], a[156:159], a[44:47], v[152:155]
    v_exp_f32_e64 v132, v132
    v_mfma_f32_16x16x32_bf16 v[140:143], a[128:131], a[48:51], v[204:207]
    ds_read_b128 a[160:163], v241 offset:57344
    v_mfma_f32_16x16x32_bf16 v[140:143], a[132:135], a[52:55], v[140:143]
    v_exp_f32_e64 v133, v133
    v_mfma_f32_16x16x32_bf16 v[140:143], a[136:139], a[56:59], v[140:143]
    ds_read_b128 a[164:167], v241 offset:58368
    v_cvt_pk_bf16_f32 v164, v132, v133
    v_mfma_f32_16x16x32_bf16 v[140:143], a[140:143], a[60:63], v[140:143]
    v_exp_f32_e64 v134, v134
    v_mfma_f32_16x16x32_bf16 v[156:159], a[144:147], a[48:51], v[204:207]
    ds_read_b128 a[168:171], v241 offset:59392
    v_mfma_f32_16x16x32_bf16 v[156:159], a[148:151], a[52:55], v[156:159]
    v_exp_f32_e64 v135, v135
    v_mfma_f32_16x16x32_bf16 v[156:159], a[152:155], a[56:59], v[156:159]
    ds_read_b128 a[172:175], v241 offset:60416
    v_cvt_pk_bf16_f32 v165, v134, v135
    v_mfma_f32_16x16x32_bf16 v[156:159], a[156:159], a[60:63], v[156:159]
    v_exp_f32_e64 v148, v148
    v_mfma_f32_16x16x32_bf16 a[224:227], a[240:243], v[176:179], a[224:227]
    ds_read_b128 a[176:179], v241 offset:61440
    v_mfma_f32_16x16x32_bf16 a[228:231], a[240:243], v[180:183], a[228:231]
    s_waitcnt lgkmcnt(15)
    v_exp_f32 v149, v149
    v_mfma_f32_16x16x32_bf16 a[232:235], a[240:243], v[184:187], a[232:235]
    ds_read_b128 a[180:183], v241 offset:62464
    v_cvt_pk_bf16_f32 v166, v148, v149
    v_mfma_f32_16x16x32_bf16 a[236:239], a[240:243], v[188:191], a[236:239]
    v_exp_f32_e64 v150, v150
    v_mfma_f32_16x16x32_bf16 v[0:3], a[192:195], v[176:179], v[0:3]
    ds_read_b128 a[184:187], v241 offset:63488
    v_mfma_f32_16x16x32_bf16 v[4:7], a[192:195], v[180:183], v[4:7]
    s_waitcnt lgkmcnt(15)
    v_exp_f32 v151, v151
    v_mfma_f32_16x16x32_bf16 v[8:11], a[192:195], v[184:187], v[8:11]
    ds_read_b128 a[188:191], v241 offset:64512
    v_cvt_pk_bf16_f32 v167, v150, v151
    v_mfma_f32_16x16x32_bf16 v[12:15], a[192:195], v[188:191], v[12:15]
    v_exp_f32_e64 v136, v136
    v_mfma_f32_16x16x32_bf16 v[16:19], a[196:199], v[176:179], v[16:19]
    ds_read_b128 a[128:131], v240 offset:0
    v_mfma_f32_16x16x32_bf16 v[20:23], a[196:199], v[180:183], v[20:23]
    s_waitcnt lgkmcnt(15)
    v_exp_f32 v137, v137
    v_mfma_f32_16x16x32_bf16 v[24:27], a[196:199], v[184:187], v[24:27]
    ds_read_b128 a[132:135], v240 offset:1024
    v_cvt_pk_bf16_f32 v168, v136, v137
    v_mfma_f32_16x16x32_bf16 v[28:31], a[196:199], v[188:191], v[28:31]
    v_exp_f32_e64 v138, v138
    v_mfma_f32_16x16x32_bf16 v[32:35], a[200:203], v[176:179], v[32:35]
    ds_read_b128 a[136:139], v240 offset:2048
    v_mfma_f32_16x16x32_bf16 v[36:39], a[200:203], v[180:183], v[36:39]
    s_waitcnt lgkmcnt(15)
    v_exp_f32 v139, v139
    v_mfma_f32_16x16x32_bf16 v[40:43], a[200:203], v[184:187], v[40:43]
    ds_read_b128 a[140:143], v240 offset:3072
    v_cvt_pk_bf16_f32 v169, v138, v139
    v_mfma_f32_16x16x32_bf16 v[44:47], a[200:203], v[188:191], v[44:47]
    v_exp_f32_e64 v152, v152
    v_mfma_f32_16x16x32_bf16 v[48:51], a[204:207], v[176:179], v[48:51]
    ds_read_b128 a[144:147], v240 offset:4096
    v_mfma_f32_16x16x32_bf16 v[52:55], a[204:207], v[180:183], v[52:55]
    s_waitcnt lgkmcnt(15)
    v_exp_f32 v153, v153
    v_mfma_f32_16x16x32_bf16 v[56:59], a[204:207], v[184:187], v[56:59]
    ds_read_b128 a[148:151], v240 offset:5120
    v_cvt_pk_bf16_f32 v170, v152, v153
    v_mfma_f32_16x16x32_bf16 v[60:63], a[204:207], v[188:191], v[60:63]
    v_exp_f32_e64 v154, v154
    v_mfma_f32_16x16x32_bf16 v[64:67], a[208:211], v[176:179], v[64:67]
    ds_read_b128 a[152:155], v240 offset:6144
    v_mfma_f32_16x16x32_bf16 v[68:71], a[208:211], v[180:183], v[68:71]
    s_waitcnt lgkmcnt(15)
    v_exp_f32 v155, v155
    v_mfma_f32_16x16x32_bf16 v[72:75], a[208:211], v[184:187], v[72:75]
    ds_read_b128 a[156:159], v240 offset:7168
    v_cvt_pk_bf16_f32 v171, v154, v155
    v_mfma_f32_16x16x32_bf16 v[76:79], a[208:211], v[188:191], v[76:79]
    v_exp_f32_e64 v140, v140
    v_mfma_f32_16x16x32_bf16 v[80:83], a[212:215], v[176:179], v[80:83]
    v_mfma_f32_16x16x32_bf16 v[84:87], a[212:215], v[180:183], v[84:87]
    s_waitcnt lgkmcnt(15)
    v_exp_f32 v141, v141
    v_mfma_f32_16x16x32_bf16 v[88:91], a[212:215], v[184:187], v[88:91]
    v_cvt_pk_bf16_f32 v172, v140, v141
    v_mfma_f32_16x16x32_bf16 v[92:95], a[212:215], v[188:191], v[92:95]
    v_exp_f32_e64 v142, v142
    v_mfma_f32_16x16x32_bf16 v[96:99], a[216:219], v[176:179], v[96:99]
    v_mfma_f32_16x16x32_bf16 v[100:103], a[216:219], v[180:183], v[100:103]
    s_waitcnt lgkmcnt(15)
    v_exp_f32 v143, v143
    v_mfma_f32_16x16x32_bf16 v[104:107], a[216:219], v[184:187], v[104:107]
    v_cvt_pk_bf16_f32 v173, v142, v143
    v_mfma_f32_16x16x32_bf16 v[108:111], a[216:219], v[188:191], v[108:111]
    v_exp_f32_e64 v156, v156
    v_mfma_f32_16x16x32_bf16 v[112:115], a[220:223], v[176:179], v[112:115]
    v_mfma_f32_16x16x32_bf16 v[116:119], a[220:223], v[180:183], v[116:119]
    s_waitcnt lgkmcnt(12)
    v_exp_f32 v157, v157
    v_mfma_f32_16x16x32_bf16 v[120:123], a[220:223], v[184:187], v[120:123]
    v_cvt_pk_bf16_f32 v174, v156, v157
    v_mfma_f32_16x16x32_bf16 v[124:127], a[220:223], v[188:191], v[124:127]
    v_exp_f32_e64 v158, v158
    v_mfma_f32_16x16x32_bf16 v[128:131], a[160:163], a[0:3], v[192:195]
    v_mfma_f32_16x16x32_bf16 v[128:131], a[164:167], a[4:7], v[128:131]
    s_waitcnt lgkmcnt(8)
    v_exp_f32 v159, v159
    v_mfma_f32_16x16x32_bf16 v[128:131], a[168:171], a[8:11], v[128:131]
    s_waitcnt vmcnt(63)
    v_cvt_pk_bf16_f32 v175, v158, v159
    v_mfma_f32_16x16x32_bf16 v[128:131], a[172:175], a[12:15], v[128:131]
    v_mfma_f32_16x16x32_bf16 v[144:147], a[176:179], a[0:3], v[192:195]
    v_accvgpr_mov_b32 a0, a64
    v_accvgpr_mov_b32 a1, a65
    v_mfma_f32_16x16x32_bf16 v[144:147], a[180:183], a[4:7], v[144:147]
    v_accvgpr_mov_b32 a2, a66
    v_accvgpr_mov_b32 a3, a67
    v_mfma_f32_16x16x32_bf16 v[144:147], a[184:187], a[8:11], v[144:147]
    v_accvgpr_mov_b32 a4, a68
    v_accvgpr_mov_b32 a5, a69
    v_mfma_f32_16x16x32_bf16 v[144:147], a[188:191], a[12:15], v[144:147]
    v_exp_f32 v128, v128
    v_mfma_f32_16x16x32_bf16 v[132:135], a[160:163], a[16:19], v[196:199]
    s_waitcnt vmcnt(2)
    v_accvgpr_mov_b32 a6, a70
    v_accvgpr_mov_b32 a7, a71
    v_mfma_f32_16x16x32_bf16 v[132:135], a[164:167], a[20:23], v[132:135]
    v_exp_f32 v129, v129
    v_mfma_f32_16x16x32_bf16 v[132:135], a[168:171], a[24:27], v[132:135]
    s_barrier
    v_accvgpr_mov_b32 a8, a72
    v_mfma_f32_16x16x32_bf16 v[132:135], a[172:175], a[28:31], v[132:135]
    s_waitcnt vmcnt(63)
    v_exp_f32 v130, v130
    v_mfma_f32_16x16x32_bf16 v[148:151], a[176:179], a[16:19], v[196:199]
    buffer_load_dwordx4 v247, s[20:23], s39 offen offset:0 lds
    v_accvgpr_mov_b32 a16, a80
    v_mfma_f32_16x16x32_bf16 v[148:151], a[180:183], a[20:23], v[148:151]
    v_exp_f32 v131, v131
    v_mfma_f32_16x16x32_bf16 v[148:151], a[184:187], a[24:27], v[148:151]
    buffer_load_dwordx4 v247, s[20:23], s39 offen offset:1024 lds
    v_accvgpr_mov_b32 a17, a81
    v_mfma_f32_16x16x32_bf16 v[148:151], a[188:191], a[28:31], v[148:151]
    s_add_u32 m0, s40, 8192
    v_exp_f32 v132, v132
    v_mfma_f32_16x16x32_bf16 v[136:139], a[160:163], a[32:35], v[200:203]
    buffer_load_dwordx4 v247, s[20:23], s51 offen offset:0 lds
    v_accvgpr_mov_b32 a18, a82
    v_mfma_f32_16x16x32_bf16 v[136:139], a[164:167], a[36:39], v[136:139]
    v_exp_f32 v133, v133
    v_mfma_f32_16x16x32_bf16 v[136:139], a[168:171], a[40:43], v[136:139]
    buffer_load_dwordx4 v247, s[20:23], s51 offen offset:1024 lds
    v_accvgpr_mov_b32 a19, a83
    v_mfma_f32_16x16x32_bf16 v[136:139], a[172:175], a[44:47], v[136:139]
    s_waitcnt vmcnt(63)
    v_exp_f32_e64 v134, v134
    v_mfma_f32_16x16x32_bf16 v[152:155], a[176:179], a[32:35], v[200:203]
    ds_read_b64_tr_b16 a[192:193], v242 offset:16384
    v_accvgpr_mov_b32 a32, a96
    v_mfma_f32_16x16x32_bf16 v[152:155], a[180:183], a[36:39], v[152:155]
    v_exp_f32 v135, v135
    v_mfma_f32_16x16x32_bf16 v[152:155], a[184:187], a[40:43], v[152:155]
    ds_read_b64_tr_b16 a[194:195], v242 offset:20480
    v_accvgpr_mov_b32 a33, a97
    v_mfma_f32_16x16x32_bf16 v[152:155], a[188:191], a[44:47], v[152:155]
    v_exp_f32 v136, v136
    v_mfma_f32_16x16x32_bf16 v[140:143], a[160:163], a[48:51], v[204:207]
    ds_read_b64_tr_b16 a[196:197], v242 offset:16392
    v_accvgpr_mov_b32 a34, a98
    v_mfma_f32_16x16x32_bf16 v[140:143], a[164:167], a[52:55], v[140:143]
    v_exp_f32 v137, v137
    v_mfma_f32_16x16x32_bf16 v[140:143], a[168:171], a[56:59], v[140:143]
    ds_read_b64_tr_b16 a[198:199], v242 offset:20488
    v_accvgpr_mov_b32 a20, a84
    v_mfma_f32_16x16x32_bf16 v[140:143], a[172:175], a[60:63], v[140:143]
    s_waitcnt vmcnt(63)
    v_exp_f32_e64 v138, v138
    v_mfma_f32_16x16x32_bf16 v[156:159], a[176:179], a[48:51], v[204:207]
    ds_read_b64_tr_b16 a[200:201], v243 offset:16384
    v_accvgpr_mov_b32 a48, a112
    v_mfma_f32_16x16x32_bf16 v[156:159], a[180:183], a[52:55], v[156:159]
    v_exp_f32 v139, v139
    v_mfma_f32_16x16x32_bf16 v[156:159], a[184:187], a[56:59], v[156:159]
    ds_read_b64_tr_b16 a[202:203], v243 offset:20480
    v_accvgpr_mov_b32 a49, a113
    v_mfma_f32_16x16x32_bf16 v[156:159], a[188:191], a[60:63], v[156:159]
    v_exp_f32 v140, v140
    v_mfma_f32_16x16x32_bf16 a[224:227], a[240:243], v[160:163], a[224:227]
    ds_read_b64_tr_b16 a[204:205], v243 offset:16392
    v_accvgpr_mov_b32 a21, a85
    v_accvgpr_mov_b32 a35, a99
    v_mfma_f32_16x16x32_bf16 a[228:231], a[240:243], v[164:167], a[228:231]
    s_waitcnt lgkmcnt(5)
    v_exp_f32 v141, v141
    v_mfma_f32_16x16x32_bf16 a[232:235], a[240:243], v[168:171], a[232:235]
    ds_read_b64_tr_b16 a[206:207], v243 offset:20488
    v_accvgpr_mov_b32 a50, a114
    v_mfma_f32_16x16x32_bf16 a[236:239], a[240:243], v[172:175], a[236:239]
    v_exp_f32 v142, v142
    v_mfma_f32_16x16x32_bf16 v[0:3], a[192:195], v[160:163], v[0:3]
    ds_read_b64_tr_b16 a[208:209], v244 offset:16384
    v_accvgpr_mov_b32 a36, a100
    v_accvgpr_mov_b32 a22, a86
    v_mfma_f32_16x16x32_bf16 v[4:7], a[192:195], v[164:167], v[4:7]
    s_waitcnt lgkmcnt(5)
    v_exp_f32 v143, v143
    v_mfma_f32_16x16x32_bf16 v[8:11], a[192:195], v[168:171], v[8:11]
    ds_read_b64_tr_b16 a[210:211], v244 offset:20480
    v_accvgpr_mov_b32 a37, a101
    v_mfma_f32_16x16x32_bf16 v[12:15], a[192:195], v[172:175], v[12:15]
    v_exp_f32 v144, v144
    v_mfma_f32_16x16x32_bf16 v[16:19], a[196:199], v[160:163], v[16:19]
    ds_read_b64_tr_b16 a[212:213], v244 offset:16392
    v_accvgpr_mov_b32 a51, a115
    v_accvgpr_mov_b32 a23, a87
    v_mfma_f32_16x16x32_bf16 v[20:23], a[196:199], v[164:167], v[20:23]
    s_waitcnt lgkmcnt(5)
    v_exp_f32 v145, v145
    v_mfma_f32_16x16x32_bf16 v[24:27], a[196:199], v[168:171], v[24:27]
    ds_read_b64_tr_b16 a[214:215], v244 offset:20488
    v_accvgpr_mov_b32 a9, a73
    v_accvgpr_mov_b32 a52, a116
    v_mfma_f32_16x16x32_bf16 v[28:31], a[196:199], v[172:175], v[28:31]
    v_exp_f32_e64 v146, v146
    v_mfma_f32_16x16x32_bf16 v[32:35], a[200:203], v[160:163], v[32:35]
    ds_read_b64_tr_b16 a[216:217], v245 offset:16384
    v_accvgpr_mov_b32 a38, a102
    v_accvgpr_mov_b32 a10, a74
    v_mfma_f32_16x16x32_bf16 v[36:39], a[200:203], v[164:167], v[36:39]
    s_waitcnt lgkmcnt(5)
    v_exp_f32 v147, v147
    v_mfma_f32_16x16x32_bf16 v[40:43], a[200:203], v[168:171], v[40:43]
    ds_read_b64_tr_b16 a[218:219], v245 offset:20480
    v_accvgpr_mov_b32 a24, a88
    v_accvgpr_mov_b32 a53, a117
    v_mfma_f32_16x16x32_bf16 v[44:47], a[200:203], v[172:175], v[44:47]
    v_exp_f32_e64 v148, v148
    v_mfma_f32_16x16x32_bf16 v[48:51], a[204:207], v[160:163], v[48:51]
    ds_read_b64_tr_b16 a[220:221], v245 offset:16392
    v_accvgpr_mov_b32 a39, a103
    v_mfma_f32_16x16x32_bf16 v[52:55], a[204:207], v[164:167], v[52:55]
    s_waitcnt lgkmcnt(5)
    v_exp_f32_e64 v149, v149
    v_mfma_f32_16x16x32_bf16 v[56:59], a[204:207], v[168:171], v[56:59]
    ds_read_b64_tr_b16 a[222:223], v245 offset:20488
    v_accvgpr_mov_b32 a25, a89
    v_accvgpr_mov_b32 a11, a75
    v_mfma_f32_16x16x32_bf16 v[60:63], a[204:207], v[172:175], v[60:63]
    v_exp_f32_e64 v150, v150
    v_mfma_f32_16x16x32_bf16 v[64:67], a[208:211], v[160:163], v[64:67]
    ds_read_b64_tr_b16 a[192:193], v242 offset:24576
    v_accvgpr_mov_b32 a54, a118
    v_accvgpr_mov_b32 a26, a90
    v_mfma_f32_16x16x32_bf16 v[68:71], a[208:211], v[164:167], v[68:71]
    s_waitcnt lgkmcnt(5)
    v_exp_f32 v151, v151
    v_mfma_f32_16x16x32_bf16 v[72:75], a[208:211], v[168:171], v[72:75]
    ds_read_b64_tr_b16 a[194:195], v242 offset:28672
    v_accvgpr_mov_b32 a40, a104
    v_accvgpr_mov_b32 a12, a76
    v_mfma_f32_16x16x32_bf16 v[76:79], a[208:211], v[172:175], v[76:79]
    v_exp_f32_e64 v152, v152
    v_mfma_f32_16x16x32_bf16 v[80:83], a[212:215], v[160:163], v[80:83]
    ds_read_b64_tr_b16 a[196:197], v242 offset:24584
    v_accvgpr_mov_b32 a55, a119
    v_accvgpr_mov_b32 a41, a105
    v_mfma_f32_16x16x32_bf16 v[84:87], a[212:215], v[164:167], v[84:87]
    s_waitcnt lgkmcnt(5)
    v_exp_f32 v153, v153
    v_mfma_f32_16x16x32_bf16 v[88:91], a[212:215], v[168:171], v[88:91]
    ds_read_b64_tr_b16 a[198:199], v242 offset:28680
    v_accvgpr_mov_b32 a13, a77
    v_accvgpr_mov_b32 a27, a91
    v_mfma_f32_16x16x32_bf16 v[92:95], a[212:215], v[172:175], v[92:95]
    v_exp_f32_e64 v154, v154
    v_mfma_f32_16x16x32_bf16 v[96:99], a[216:219], v[160:163], v[96:99]
    ds_read_b64_tr_b16 a[200:201], v243 offset:24576
    v_cvt_pk_bf16_f32 v176, v128, v129
    v_cvt_pk_bf16_f32 v177, v130, v131
    v_mfma_f32_16x16x32_bf16 v[100:103], a[216:219], v[164:167], v[100:103]
    s_waitcnt lgkmcnt(5)
    v_exp_f32 v155, v155
    v_mfma_f32_16x16x32_bf16 v[104:107], a[216:219], v[168:171], v[104:107]
    ds_read_b64_tr_b16 a[202:203], v243 offset:28672
    v_accvgpr_mov_b32 a42, a106
    v_accvgpr_mov_b32 a56, a120
    v_mfma_f32_16x16x32_bf16 v[108:111], a[216:219], v[172:175], v[108:111]
    v_exp_f32_e64 v156, v156
    v_mfma_f32_16x16x32_bf16 v[112:115], a[220:223], v[160:163], v[112:115]
    ds_read_b64_tr_b16 a[204:205], v243 offset:24584
    v_accvgpr_mov_b32 a28, a92
    v_cvt_pk_bf16_f32 v180, v132, v133
    v_mfma_f32_16x16x32_bf16 v[116:119], a[220:223], v[164:167], v[116:119]
    s_waitcnt lgkmcnt(15)
    v_exp_f32_e64 v157, v157
    v_mfma_f32_16x16x32_bf16 v[120:123], a[220:223], v[168:171], v[120:123]
    ds_read_b64_tr_b16 a[206:207], v243 offset:28680
    v_cvt_pk_bf16_f32 v181, v134, v135
    v_accvgpr_mov_b32 a14, a78
    v_mfma_f32_16x16x32_bf16 v[124:127], a[220:223], v[172:175], v[124:127]
    v_exp_f32 v158, v158
    v_mfma_f32_16x16x32_bf16 v[128:131], a[128:131], a[64:67], 0
    ds_read_b64_tr_b16 a[208:209], v244 offset:24576
    v_accvgpr_mov_b32 a57, a121
    v_accvgpr_mov_b32 a29, a93
    v_mfma_f32_16x16x32_bf16 v[128:131], a[132:135], a[68:71], v[128:131]
    v_exp_f32_e64 v159, v159
    v_mfma_f32_16x16x32_bf16 v[128:131], a[136:139], a[72:75], v[128:131]
    ds_read_b64_tr_b16 a[210:211], v244 offset:28672
    v_accvgpr_mov_b32 a43, a107
    v_cvt_pk_bf16_f32 v184, v136, v137
    v_mfma_f32_16x16x32_bf16 v[128:131], a[140:143], a[76:79], v[128:131]
    ds_read_b64_tr_b16 a[212:213], v244 offset:24584
    v_cvt_pk_bf16_f32 v185, v138, v139
    v_accvgpr_mov_b32 a15, a79
    v_mfma_f32_16x16x32_bf16 v[132:135], a[128:131], a[80:83], 0
    ds_read_b64_tr_b16 a[214:215], v244 offset:28680
    v_accvgpr_mov_b32 a58, a122
    v_accvgpr_mov_b32 a44, a108
    v_mfma_f32_16x16x32_bf16 v[132:135], a[132:135], a[84:87], v[132:135]
    ds_read_b64_tr_b16 a[216:217], v245 offset:24576
    v_cvt_pk_bf16_f32 v188, v140, v141
    v_cvt_pk_bf16_f32 v189, v142, v143
    v_mfma_f32_16x16x32_bf16 v[132:135], a[136:139], a[88:91], v[132:135]
    ds_read_b64_tr_b16 a[218:219], v245 offset:28672
    v_accvgpr_mov_b32 a30, a94
    v_max3_f32 v216, v128, v129, v130
    v_mfma_f32_16x16x32_bf16 v[132:135], a[140:143], a[92:95], v[132:135]
    ds_read_b64_tr_b16 a[220:221], v245 offset:24584
    v_max_f32 v216, v216, v131
    v_mov_b32_e64 v217, v216
    v_mfma_f32_16x16x32_bf16 v[136:139], a[128:131], a[96:99], 0
    ds_read_b64_tr_b16 a[222:223], v245 offset:28680
    v_permlane16_swap_b32 v216, v217
    v_max_f32 v216, v216, v217
    v_mfma_f32_16x16x32_bf16 v[136:139], a[132:135], a[100:103], v[136:139]
    ds_read_b128 a[160:163], v240 offset:8192
    v_mov_b32 v217, v216
    v_accvgpr_mov_b32 a45, a109
    v_mfma_f32_16x16x32_bf16 v[136:139], a[136:139], a[104:107], v[136:139]
    ds_read_b128 a[164:167], v240 offset:9216
    v_accvgpr_mov_b32 a59, a123
    v_cvt_pk_bf16_f32 v178, v144, v145
    v_mfma_f32_16x16x32_bf16 v[136:139], a[140:143], a[108:111], v[136:139]
    ds_read_b128 a[168:171], v240 offset:10240
    v_cvt_pk_bf16_f32 v179, v146, v147
    v_permlane32_swap_b32 v216, v217
    v_mfma_f32_16x16x32_bf16 v[140:143], a[128:131], a[112:115], 0
    ds_read_b128 a[172:175], v240 offset:11264
    v_max_f32 v216, v216, v217
    v_sub_f32 v192, 0, v216
    v_mfma_f32_16x16x32_bf16 v[140:143], a[132:135], a[116:119], v[140:143]
    ds_read_b128 a[176:179], v240 offset:12288
    v_sub_f32 v193, 0, v216
    v_sub_f32 v194, 0, v216
    v_mfma_f32_16x16x32_bf16 v[140:143], a[136:139], a[120:123], v[140:143]
    ds_read_b128 a[180:183], v240 offset:13312
    v_sub_f32 v195, 0, v216
    v_accvgpr_mov_b32 a31, a95
    v_mfma_f32_16x16x32_bf16 v[140:143], a[140:143], a[124:127], v[140:143]
    ds_read_b128 a[184:187], v240 offset:14336
    v_max3_f32 v218, v132, v133, v134
    v_max_f32 v218, v218, v135
    s_waitcnt lgkmcnt(15)
    v_mfma_f32_16x16x32_bf16 v[144:147], a[144:147], a[64:67], v[192:195]
    ds_read_b128 a[188:191], v240 offset:15360
    v_mov_b32 v219, v218
    v_accvgpr_mov_b32 a60, a124
    v_mfma_f32_16x16x32_bf16 v[144:147], a[148:151], a[68:71], v[144:147]
    v_permlane16_swap_b32 v218, v219
    v_max_f32 v218, v218, v219
    v_mov_b32_e64 v219, v218
    v_mfma_f32_16x16x32_bf16 v[144:147], a[152:155], a[72:75], v[144:147]
    v_cvt_pk_bf16_f32 v182, v148, v149
    v_cvt_pk_bf16_f32 v183, v150, v151
    v_permlane32_swap_b32 v218, v219
    v_mfma_f32_16x16x32_bf16 v[144:147], a[156:159], a[76:79], v[144:147]
    v_max_f32 v218, v218, v219
    v_sub_f32 v196, 0, v218
    v_sub_f32 v197, 0, v218
    v_sub_f32 v198, 0, v218
    v_sub_f32 v199, 0, v218
    v_accvgpr_mov_b32 a46, a110
    s_nop 0
    v_mfma_f32_16x16x32_bf16 v[148:151], a[144:147], a[80:83], v[196:199]
    v_exp_f32_e64 v144, v144
    v_mfma_f32_16x16x32_bf16 v[148:151], a[148:151], a[84:87], v[148:151]
    v_max3_f32 v220, v136, v137, v138
    v_max_f32 v220, v220, v139
    v_mov_b32 v221, v220
    v_mfma_f32_16x16x32_bf16 v[148:151], a[152:155], a[88:91], v[148:151]
    v_exp_f32 v145, v145
    v_permlane16_swap_b32 v220, v221
    v_max_f32 v220, v220, v221
    v_mov_b32 v221, v220
    v_accvgpr_mov_b32 a61, a125
    v_mfma_f32_16x16x32_bf16 v[148:151], a[156:159], a[92:95], v[148:151]
    v_cvt_pk_bf16_f32 v186, v152, v153
    v_cvt_pk_bf16_f32 v187, v154, v155
    v_permlane32_swap_b32 v220, v221
    v_max_f32 v220, v220, v221
    v_sub_f32 v200, 0, v220
    v_sub_f32 v201, 0, v220
    v_sub_f32 v202, 0, v220
    v_sub_f32 v203, 0, v220
    v_accvgpr_mov_b32 a47, a111
    s_nop 0
    v_mfma_f32_16x16x32_bf16 v[152:155], a[144:147], a[96:99], v[200:203]
    v_exp_f32 v146, v146
    v_mfma_f32_16x16x32_bf16 v[152:155], a[148:151], a[100:103], v[152:155]
    v_max3_f32 v222, v140, v141, v142
    v_max_f32 v222, v222, v143
    v_mov_b32 v223, v222
    v_mfma_f32_16x16x32_bf16 v[152:155], a[152:155], a[104:107], v[152:155]
    v_exp_f32 v147, v147
    v_permlane16_swap_b32 v222, v223
    v_max_f32 v222, v222, v223
    v_mov_b32 v223, v222
    v_mfma_f32_16x16x32_bf16 v[152:155], a[156:159], a[108:111], v[152:155]
    v_cvt_pk_bf16_f32 v190, v156, v157
    v_cvt_pk_bf16_f32 v191, v158, v159
    v_permlane32_swap_b32 v222, v223
    v_max_f32 v222, v222, v223
    v_sub_f32 v204, 0, v222
    v_sub_f32 v205, 0, v222
    v_sub_f32 v206, 0, v222
    v_sub_f32 v207, 0, v222
    v_accvgpr_mov_b32 a62, a126
    s_nop 0
    v_mfma_f32_16x16x32_bf16 v[156:159], a[144:147], a[112:115], v[204:207]
    v_exp_f32_e64 v148, v148
    v_mfma_f32_16x16x32_bf16 v[156:159], a[148:151], a[116:119], v[156:159]
    v_accvgpr_mov_b32 a63, a127
    v_sub_f32 v128, v128, v216
    v_mfma_f32_16x16x32_bf16 v[156:159], a[152:155], a[120:123], v[156:159]
    v_exp_f32_e64 v128, v128
    v_mfma_f32_16x16x32_bf16 v[156:159], a[156:159], a[124:127], v[156:159]
    v_sub_f32 v129, v129, v216
    v_sub_f32 v130, v130, v216
    v_mfma_f32_16x16x32_bf16 a[224:227], a[240:243], v[176:179], a[224:227]
    v_exp_f32_e64 v129, v129
    v_mfma_f32_16x16x32_bf16 a[228:231], a[240:243], v[180:183], a[228:231]
    s_waitcnt lgkmcnt(15)
    v_sub_f32 v131, v131, v216
    v_sub_f32_e64 v132, v132, v218
    v_mfma_f32_16x16x32_bf16 a[232:235], a[240:243], v[184:187], a[232:235]
    v_exp_f32_e64 v130, v130
    v_mfma_f32_16x16x32_bf16 a[236:239], a[240:243], v[188:191], a[236:239]
    v_sub_f32 v133, v133, v218
    v_sub_f32 v134, v134, v218
    v_mfma_f32_16x16x32_bf16 v[0:3], a[192:195], v[176:179], v[0:3]
    v_exp_f32_e64 v131, v131
    v_mfma_f32_16x16x32_bf16 v[4:7], a[192:195], v[180:183], v[4:7]
    s_waitcnt lgkmcnt(15)
    v_sub_f32 v135, v135, v218
    v_sub_f32_e64 v136, v136, v220
    v_mfma_f32_16x16x32_bf16 v[8:11], a[192:195], v[184:187], v[8:11]
    s_waitcnt vmcnt(4)
    v_exp_f32 v132, v132
    v_mfma_f32_16x16x32_bf16 v[12:15], a[192:195], v[188:191], v[12:15]
    v_sub_f32 v137, v137, v220
    v_sub_f32 v138, v138, v220
    v_mfma_f32_16x16x32_bf16 v[16:19], a[196:199], v[176:179], v[16:19]
    v_exp_f32_e64 v133, v133
    v_mfma_f32_16x16x32_bf16 v[20:23], a[196:199], v[180:183], v[20:23]
    s_waitcnt lgkmcnt(15)
    v_sub_f32 v139, v139, v220
    v_sub_f32_e64 v140, v140, v222
    v_mfma_f32_16x16x32_bf16 v[24:27], a[196:199], v[184:187], v[24:27]
    v_exp_f32_e64 v134, v134
    v_mfma_f32_16x16x32_bf16 v[28:31], a[196:199], v[188:191], v[28:31]
    v_sub_f32 v141, v141, v222
    v_sub_f32 v142, v142, v222
    v_mfma_f32_16x16x32_bf16 v[32:35], a[200:203], v[176:179], v[32:35]
    v_exp_f32_e64 v135, v135
    v_mfma_f32_16x16x32_bf16 v[36:39], a[200:203], v[180:183], v[36:39]
    s_waitcnt lgkmcnt(15)
    v_sub_f32 v143, v143, v222
    v_cvt_pk_bf16_f32 v160, v128, v129
    v_mfma_f32_16x16x32_bf16 v[40:43], a[200:203], v[184:187], v[40:43]
    v_exp_f32_e64 v149, v149
    v_mfma_f32_16x16x32_bf16 v[44:47], a[200:203], v[188:191], v[44:47]
    v_cvt_pk_bf16_f32 v161, v130, v131
    v_cvt_pk_bf16_f32 v162, v144, v145
    v_mfma_f32_16x16x32_bf16 v[48:51], a[204:207], v[176:179], v[48:51]
    v_exp_f32_e64 v150, v150
    v_mfma_f32_16x16x32_bf16 v[52:55], a[204:207], v[180:183], v[52:55]
    s_waitcnt lgkmcnt(14)
    v_cvt_pk_bf16_f32 v163, v146, v147
    v_cvt_pk_bf16_f32 v164, v132, v133
    v_mfma_f32_16x16x32_bf16 v[56:59], a[204:207], v[184:187], v[56:59]
    v_exp_f32 v151, v151
    v_mfma_f32_16x16x32_bf16 v[60:63], a[204:207], v[188:191], v[60:63]
    v_cvt_pk_bf16_f32 v165, v134, v135
    v_cvt_pk_bf16_f32 v166, v148, v149
    v_mfma_f32_16x16x32_bf16 v[64:67], a[208:211], v[176:179], v[64:67]
    v_exp_f32_e64 v136, v136
    v_mfma_f32_16x16x32_bf16 v[68:71], a[208:211], v[180:183], v[68:71]
    s_waitcnt lgkmcnt(12)
    v_cvt_pk_bf16_f32 v167, v150, v151
    v_accvgpr_read_b32 v224, a224
    v_mfma_f32_16x16x32_bf16 v[72:75], a[208:211], v[184:187], v[72:75]
    v_exp_f32 v137, v137
    v_mfma_f32_16x16x32_bf16 v[76:79], a[208:211], v[188:191], v[76:79]
    v_cvt_pk_bf16_f32 v168, v136, v137
    v_cmp_nle_f32 vcc, v224, v255
    v_mfma_f32_16x16x32_bf16 v[80:83], a[212:215], v[176:179], v[80:83]
    v_exp_f32 v138, v138
    v_mfma_f32_16x16x32_bf16 v[84:87], a[212:215], v[180:183], v[84:87]
    s_waitcnt lgkmcnt(10)
    v_accvgpr_read_b32 v226, a228
    v_accvgpr_read_b32 v228, a232
    v_mfma_f32_16x16x32_bf16 v[88:91], a[212:215], v[184:187], v[88:91]
    s_or_b64 s[42:43], s[42:43], vcc
    v_exp_f32_e64 v139, v139
    v_mfma_f32_16x16x32_bf16 v[92:95], a[212:215], v[188:191], v[92:95]
    v_cvt_pk_bf16_f32 v169, v138, v139
    v_cmp_nle_f32 vcc, v226, v255
    v_mfma_f32_16x16x32_bf16 v[96:99], a[216:219], v[176:179], v[96:99]
    v_exp_f32 v152, v152
    v_mfma_f32_16x16x32_bf16 v[100:103], a[216:219], v[180:183], v[100:103]
    s_waitcnt lgkmcnt(8)
    v_accvgpr_read_b32 v230, a236
    v_mfma_f32_16x16x32_bf16 v[104:107], a[216:219], v[184:187], v[104:107]
    s_or_b64 s[42:43], s[42:43], vcc
    v_exp_f32_e64 v153, v153
    v_mfma_f32_16x16x32_bf16 v[108:111], a[216:219], v[188:191], v[108:111]
    v_cvt_pk_bf16_f32 v170, v152, v153
    v_cmp_nle_f32 vcc, v228, v255
    v_mfma_f32_16x16x32_bf16 v[112:115], a[220:223], v[176:179], v[112:115]
    v_exp_f32 v154, v154
    v_mfma_f32_16x16x32_bf16 v[116:119], a[220:223], v[180:183], v[116:119]
    v_mfma_f32_16x16x32_bf16 v[120:123], a[220:223], v[184:187], v[120:123]
    s_or_b64 s[42:43], s[42:43], vcc
    v_exp_f32 v155, v155
    v_mfma_f32_16x16x32_bf16 v[124:127], a[220:223], v[188:191], v[124:127]
    v_cvt_pk_bf16_f32 v171, v154, v155
    v_cmp_nle_f32 vcc, v230, v255
    v_exp_f32 v140, v140
    v_exp_f32 v141, v141
    v_exp_f32 v142, v142
    v_cvt_pk_bf16_f32 v172, v140, v141
    v_exp_f32 v143, v143
    v_exp_f32 v156, v156
    v_cvt_pk_bf16_f32 v173, v142, v143
    v_exp_f32 v157, v157
    v_exp_f32 v158, v158
    v_cvt_pk_bf16_f32 v174, v156, v157
    v_exp_f32 v159, v159
    s_waitcnt lgkmcnt(4)
    v_cvt_pk_bf16_f32 v175, v158, v159
    s_waitcnt lgkmcnt(0)
    v_rcp_f32 v248, v224
    v_rcp_f32 v249, v226
    v_rcp_f32 v250, v228
    v_rcp_f32 v251, v230
    s_or_b64 s[42:43], s[42:43], vcc
    v_pk_mul_f32 v[0:1], v[0:1], v[248:249] op_sel:[0,0] op_sel_hi:[1,0]
    v_pk_mul_f32 v[2:3], v[2:3], v[248:249] op_sel:[0,0] op_sel_hi:[1,0]
    v_cvt_pk_bf16_f32 v232, v0, v1
    v_cvt_pk_bf16_f32 v233, v2, v3
    v_pk_mul_f32 v[16:17], v[16:17], v[248:249] op_sel:[0,0] op_sel_hi:[1,0]
    v_pk_mul_f32 v[18:19], v[18:19], v[248:249] op_sel:[0,0] op_sel_hi:[1,0]
    v_cvt_pk_bf16_f32 v234, v16, v17
    v_cvt_pk_bf16_f32 v235, v18, v19
    v_accvgpr_write_b32 a64, v232
    v_accvgpr_write_b32 a65, v233
    v_accvgpr_write_b32 a66, v234
    v_accvgpr_write_b32 a67, v235
    v_pk_mul_f32 v[4:5], v[4:5], v[248:249] op_sel:[0,1] op_sel_hi:[1,1]
    v_pk_mul_f32 v[6:7], v[6:7], v[248:249] op_sel:[0,1] op_sel_hi:[1,1]
    v_cvt_pk_bf16_f32 v236, v4, v5
    v_cvt_pk_bf16_f32 v237, v6, v7
    v_pk_mul_f32 v[20:21], v[20:21], v[248:249] op_sel:[0,1] op_sel_hi:[1,1]
    v_pk_mul_f32 v[22:23], v[22:23], v[248:249] op_sel:[0,1] op_sel_hi:[1,1]
    v_cvt_pk_bf16_f32 v238, v20, v21
    v_cvt_pk_bf16_f32 v239, v22, v23
    v_accvgpr_write_b32 a68, v236
    v_accvgpr_write_b32 a69, v237
    v_accvgpr_write_b32 a70, v238
    v_accvgpr_write_b32 a71, v239
    v_pk_mul_f32 v[8:9], v[8:9], v[250:251] op_sel:[0,0] op_sel_hi:[1,0]
    v_pk_mul_f32 v[10:11], v[10:11], v[250:251] op_sel:[0,0] op_sel_hi:[1,0]
    v_cvt_pk_bf16_f32 v232, v8, v9
    v_cvt_pk_bf16_f32 v233, v10, v11
    v_pk_mul_f32 v[24:25], v[24:25], v[250:251] op_sel:[0,0] op_sel_hi:[1,0]
    v_pk_mul_f32 v[26:27], v[26:27], v[250:251] op_sel:[0,0] op_sel_hi:[1,0]
    v_cvt_pk_bf16_f32 v234, v24, v25
    v_cvt_pk_bf16_f32 v235, v26, v27
    v_accvgpr_write_b32 a72, v232
    v_accvgpr_write_b32 a73, v233
    v_accvgpr_write_b32 a74, v234
    v_accvgpr_write_b32 a75, v235
    v_pk_mul_f32 v[12:13], v[12:13], v[250:251] op_sel:[0,1] op_sel_hi:[1,1]
    v_pk_mul_f32 v[14:15], v[14:15], v[250:251] op_sel:[0,1] op_sel_hi:[1,1]
    v_cvt_pk_bf16_f32 v236, v12, v13
    v_cvt_pk_bf16_f32 v237, v14, v15
    v_pk_mul_f32 v[28:29], v[28:29], v[250:251] op_sel:[0,1] op_sel_hi:[1,1]
    v_pk_mul_f32 v[30:31], v[30:31], v[250:251] op_sel:[0,1] op_sel_hi:[1,1]
    v_cvt_pk_bf16_f32 v238, v28, v29
    v_cvt_pk_bf16_f32 v239, v30, v31
    v_accvgpr_write_b32 a76, v236
    v_accvgpr_write_b32 a77, v237
    v_accvgpr_write_b32 a78, v238
    v_accvgpr_write_b32 a79, v239
    v_pk_mul_f32 v[32:33], v[32:33], v[248:249] op_sel:[0,0] op_sel_hi:[1,0]
    v_pk_mul_f32 v[34:35], v[34:35], v[248:249] op_sel:[0,0] op_sel_hi:[1,0]
    v_cvt_pk_bf16_f32 v232, v32, v33
    v_cvt_pk_bf16_f32 v233, v34, v35
    v_pk_mul_f32 v[48:49], v[48:49], v[248:249] op_sel:[0,0] op_sel_hi:[1,0]
    v_pk_mul_f32 v[50:51], v[50:51], v[248:249] op_sel:[0,0] op_sel_hi:[1,0]
    v_cvt_pk_bf16_f32 v234, v48, v49
    v_cvt_pk_bf16_f32 v235, v50, v51
    v_accvgpr_write_b32 a80, v232
    v_accvgpr_write_b32 a81, v233
    v_accvgpr_write_b32 a82, v234
    v_accvgpr_write_b32 a83, v235
    v_pk_mul_f32 v[36:37], v[36:37], v[248:249] op_sel:[0,1] op_sel_hi:[1,1]
    v_pk_mul_f32 v[38:39], v[38:39], v[248:249] op_sel:[0,1] op_sel_hi:[1,1]
    v_cvt_pk_bf16_f32 v236, v36, v37
    v_cvt_pk_bf16_f32 v237, v38, v39
    v_pk_mul_f32 v[52:53], v[52:53], v[248:249] op_sel:[0,1] op_sel_hi:[1,1]
    v_pk_mul_f32 v[54:55], v[54:55], v[248:249] op_sel:[0,1] op_sel_hi:[1,1]
    v_cvt_pk_bf16_f32 v238, v52, v53
    v_cvt_pk_bf16_f32 v239, v54, v55
    v_accvgpr_write_b32 a84, v236
    v_accvgpr_write_b32 a85, v237
    v_accvgpr_write_b32 a86, v238
    v_accvgpr_write_b32 a87, v239
    v_pk_mul_f32 v[40:41], v[40:41], v[250:251] op_sel:[0,0] op_sel_hi:[1,0]
    v_pk_mul_f32 v[42:43], v[42:43], v[250:251] op_sel:[0,0] op_sel_hi:[1,0]
    v_cvt_pk_bf16_f32 v232, v40, v41
    v_cvt_pk_bf16_f32 v233, v42, v43
    v_pk_mul_f32 v[56:57], v[56:57], v[250:251] op_sel:[0,0] op_sel_hi:[1,0]
    v_pk_mul_f32 v[58:59], v[58:59], v[250:251] op_sel:[0,0] op_sel_hi:[1,0]
    v_cvt_pk_bf16_f32 v234, v56, v57
    v_cvt_pk_bf16_f32 v235, v58, v59
    v_accvgpr_write_b32 a88, v232
    v_accvgpr_write_b32 a89, v233
    v_accvgpr_write_b32 a90, v234
    v_accvgpr_write_b32 a91, v235
    v_pk_mul_f32 v[44:45], v[44:45], v[250:251] op_sel:[0,1] op_sel_hi:[1,1]
    v_pk_mul_f32 v[46:47], v[46:47], v[250:251] op_sel:[0,1] op_sel_hi:[1,1]
    v_cvt_pk_bf16_f32 v236, v44, v45
    v_cvt_pk_bf16_f32 v237, v46, v47
    v_pk_mul_f32 v[60:61], v[60:61], v[250:251] op_sel:[0,1] op_sel_hi:[1,1]
    v_pk_mul_f32 v[62:63], v[62:63], v[250:251] op_sel:[0,1] op_sel_hi:[1,1]
    v_cvt_pk_bf16_f32 v238, v60, v61
    v_cvt_pk_bf16_f32 v239, v62, v63
    v_accvgpr_write_b32 a92, v236
    v_accvgpr_write_b32 a93, v237
    v_accvgpr_write_b32 a94, v238
    v_accvgpr_write_b32 a95, v239
    v_pk_mul_f32 v[64:65], v[64:65], v[248:249] op_sel:[0,0] op_sel_hi:[1,0]
    v_pk_mul_f32 v[66:67], v[66:67], v[248:249] op_sel:[0,0] op_sel_hi:[1,0]
    v_cvt_pk_bf16_f32 v232, v64, v65
    v_cvt_pk_bf16_f32 v233, v66, v67
    v_pk_mul_f32 v[80:81], v[80:81], v[248:249] op_sel:[0,0] op_sel_hi:[1,0]
    v_pk_mul_f32 v[82:83], v[82:83], v[248:249] op_sel:[0,0] op_sel_hi:[1,0]
    v_cvt_pk_bf16_f32 v234, v80, v81
    v_cvt_pk_bf16_f32 v235, v82, v83
    v_accvgpr_write_b32 a96, v232
    v_accvgpr_write_b32 a97, v233
    v_accvgpr_write_b32 a98, v234
    v_accvgpr_write_b32 a99, v235
    v_pk_mul_f32 v[68:69], v[68:69], v[248:249] op_sel:[0,1] op_sel_hi:[1,1]
    v_pk_mul_f32 v[70:71], v[70:71], v[248:249] op_sel:[0,1] op_sel_hi:[1,1]
    v_cvt_pk_bf16_f32 v236, v68, v69
    v_cvt_pk_bf16_f32 v237, v70, v71
    v_pk_mul_f32 v[84:85], v[84:85], v[248:249] op_sel:[0,1] op_sel_hi:[1,1]
    v_pk_mul_f32 v[86:87], v[86:87], v[248:249] op_sel:[0,1] op_sel_hi:[1,1]
    v_cvt_pk_bf16_f32 v238, v84, v85
    v_cvt_pk_bf16_f32 v239, v86, v87
    v_accvgpr_write_b32 a100, v236
    v_accvgpr_write_b32 a101, v237
    v_accvgpr_write_b32 a102, v238
    v_accvgpr_write_b32 a103, v239
    v_pk_mul_f32 v[72:73], v[72:73], v[250:251] op_sel:[0,0] op_sel_hi:[1,0]
    v_pk_mul_f32 v[74:75], v[74:75], v[250:251] op_sel:[0,0] op_sel_hi:[1,0]
    v_cvt_pk_bf16_f32 v232, v72, v73
    v_cvt_pk_bf16_f32 v233, v74, v75
    v_pk_mul_f32 v[88:89], v[88:89], v[250:251] op_sel:[0,0] op_sel_hi:[1,0]
    v_pk_mul_f32 v[90:91], v[90:91], v[250:251] op_sel:[0,0] op_sel_hi:[1,0]
    v_cvt_pk_bf16_f32 v234, v88, v89
    v_cvt_pk_bf16_f32 v235, v90, v91
    v_accvgpr_write_b32 a104, v232
    v_accvgpr_write_b32 a105, v233
    v_accvgpr_write_b32 a106, v234
    v_accvgpr_write_b32 a107, v235
    v_pk_mul_f32 v[76:77], v[76:77], v[250:251] op_sel:[0,1] op_sel_hi:[1,1]
    v_pk_mul_f32 v[78:79], v[78:79], v[250:251] op_sel:[0,1] op_sel_hi:[1,1]
    v_cvt_pk_bf16_f32 v236, v76, v77
    v_cvt_pk_bf16_f32 v237, v78, v79
    v_pk_mul_f32 v[92:93], v[92:93], v[250:251] op_sel:[0,1] op_sel_hi:[1,1]
    v_pk_mul_f32 v[94:95], v[94:95], v[250:251] op_sel:[0,1] op_sel_hi:[1,1]
    v_cvt_pk_bf16_f32 v238, v92, v93
    v_cvt_pk_bf16_f32 v239, v94, v95
    v_accvgpr_write_b32 a108, v236
    v_accvgpr_write_b32 a109, v237
    v_accvgpr_write_b32 a110, v238
    v_accvgpr_write_b32 a111, v239
    v_pk_mul_f32 v[96:97], v[96:97], v[248:249] op_sel:[0,0] op_sel_hi:[1,0]
    v_pk_mul_f32 v[98:99], v[98:99], v[248:249] op_sel:[0,0] op_sel_hi:[1,0]
    v_cvt_pk_bf16_f32 v232, v96, v97
    v_cvt_pk_bf16_f32 v233, v98, v99
    v_pk_mul_f32 v[112:113], v[112:113], v[248:249] op_sel:[0,0] op_sel_hi:[1,0]
    v_pk_mul_f32 v[114:115], v[114:115], v[248:249] op_sel:[0,0] op_sel_hi:[1,0]
    v_cvt_pk_bf16_f32 v234, v112, v113
    v_cvt_pk_bf16_f32 v235, v114, v115
    v_accvgpr_write_b32 a112, v232
    v_accvgpr_write_b32 a113, v233
    v_accvgpr_write_b32 a114, v234
    v_accvgpr_write_b32 a115, v235
    v_pk_mul_f32 v[100:101], v[100:101], v[248:249] op_sel:[0,1] op_sel_hi:[1,1]
    v_pk_mul_f32 v[102:103], v[102:103], v[248:249] op_sel:[0,1] op_sel_hi:[1,1]
    v_cvt_pk_bf16_f32 v236, v100, v101
    v_cvt_pk_bf16_f32 v237, v102, v103
    v_pk_mul_f32 v[116:117], v[116:117], v[248:249] op_sel:[0,1] op_sel_hi:[1,1]
    v_pk_mul_f32 v[118:119], v[118:119], v[248:249] op_sel:[0,1] op_sel_hi:[1,1]
    v_cvt_pk_bf16_f32 v238, v116, v117
    v_cvt_pk_bf16_f32 v239, v118, v119
    v_accvgpr_write_b32 a116, v236
    v_accvgpr_write_b32 a117, v237
    v_accvgpr_write_b32 a118, v238
    v_accvgpr_write_b32 a119, v239
    v_pk_mul_f32 v[104:105], v[104:105], v[250:251] op_sel:[0,0] op_sel_hi:[1,0]
    v_pk_mul_f32 v[106:107], v[106:107], v[250:251] op_sel:[0,0] op_sel_hi:[1,0]
    v_cvt_pk_bf16_f32 v232, v104, v105
    v_cvt_pk_bf16_f32 v233, v106, v107
    v_pk_mul_f32 v[120:121], v[120:121], v[250:251] op_sel:[0,0] op_sel_hi:[1,0]
    v_pk_mul_f32 v[122:123], v[122:123], v[250:251] op_sel:[0,0] op_sel_hi:[1,0]
    v_cvt_pk_bf16_f32 v234, v120, v121
    v_cvt_pk_bf16_f32 v235, v122, v123
    v_accvgpr_write_b32 a120, v232
    v_accvgpr_write_b32 a121, v233
    v_accvgpr_write_b32 a122, v234
    v_accvgpr_write_b32 a123, v235
    v_pk_mul_f32 v[108:109], v[108:109], v[250:251] op_sel:[0,1] op_sel_hi:[1,1]
    v_pk_mul_f32 v[110:111], v[110:111], v[250:251] op_sel:[0,1] op_sel_hi:[1,1]
    v_cvt_pk_bf16_f32 v236, v108, v109
    v_cvt_pk_bf16_f32 v237, v110, v111
    v_pk_mul_f32 v[124:125], v[124:125], v[250:251] op_sel:[0,1] op_sel_hi:[1,1]
    v_pk_mul_f32 v[126:127], v[126:127], v[250:251] op_sel:[0,1] op_sel_hi:[1,1]
    v_cvt_pk_bf16_f32 v238, v124, v125
    v_cvt_pk_bf16_f32 v239, v126, v127
    v_accvgpr_write_b32 a124, v236
    v_accvgpr_write_b32 a125, v237
    v_accvgpr_write_b32 a126, v238
    v_accvgpr_write_b32 a127, v239
    s_mov_b32 s29, 1
.p2align 6
L_pass:
    v_mfma_f32_16x16x32_bf16 v[128:131], a[160:163], a[0:3], v[192:195]
    ds_read_b128 a[128:131], v240 offset:16384
    v_mfma_f32_16x16x32_bf16 v[128:131], a[164:167], a[4:7], v[128:131]
    ds_read_b128 a[132:135], v240 offset:17408
    v_mfma_f32_16x16x32_bf16 v[128:131], a[168:171], a[8:11], v[128:131]
    ds_read_b128 a[136:139], v240 offset:18432
    v_mfma_f32_16x16x32_bf16 v[128:131], a[172:175], a[12:15], v[128:131]
    ds_read_b128 a[140:143], v240 offset:19456
    v_mfma_f32_16x16x32_bf16 v[144:147], a[176:179], a[0:3], v[192:195]
    ds_read_b128 a[144:147], v240 offset:20480
    v_mfma_f32_16x16x32_bf16 v[144:147], a[180:183], a[4:7], v[144:147]
    ds_read_b128 a[148:151], v240 offset:21504
    v_mfma_f32_16x16x32_bf16 v[144:147], a[184:187], a[8:11], v[144:147]
    ds_read_b128 a[152:155], v240 offset:22528
    v_mfma_f32_16x16x32_bf16 v[144:147], a[188:191], a[12:15], v[144:147]
    s_add_u32 m0, s40, 16384
    v_exp_f32_e64 v128, v128
    v_mfma_f32_16x16x32_bf16 v[132:135], a[160:163], a[16:19], v[196:199]
    ds_read_b128 a[156:159], v240 offset:23552
    v_mfma_f32_16x16x32_bf16 v[132:135], a[164:167], a[20:23], v[132:135]
    s_waitcnt vmcnt(0)
    v_exp_f32 v129, v129
    v_mfma_f32_16x16x32_bf16 v[132:135], a[168:171], a[24:27], v[132:135]
    s_barrier
    v_cvt_pk_bf16_f32 v176, v128, v129
    v_mfma_f32_16x16x32_bf16 v[132:135], a[172:175], a[28:31], v[132:135]
    s_add_u32 s39, s38, 16384
    v_exp_f32 v130, v130
    v_mfma_f32_16x16x32_bf16 v[148:151], a[176:179], a[16:19], v[196:199]
    buffer_load_dwordx4 v247, s[20:23], s39 offen offset:0 lds
    v_mfma_f32_16x16x32_bf16 v[148:151], a[180:183], a[20:23], v[148:151]
    s_add_u32 s51, s38, 24576
    v_exp_f32_e64 v131, v131
    v_mfma_f32_16x16x32_bf16 v[148:151], a[184:187], a[24:27], v[148:151]
    buffer_load_dwordx4 v247, s[20:23], s39 offen offset:1024 lds
    v_cvt_pk_bf16_f32 v177, v130, v131
    v_mfma_f32_16x16x32_bf16 v[148:151], a[188:191], a[28:31], v[148:151]
    s_add_u32 m0, s40, 24576
    v_exp_f32_e64 v144, v144
    v_mfma_f32_16x16x32_bf16 v[136:139], a[160:163], a[32:35], v[200:203]
    buffer_load_dwordx4 v247, s[20:23], s51 offen offset:0 lds
    v_mfma_f32_16x16x32_bf16 v[136:139], a[164:167], a[36:39], v[136:139]
    s_add_u32 s39, s38, 32768
    v_exp_f32_e64 v145, v145
    v_mfma_f32_16x16x32_bf16 v[136:139], a[168:171], a[40:43], v[136:139]
    buffer_load_dwordx4 v247, s[20:23], s51 offen offset:1024 lds
    v_cvt_pk_bf16_f32 v178, v144, v145
    v_mfma_f32_16x16x32_bf16 v[136:139], a[172:175], a[44:47], v[136:139]
    s_add_u32 m0, s40, 0
    v_exp_f32 v146, v146
    v_mfma_f32_16x16x32_bf16 v[152:155], a[176:179], a[32:35], v[200:203]
    ds_read_b64_tr_b16 a[192:193], v242 offset:0
    v_mfma_f32_16x16x32_bf16 v[152:155], a[180:183], a[36:39], v[152:155]
    s_add_u32 s51, s38, 40960
    v_exp_f32_e64 v147, v147
    v_mfma_f32_16x16x32_bf16 v[152:155], a[184:187], a[40:43], v[152:155]
    ds_read_b64_tr_b16 a[194:195], v242 offset:4096
    v_cvt_pk_bf16_f32 v179, v146, v147
    v_mfma_f32_16x16x32_bf16 v[152:155], a[188:191], a[44:47], v[152:155]
    s_add_u32 s44, s44, 256
    v_exp_f32_e64 v132, v132
    v_mfma_f32_16x16x32_bf16 v[140:143], a[160:163], a[48:51], v[204:207]
    buffer_store_dwordx4 a[64:67], v246, s[24:27], s66 offen offset:0 sc1
    v_mfma_f32_16x16x32_bf16 v[140:143], a[164:167], a[52:55], v[140:143]
    v_exp_f32_e64 v133, v133
    v_mfma_f32_16x16x32_bf16 v[140:143], a[168:171], a[56:59], v[140:143]
    ds_read_b64_tr_b16 a[196:197], v242 offset:8
    v_cvt_pk_bf16_f32 v180, v132, v133
    v_mfma_f32_16x16x32_bf16 v[140:143], a[172:175], a[60:63], v[140:143]
    v_exp_f32_e64 v134, v134
    v_mfma_f32_16x16x32_bf16 v[156:159], a[176:179], a[48:51], v[204:207]
    ds_read_b64_tr_b16 a[198:199], v242 offset:4104
    v_mfma_f32_16x16x32_bf16 v[156:159], a[180:183], a[52:55], v[156:159]
    v_exp_f32_e64 v135, v135
    v_mfma_f32_16x16x32_bf16 v[156:159], a[184:187], a[56:59], v[156:159]
    ds_read_b64_tr_b16 a[200:201], v243 offset:0
    v_cvt_pk_bf16_f32 v181, v134, v135
    v_mfma_f32_16x16x32_bf16 v[156:159], a[188:191], a[60:63], v[156:159]
    v_exp_f32_e64 v148, v148
    v_mfma_f32_16x16x32_bf16 a[224:227], a[240:243], v[160:163], 0
    ds_read_b64_tr_b16 a[202:203], v243 offset:4096
    v_mfma_f32_16x16x32_bf16 a[228:231], a[240:243], v[164:167], 0
    s_waitcnt lgkmcnt(4)
    v_exp_f32 v149, v149
    v_mfma_f32_16x16x32_bf16 a[232:235], a[240:243], v[168:171], 0
    buffer_store_dwordx4 a[80:83], v246, s[24:27], s66 offen offset:64 sc1
    v_cvt_pk_bf16_f32 v182, v148, v149
    v_mfma_f32_16x16x32_bf16 a[236:239], a[240:243], v[172:175], 0
    v_exp_f32_e64 v150, v150
    v_mfma_f32_16x16x32_bf16 v[0:3], a[192:195], v[160:163], 0
    ds_read_b64_tr_b16 a[204:205], v243 offset:8
    v_mfma_f32_16x16x32_bf16 v[4:7], a[192:195], v[164:167], 0
    s_waitcnt lgkmcnt(3)
    v_exp_f32 v151, v151
    v_mfma_f32_16x16x32_bf16 v[8:11], a[192:195], v[168:171], 0
    ds_read_b64_tr_b16 a[206:207], v243 offset:4104
    v_cvt_pk_bf16_f32 v183, v150, v151
    v_mfma_f32_16x16x32_bf16 v[12:15], a[192:195], v[172:175], 0
    v_exp_f32_e64 v136, v136
    v_mfma_f32_16x16x32_bf16 v[16:19], a[196:199], v[160:163], 0
    ds_read_b64_tr_b16 a[208:209], v244 offset:0
    v_mfma_f32_16x16x32_bf16 v[20:23], a[196:199], v[164:167], 0
    s_waitcnt lgkmcnt(3)
    v_exp_f32 v137, v137
    v_mfma_f32_16x16x32_bf16 v[24:27], a[196:199], v[168:171], 0
    ds_read_b64_tr_b16 a[210:211], v244 offset:4096
    v_cvt_pk_bf16_f32 v184, v136, v137
    v_mfma_f32_16x16x32_bf16 v[28:31], a[196:199], v[172:175], 0
    v_exp_f32_e64 v138, v138
    v_mfma_f32_16x16x32_bf16 v[32:35], a[200:203], v[160:163], 0
    ds_read_b64_tr_b16 a[212:213], v244 offset:8
    v_mfma_f32_16x16x32_bf16 v[36:39], a[200:203], v[164:167], 0
    s_waitcnt lgkmcnt(3)
    v_exp_f32 v139, v139
    v_mfma_f32_16x16x32_bf16 v[40:43], a[200:203], v[168:171], 0
    ds_read_b64_tr_b16 a[214:215], v244 offset:4104
    v_cvt_pk_bf16_f32 v185, v138, v139
    v_mfma_f32_16x16x32_bf16 v[44:47], a[200:203], v[172:175], 0
    v_exp_f32_e64 v152, v152
    v_mfma_f32_16x16x32_bf16 v[48:51], a[204:207], v[160:163], 0
    buffer_store_dwordx4 a[96:99], v246, s[24:27], s66 offen offset:128 sc1
    v_mfma_f32_16x16x32_bf16 v[52:55], a[204:207], v[164:167], 0
    s_waitcnt lgkmcnt(2)
    v_exp_f32 v153, v153
    v_mfma_f32_16x16x32_bf16 v[56:59], a[204:207], v[168:171], 0
    ds_read_b64_tr_b16 a[216:217], v245 offset:0
    v_cvt_pk_bf16_f32 v186, v152, v153
    v_mfma_f32_16x16x32_bf16 v[60:63], a[204:207], v[172:175], 0
    v_exp_f32_e64 v154, v154
    v_mfma_f32_16x16x32_bf16 v[64:67], a[208:211], v[160:163], 0
    ds_read_b64_tr_b16 a[218:219], v245 offset:4096
    v_mfma_f32_16x16x32_bf16 v[68:71], a[208:211], v[164:167], 0
    s_waitcnt lgkmcnt(2)
    v_exp_f32 v155, v155
    v_mfma_f32_16x16x32_bf16 v[72:75], a[208:211], v[168:171], 0
    ds_read_b64_tr_b16 a[220:221], v245 offset:8
    v_cvt_pk_bf16_f32 v187, v154, v155
    v_mfma_f32_16x16x32_bf16 v[76:79], a[208:211], v[172:175], 0
    v_exp_f32_e64 v140, v140
    v_mfma_f32_16x16x32_bf16 v[80:83], a[212:215], v[160:163], 0
    ds_read_b64_tr_b16 a[222:223], v245 offset:4104
    v_mfma_f32_16x16x32_bf16 v[84:87], a[212:215], v[164:167], 0
    v_exp_f32_e64 v141, v141
    v_mfma_f32_16x16x32_bf16 v[88:91], a[212:215], v[168:171], 0
    buffer_store_dwordx4 a[112:115], v246, s[24:27], s66 offen offset:192 sc1
    v_cvt_pk_bf16_f32 v188, v140, v141
    v_mfma_f32_16x16x32_bf16 v[92:95], a[212:215], v[172:175], 0
    s_waitcnt lgkmcnt(2)
    v_exp_f32 v142, v142
    v_mfma_f32_16x16x32_bf16 v[96:99], a[216:219], v[160:163], 0
    ds_read_b64_tr_b16 a[192:193], v242 offset:8192
    v_mfma_f32_16x16x32_bf16 v[100:103], a[216:219], v[164:167], 0
    s_mov_b32 s66, s34
    v_exp_f32 v143, v143
    v_mfma_f32_16x16x32_bf16 v[104:107], a[216:219], v[168:171], 0
    ds_read_b64_tr_b16 a[194:195], v242 offset:12288
    v_cvt_pk_bf16_f32 v189, v142, v143
    v_mfma_f32_16x16x32_bf16 v[108:111], a[216:219], v[172:175], 0
    s_waitcnt lgkmcnt(2)
    v_exp_f32 v156, v156
    v_mfma_f32_16x16x32_bf16 v[112:115], a[220:223], v[160:163], 0
    ds_read_b64_tr_b16 a[196:197], v242 offset:8200
    v_mfma_f32_16x16x32_bf16 v[116:119], a[220:223], v[164:167], 0
    s_waitcnt lgkmcnt(15)
    v_exp_f32 v157, v157
    v_mfma_f32_16x16x32_bf16 v[120:123], a[220:223], v[168:171], 0
    ds_read_b64_tr_b16 a[198:199], v242 offset:12296
    v_cvt_pk_bf16_f32 v190, v156, v157
    v_mfma_f32_16x16x32_bf16 v[124:127], a[220:223], v[172:175], 0
    s_mov_b32 s34, s30
    v_exp_f32 v158, v158
    v_mfma_f32_16x16x32_bf16 v[128:131], a[128:131], a[0:3], v[192:195]
    buffer_store_dwordx4 a[68:71], v246, s[24:27], s67 offen offset:0 sc1
    v_mfma_f32_16x16x32_bf16 v[128:131], a[132:135], a[4:7], v[128:131]
    s_waitcnt lgkmcnt(15)
    v_exp_f32 v159, v159
    v_mfma_f32_16x16x32_bf16 v[128:131], a[136:139], a[8:11], v[128:131]
    ds_read_b64_tr_b16 a[200:201], v243 offset:8192
    v_cvt_pk_bf16_f32 v191, v158, v159
    v_mfma_f32_16x16x32_bf16 v[128:131], a[140:143], a[12:15], v[128:131]
    ds_read_b64_tr_b16 a[202:203], v243 offset:12288
    v_mfma_f32_16x16x32_bf16 v[144:147], a[144:147], a[0:3], v[192:195]
    ds_read_b64_tr_b16 a[204:205], v243 offset:8200
    v_mfma_f32_16x16x32_bf16 v[144:147], a[148:151], a[4:7], v[144:147]
    ds_read_b64_tr_b16 a[206:207], v243 offset:12296
    v_mfma_f32_16x16x32_bf16 v[144:147], a[152:155], a[8:11], v[144:147]
    ds_read_b64_tr_b16 a[208:209], v244 offset:8192
    v_mfma_f32_16x16x32_bf16 v[144:147], a[156:159], a[12:15], v[144:147]
    v_exp_f32_e64 v128, v128
    v_mfma_f32_16x16x32_bf16 v[132:135], a[128:131], a[16:19], v[196:199]
    ds_read_b64_tr_b16 a[210:211], v244 offset:12288
    v_mfma_f32_16x16x32_bf16 v[132:135], a[132:135], a[20:23], v[132:135]
    v_exp_f32_e64 v129, v129
    v_mfma_f32_16x16x32_bf16 v[132:135], a[136:139], a[24:27], v[132:135]
    buffer_store_dwordx4 a[84:87], v246, s[24:27], s67 offen offset:64 sc1
    v_cvt_pk_bf16_f32 v160, v128, v129
    v_mfma_f32_16x16x32_bf16 v[132:135], a[140:143], a[28:31], v[132:135]
    v_exp_f32_e64 v130, v130
    v_mfma_f32_16x16x32_bf16 v[148:151], a[144:147], a[16:19], v[196:199]
    ds_read_b64_tr_b16 a[212:213], v244 offset:8200
    v_mfma_f32_16x16x32_bf16 v[148:151], a[148:151], a[20:23], v[148:151]
    v_exp_f32_e64 v131, v131
    v_mfma_f32_16x16x32_bf16 v[148:151], a[152:155], a[24:27], v[148:151]
    ds_read_b64_tr_b16 a[214:215], v244 offset:12296
    v_cvt_pk_bf16_f32 v161, v130, v131
    v_mfma_f32_16x16x32_bf16 v[148:151], a[156:159], a[28:31], v[148:151]
    v_exp_f32_e64 v144, v144
    v_mfma_f32_16x16x32_bf16 v[136:139], a[128:131], a[32:35], v[200:203]
    ds_read_b64_tr_b16 a[216:217], v245 offset:8192
    v_mfma_f32_16x16x32_bf16 v[136:139], a[132:135], a[36:39], v[136:139]
    v_exp_f32_e64 v145, v145
    v_mfma_f32_16x16x32_bf16 v[136:139], a[136:139], a[40:43], v[136:139]
    ds_read_b64_tr_b16 a[218:219], v245 offset:12288
    v_cvt_pk_bf16_f32 v162, v144, v145
    v_mfma_f32_16x16x32_bf16 v[136:139], a[140:143], a[44:47], v[136:139]
    v_exp_f32_e64 v146, v146
    v_mfma_f32_16x16x32_bf16 v[152:155], a[144:147], a[32:35], v[200:203]
    ds_read_b64_tr_b16 a[220:221], v245 offset:8200
    v_mfma_f32_16x16x32_bf16 v[152:155], a[148:151], a[36:39], v[152:155]
    v_exp_f32_e64 v147, v147
    v_mfma_f32_16x16x32_bf16 v[152:155], a[152:155], a[40:43], v[152:155]
    ds_read_b64_tr_b16 a[222:223], v245 offset:12296
    v_cvt_pk_bf16_f32 v163, v146, v147
    v_mfma_f32_16x16x32_bf16 v[152:155], a[156:159], a[44:47], v[152:155]
    v_exp_f32_e64 v132, v132
    v_mfma_f32_16x16x32_bf16 v[140:143], a[128:131], a[48:51], v[204:207]
    ds_read_b128 a[160:163], v240 offset:24576
    v_mfma_f32_16x16x32_bf16 v[140:143], a[132:135], a[52:55], v[140:143]
    v_exp_f32_e64 v133, v133
    v_mfma_f32_16x16x32_bf16 v[140:143], a[136:139], a[56:59], v[140:143]
    ds_read_b128 a[164:167], v240 offset:25600
    v_cvt_pk_bf16_f32 v164, v132, v133
    v_mfma_f32_16x16x32_bf16 v[140:143], a[140:143], a[60:63], v[140:143]
    v_exp_f32_e64 v134, v134
    v_mfma_f32_16x16x32_bf16 v[156:159], a[144:147], a[48:51], v[204:207]
    ds_read_b128 a[168:171], v240 offset:26624
    v_mfma_f32_16x16x32_bf16 v[156:159], a[148:151], a[52:55], v[156:159]
    v_exp_f32_e64 v135, v135
    v_mfma_f32_16x16x32_bf16 v[156:159], a[152:155], a[56:59], v[156:159]
    ds_read_b128 a[172:175], v240 offset:27648
    v_cvt_pk_bf16_f32 v165, v134, v135
    v_mfma_f32_16x16x32_bf16 v[156:159], a[156:159], a[60:63], v[156:159]
    v_exp_f32_e64 v148, v148
    v_mfma_f32_16x16x32_bf16 a[224:227], a[240:243], v[176:179], a[224:227]
    ds_read_b128 a[176:179], v240 offset:28672
    v_mfma_f32_16x16x32_bf16 a[228:231], a[240:243], v[180:183], a[228:231]
    s_waitcnt lgkmcnt(15)
    v_exp_f32 v149, v149
    v_mfma_f32_16x16x32_bf16 a[232:235], a[240:243], v[184:187], a[232:235]
    ds_read_b128 a[180:183], v240 offset:29696
    v_cvt_pk_bf16_f32 v166, v148, v149
    v_mfma_f32_16x16x32_bf16 a[236:239], a[240:243], v[188:191], a[236:239]
    v_exp_f32_e64 v150, v150
    v_mfma_f32_16x16x32_bf16 v[0:3], a[192:195], v[176:179], v[0:3]
    ds_read_b128 a[184:187], v240 offset:30720
    v_mfma_f32_16x16x32_bf16 v[4:7], a[192:195], v[180:183], v[4:7]
    s_waitcnt lgkmcnt(15)
    v_exp_f32 v151, v151
    v_mfma_f32_16x16x32_bf16 v[8:11], a[192:195], v[184:187], v[8:11]
    ds_read_b128 a[188:191], v240 offset:31744
    v_cvt_pk_bf16_f32 v167, v150, v151
    v_mfma_f32_16x16x32_bf16 v[12:15], a[192:195], v[188:191], v[12:15]
    v_exp_f32_e64 v136, v136
    v_mfma_f32_16x16x32_bf16 v[16:19], a[196:199], v[176:179], v[16:19]
    ds_read_b128 a[128:131], v240 offset:32768
    v_mfma_f32_16x16x32_bf16 v[20:23], a[196:199], v[180:183], v[20:23]
    s_waitcnt lgkmcnt(15)
    v_exp_f32 v137, v137
    v_mfma_f32_16x16x32_bf16 v[24:27], a[196:199], v[184:187], v[24:27]
    ds_read_b128 a[132:135], v240 offset:33792
    v_cvt_pk_bf16_f32 v168, v136, v137
    v_mfma_f32_16x16x32_bf16 v[28:31], a[196:199], v[188:191], v[28:31]
    v_exp_f32_e64 v138, v138
    v_mfma_f32_16x16x32_bf16 v[32:35], a[200:203], v[176:179], v[32:35]
    ds_read_b128 a[136:139], v240 offset:34816
    v_mfma_f32_16x16x32_bf16 v[36:39], a[200:203], v[180:183], v[36:39]
    s_waitcnt lgkmcnt(15)
    v_exp_f32 v139, v139
    v_mfma_f32_16x16x32_bf16 v[40:43], a[200:203], v[184:187], v[40:43]
    ds_read_b128 a[140:143], v240 offset:35840
    v_cvt_pk_bf16_f32 v169, v138, v139
    v_mfma_f32_16x16x32_bf16 v[44:47], a[200:203], v[188:191], v[44:47]
    v_exp_f32_e64 v152, v152
    v_mfma_f32_16x16x32_bf16 v[48:51], a[204:207], v[176:179], v[48:51]
    ds_read_b128 a[144:147], v240 offset:36864
    v_mfma_f32_16x16x32_bf16 v[52:55], a[204:207], v[180:183], v[52:55]
    s_waitcnt lgkmcnt(15)
    v_exp_f32 v153, v153
    v_mfma_f32_16x16x32_bf16 v[56:59], a[204:207], v[184:187], v[56:59]
    ds_read_b128 a[148:151], v240 offset:37888
    v_cvt_pk_bf16_f32 v170, v152, v153
    v_mfma_f32_16x16x32_bf16 v[60:63], a[204:207], v[188:191], v[60:63]
    v_exp_f32_e64 v154, v154
    v_mfma_f32_16x16x32_bf16 v[64:67], a[208:211], v[176:179], v[64:67]
    ds_read_b128 a[152:155], v240 offset:38912
    v_mfma_f32_16x16x32_bf16 v[68:71], a[208:211], v[180:183], v[68:71]
    s_waitcnt lgkmcnt(15)
    v_exp_f32 v155, v155
    v_mfma_f32_16x16x32_bf16 v[72:75], a[208:211], v[184:187], v[72:75]
    ds_read_b128 a[156:159], v240 offset:39936
    v_cvt_pk_bf16_f32 v171, v154, v155
    v_mfma_f32_16x16x32_bf16 v[76:79], a[208:211], v[188:191], v[76:79]
    v_exp_f32_e64 v140, v140
    v_mfma_f32_16x16x32_bf16 v[80:83], a[212:215], v[176:179], v[80:83]
    v_mfma_f32_16x16x32_bf16 v[84:87], a[212:215], v[180:183], v[84:87]
    s_waitcnt lgkmcnt(15)
    v_exp_f32 v141, v141
    v_mfma_f32_16x16x32_bf16 v[88:91], a[212:215], v[184:187], v[88:91]
    v_cvt_pk_bf16_f32 v172, v140, v141
    v_mfma_f32_16x16x32_bf16 v[92:95], a[212:215], v[188:191], v[92:95]
    v_exp_f32_e64 v142, v142
    v_mfma_f32_16x16x32_bf16 v[96:99], a[216:219], v[176:179], v[96:99]
    v_mfma_f32_16x16x32_bf16 v[100:103], a[216:219], v[180:183], v[100:103]
    s_waitcnt lgkmcnt(15)
    v_exp_f32 v143, v143
    v_mfma_f32_16x16x32_bf16 v[104:107], a[216:219], v[184:187], v[104:107]
    v_cvt_pk_bf16_f32 v173, v142, v143
    v_mfma_f32_16x16x32_bf16 v[108:111], a[216:219], v[188:191], v[108:111]
    v_exp_f32_e64 v156, v156
    v_mfma_f32_16x16x32_bf16 v[112:115], a[220:223], v[176:179], v[112:115]
    v_mfma_f32_16x16x32_bf16 v[116:119], a[220:223], v[180:183], v[116:119]
    s_waitcnt lgkmcnt(12)
    v_exp_f32 v157, v157
    v_mfma_f32_16x16x32_bf16 v[120:123], a[220:223], v[184:187], v[120:123]
    v_cvt_pk_bf16_f32 v174, v156, v157
    v_mfma_f32_16x16x32_bf16 v[124:127], a[220:223], v[188:191], v[124:127]
    v_exp_f32_e64 v158, v158
    v_mfma_f32_16x16x32_bf16 v[128:131], a[160:163], a[0:3], v[192:195]
    v_mfma_f32_16x16x32_bf16 v[128:131], a[164:167], a[4:7], v[128:131]
    s_waitcnt lgkmcnt(8)
    v_exp_f32 v159, v159
    v_mfma_f32_16x16x32_bf16 v[128:131], a[168:171], a[8:11], v[128:131]
    v_cvt_pk_bf16_f32 v175, v158, v159
    v_mfma_f32_16x16x32_bf16 v[128:131], a[172:175], a[12:15], v[128:131]
    v_mfma_f32_16x16x32_bf16 v[144:147], a[176:179], a[0:3], v[192:195]
    v_mfma_f32_16x16x32_bf16 v[144:147], a[180:183], a[4:7], v[144:147]
    v_mfma_f32_16x16x32_bf16 v[144:147], a[184:187], a[8:11], v[144:147]
    v_mfma_f32_16x16x32_bf16 v[144:147], a[188:191], a[12:15], v[144:147]
    v_mfma_f32_16x16x32_bf16 v[132:135], a[160:163], a[16:19], v[196:199]
    s_waitcnt vmcnt(6)
    v_mfma_f32_16x16x32_bf16 v[132:135], a[164:167], a[20:23], v[132:135]
    s_barrier
    v_mfma_f32_16x16x32_bf16 v[132:135], a[168:171], a[24:27], v[132:135]
    v_exp_f32_e64 v128, v128
    v_mfma_f32_16x16x32_bf16 v[132:135], a[172:175], a[28:31], v[132:135]
    buffer_load_dwordx4 v247, s[20:23], s39 offen offset:0 lds
    v_mfma_f32_16x16x32_bf16 v[148:151], a[176:179], a[16:19], v[196:199]
    v_exp_f32_e64 v129, v129
    v_mfma_f32_16x16x32_bf16 v[148:151], a[180:183], a[20:23], v[148:151]
    buffer_load_dwordx4 v247, s[20:23], s39 offen offset:1024 lds
    v_cvt_pk_bf16_f32 v176, v128, v129
    v_mfma_f32_16x16x32_bf16 v[148:151], a[184:187], a[24:27], v[148:151]
    s_add_u32 m0, s40, 8192
    v_exp_f32_e64 v130, v130
    v_mfma_f32_16x16x32_bf16 v[148:151], a[188:191], a[28:31], v[148:151]
    buffer_load_dwordx4 v247, s[20:23], s51 offen offset:0 lds
    v_mfma_f32_16x16x32_bf16 v[136:139], a[160:163], a[32:35], v[200:203]
    s_add_u32 s39, s38, 49152
    v_exp_f32_e64 v131, v131
    v_mfma_f32_16x16x32_bf16 v[136:139], a[164:167], a[36:39], v[136:139]
    buffer_load_dwordx4 v247, s[20:23], s51 offen offset:1024 lds
    v_cvt_pk_bf16_f32 v177, v130, v131
    v_mfma_f32_16x16x32_bf16 v[136:139], a[168:171], a[40:43], v[136:139]
    s_add_u32 m0, s40, 16384
    v_exp_f32_e64 v144, v144
    v_mfma_f32_16x16x32_bf16 v[136:139], a[172:175], a[44:47], v[136:139]
    ds_read_b64_tr_b16 a[192:193], v242 offset:16384
    v_mfma_f32_16x16x32_bf16 v[152:155], a[176:179], a[32:35], v[200:203]
    s_add_u32 s51, s38, 57344
    v_exp_f32_e64 v145, v145
    v_mfma_f32_16x16x32_bf16 v[152:155], a[180:183], a[36:39], v[152:155]
    ds_read_b64_tr_b16 a[194:195], v242 offset:20480
    v_cvt_pk_bf16_f32 v178, v144, v145
    v_mfma_f32_16x16x32_bf16 v[152:155], a[184:187], a[40:43], v[152:155]
    v_exp_f32_e64 v146, v146
    v_mfma_f32_16x16x32_bf16 v[152:155], a[188:191], a[44:47], v[152:155]
    buffer_store_dwordx4 a[100:103], v246, s[24:27], s67 offen offset:128 sc1
    v_mfma_f32_16x16x32_bf16 v[140:143], a[160:163], a[48:51], v[204:207]
    v_exp_f32_e64 v147, v147
    v_mfma_f32_16x16x32_bf16 v[140:143], a[164:167], a[52:55], v[140:143]
    ds_read_b64_tr_b16 a[196:197], v242 offset:16392
    v_cvt_pk_bf16_f32 v179, v146, v147
    v_mfma_f32_16x16x32_bf16 v[140:143], a[168:171], a[56:59], v[140:143]
    v_exp_f32_e64 v132, v132
    v_mfma_f32_16x16x32_bf16 v[140:143], a[172:175], a[60:63], v[140:143]
    ds_read_b64_tr_b16 a[198:199], v242 offset:20488
    v_mfma_f32_16x16x32_bf16 v[156:159], a[176:179], a[48:51], v[204:207]
    v_exp_f32_e64 v133, v133
    v_mfma_f32_16x16x32_bf16 v[156:159], a[180:183], a[52:55], v[156:159]
    ds_read_b64_tr_b16 a[200:201], v243 offset:16384
    v_cvt_pk_bf16_f32 v180, v132, v133
    v_mfma_f32_16x16x32_bf16 v[156:159], a[184:187], a[56:59], v[156:159]
    v_exp_f32_e64 v134, v134
    v_mfma_f32_16x16x32_bf16 v[156:159], a[188:191], a[60:63], v[156:159]
    ds_read_b64_tr_b16 a[202:203], v243 offset:20480
    v_mfma_f32_16x16x32_bf16 a[224:227], a[240:243], v[160:163], a[224:227]
    v_exp_f32_e64 v135, v135
    v_mfma_f32_16x16x32_bf16 a[228:231], a[240:243], v[164:167], a[228:231]
    ds_read_b64_tr_b16 a[204:205], v243 offset:16392
    v_cvt_pk_bf16_f32 v181, v134, v135
    v_mfma_f32_16x16x32_bf16 a[232:235], a[240:243], v[168:171], a[232:235]
    s_waitcnt lgkmcnt(5)
    v_exp_f32 v148, v148
    v_mfma_f32_16x16x32_bf16 a[236:239], a[240:243], v[172:175], a[236:239]
    buffer_store_dwordx4 a[116:119], v246, s[24:27], s67 offen offset:192 sc1
    v_mfma_f32_16x16x32_bf16 v[0:3], a[192:195], v[160:163], v[0:3]
    s_mov_b32 s67, s35
    v_exp_f32 v149, v149
    v_mfma_f32_16x16x32_bf16 v[4:7], a[192:195], v[164:167], v[4:7]
    ds_read_b64_tr_b16 a[206:207], v243 offset:20488
    v_cvt_pk_bf16_f32 v182, v148, v149
    v_mfma_f32_16x16x32_bf16 v[8:11], a[192:195], v[168:171], v[8:11]
    s_waitcnt lgkmcnt(4)
    v_exp_f32 v150, v150
    v_mfma_f32_16x16x32_bf16 v[12:15], a[192:195], v[172:175], v[12:15]
    ds_read_b64_tr_b16 a[208:209], v244 offset:16384
    v_mfma_f32_16x16x32_bf16 v[16:19], a[196:199], v[160:163], v[16:19]
    s_mov_b32 s35, s31
    v_exp_f32 v151, v151
    v_mfma_f32_16x16x32_bf16 v[20:23], a[196:199], v[164:167], v[20:23]
    ds_read_b64_tr_b16 a[210:211], v244 offset:20480
    v_cvt_pk_bf16_f32 v183, v150, v151
    v_mfma_f32_16x16x32_bf16 v[24:27], a[196:199], v[168:171], v[24:27]
    s_waitcnt lgkmcnt(4)
    v_exp_f32 v136, v136
    v_mfma_f32_16x16x32_bf16 v[28:31], a[196:199], v[172:175], v[28:31]
    ds_read_b64_tr_b16 a[212:213], v244 offset:16392
    v_mfma_f32_16x16x32_bf16 v[32:35], a[200:203], v[160:163], v[32:35]
    v_exp_f32_e64 v137, v137
    v_mfma_f32_16x16x32_bf16 v[36:39], a[200:203], v[164:167], v[36:39]
    ds_read_b64_tr_b16 a[214:215], v244 offset:20488
    v_cvt_pk_bf16_f32 v184, v136, v137
    v_mfma_f32_16x16x32_bf16 v[40:43], a[200:203], v[168:171], v[40:43]
    s_waitcnt lgkmcnt(4)
    v_exp_f32 v138, v138
    v_mfma_f32_16x16x32_bf16 v[44:47], a[200:203], v[172:175], v[44:47]
    buffer_store_dwordx4 a[72:75], v246, s[24:27], s68 offen offset:0 sc1
    v_mfma_f32_16x16x32_bf16 v[48:51], a[204:207], v[160:163], v[48:51]
    v_exp_f32_e64 v139, v139
    v_mfma_f32_16x16x32_bf16 v[52:55], a[204:207], v[164:167], v[52:55]
    ds_read_b64_tr_b16 a[216:217], v245 offset:16384
    v_cvt_pk_bf16_f32 v185, v138, v139
    v_mfma_f32_16x16x32_bf16 v[56:59], a[204:207], v[168:171], v[56:59]
    s_waitcnt lgkmcnt(3)
    v_exp_f32 v152, v152
    v_mfma_f32_16x16x32_bf16 v[60:63], a[204:207], v[172:175], v[60:63]
    ds_read_b64_tr_b16 a[218:219], v245 offset:20480
    v_mfma_f32_16x16x32_bf16 v[64:67], a[208:211], v[160:163], v[64:67]
    v_exp_f32_e64 v153, v153
    v_mfma_f32_16x16x32_bf16 v[68:71], a[208:211], v[164:167], v[68:71]
    ds_read_b64_tr_b16 a[220:221], v245 offset:16392
    v_cvt_pk_bf16_f32 v186, v152, v153
    v_mfma_f32_16x16x32_bf16 v[72:75], a[208:211], v[168:171], v[72:75]
    s_waitcnt lgkmcnt(3)
    v_exp_f32 v154, v154
    v_mfma_f32_16x16x32_bf16 v[76:79], a[208:211], v[172:175], v[76:79]
    ds_read_b64_tr_b16 a[222:223], v245 offset:20488
    v_mfma_f32_16x16x32_bf16 v[80:83], a[212:215], v[160:163], v[80:83]
    v_exp_f32_e64 v155, v155
    v_mfma_f32_16x16x32_bf16 v[84:87], a[212:215], v[164:167], v[84:87]
    buffer_store_dwordx4 a[88:91], v246, s[24:27], s68 offen offset:64 sc1
    v_cvt_pk_bf16_f32 v187, v154, v155
    v_mfma_f32_16x16x32_bf16 v[88:91], a[212:215], v[168:171], v[88:91]
    s_waitcnt lgkmcnt(2)
    v_exp_f32 v140, v140
    v_mfma_f32_16x16x32_bf16 v[92:95], a[212:215], v[172:175], v[92:95]
    ds_read_b64_tr_b16 a[192:193], v242 offset:24576
    v_mfma_f32_16x16x32_bf16 v[96:99], a[216:219], v[160:163], v[96:99]
    v_exp_f32_e64 v141, v141
    v_mfma_f32_16x16x32_bf16 v[100:103], a[216:219], v[164:167], v[100:103]
    ds_read_b64_tr_b16 a[194:195], v242 offset:28672
    v_cvt_pk_bf16_f32 v188, v140, v141
    v_mfma_f32_16x16x32_bf16 v[104:107], a[216:219], v[168:171], v[104:107]
    s_waitcnt lgkmcnt(2)
    v_exp_f32 v142, v142
    v_mfma_f32_16x16x32_bf16 v[108:111], a[216:219], v[172:175], v[108:111]
    ds_read_b64_tr_b16 a[196:197], v242 offset:24584
    v_mfma_f32_16x16x32_bf16 v[112:115], a[220:223], v[160:163], v[112:115]
    v_exp_f32_e64 v143, v143
    v_mfma_f32_16x16x32_bf16 v[116:119], a[220:223], v[164:167], v[116:119]
    ds_read_b64_tr_b16 a[198:199], v242 offset:28680
    v_cvt_pk_bf16_f32 v189, v142, v143
    v_mfma_f32_16x16x32_bf16 v[120:123], a[220:223], v[168:171], v[120:123]
    s_waitcnt lgkmcnt(15)
    v_exp_f32 v156, v156
    v_mfma_f32_16x16x32_bf16 v[124:127], a[220:223], v[172:175], v[124:127]
    buffer_store_dwordx4 a[104:107], v246, s[24:27], s68 offen offset:128 sc1
    v_mfma_f32_16x16x32_bf16 v[128:131], a[128:131], a[0:3], v[192:195]
    v_exp_f32_e64 v157, v157
    v_mfma_f32_16x16x32_bf16 v[128:131], a[132:135], a[4:7], v[128:131]
    ds_read_b64_tr_b16 a[200:201], v243 offset:24576
    v_cvt_pk_bf16_f32 v190, v156, v157
    v_mfma_f32_16x16x32_bf16 v[128:131], a[136:139], a[8:11], v[128:131]
    s_waitcnt lgkmcnt(15)
    v_exp_f32 v158, v158
    v_mfma_f32_16x16x32_bf16 v[128:131], a[140:143], a[12:15], v[128:131]
    ds_read_b64_tr_b16 a[202:203], v243 offset:28672
    v_mfma_f32_16x16x32_bf16 v[144:147], a[144:147], a[0:3], v[192:195]
    v_exp_f32_e64 v159, v159
    v_mfma_f32_16x16x32_bf16 v[144:147], a[148:151], a[4:7], v[144:147]
    ds_read_b64_tr_b16 a[204:205], v243 offset:24584
    v_cvt_pk_bf16_f32 v191, v158, v159
    v_mfma_f32_16x16x32_bf16 v[144:147], a[152:155], a[8:11], v[144:147]
    ds_read_b64_tr_b16 a[206:207], v243 offset:28680
    v_mfma_f32_16x16x32_bf16 v[144:147], a[156:159], a[12:15], v[144:147]
    v_exp_f32_e64 v128, v128
    v_mfma_f32_16x16x32_bf16 v[132:135], a[128:131], a[16:19], v[196:199]
    ds_read_b64_tr_b16 a[208:209], v244 offset:24576
    v_mfma_f32_16x16x32_bf16 v[132:135], a[132:135], a[20:23], v[132:135]
    v_exp_f32_e64 v129, v129
    v_mfma_f32_16x16x32_bf16 v[132:135], a[136:139], a[24:27], v[132:135]
    buffer_store_dwordx4 a[120:123], v246, s[24:27], s68 offen offset:192 sc1
    v_cvt_pk_bf16_f32 v160, v128, v129
    v_mfma_f32_16x16x32_bf16 v[132:135], a[140:143], a[28:31], v[132:135]
    s_mov_b32 s68, s36
    v_exp_f32 v130, v130
    v_mfma_f32_16x16x32_bf16 v[148:151], a[144:147], a[16:19], v[196:199]
    ds_read_b64_tr_b16 a[210:211], v244 offset:28672
    v_mfma_f32_16x16x32_bf16 v[148:151], a[148:151], a[20:23], v[148:151]
    s_mov_b32 s36, s32
    v_exp_f32 v131, v131
    v_mfma_f32_16x16x32_bf16 v[148:151], a[152:155], a[24:27], v[148:151]
    ds_read_b64_tr_b16 a[212:213], v244 offset:24584
    v_cvt_pk_bf16_f32 v161, v130, v131
    v_mfma_f32_16x16x32_bf16 v[148:151], a[156:159], a[28:31], v[148:151]
    v_exp_f32_e64 v144, v144
    v_mfma_f32_16x16x32_bf16 v[136:139], a[128:131], a[32:35], v[200:203]
    ds_read_b64_tr_b16 a[214:215], v244 offset:28680
    v_mfma_f32_16x16x32_bf16 v[136:139], a[132:135], a[36:39], v[136:139]
    v_exp_f32_e64 v145, v145
    v_mfma_f32_16x16x32_bf16 v[136:139], a[136:139], a[40:43], v[136:139]
    ds_read_b64_tr_b16 a[216:217], v245 offset:24576
    v_cvt_pk_bf16_f32 v162, v144, v145
    v_mfma_f32_16x16x32_bf16 v[136:139], a[140:143], a[44:47], v[136:139]
    v_exp_f32_e64 v146, v146
    v_mfma_f32_16x16x32_bf16 v[152:155], a[144:147], a[32:35], v[200:203]
    ds_read_b64_tr_b16 a[218:219], v245 offset:28672
    v_mfma_f32_16x16x32_bf16 v[152:155], a[148:151], a[36:39], v[152:155]
    v_exp_f32_e64 v147, v147
    v_mfma_f32_16x16x32_bf16 v[152:155], a[152:155], a[40:43], v[152:155]
    ds_read_b64_tr_b16 a[220:221], v245 offset:24584
    v_cvt_pk_bf16_f32 v163, v146, v147
    v_mfma_f32_16x16x32_bf16 v[152:155], a[156:159], a[44:47], v[152:155]
    v_exp_f32_e64 v132, v132
    v_mfma_f32_16x16x32_bf16 v[140:143], a[128:131], a[48:51], v[204:207]
    ds_read_b64_tr_b16 a[222:223], v245 offset:28680
    v_mfma_f32_16x16x32_bf16 v[140:143], a[132:135], a[52:55], v[140:143]
    v_exp_f32_e64 v133, v133
    v_mfma_f32_16x16x32_bf16 v[140:143], a[136:139], a[56:59], v[140:143]
    ds_read_b128 a[160:163], v240 offset:40960
    v_cvt_pk_bf16_f32 v164, v132, v133
    v_mfma_f32_16x16x32_bf16 v[140:143], a[140:143], a[60:63], v[140:143]
    v_exp_f32_e64 v134, v134
    v_mfma_f32_16x16x32_bf16 v[156:159], a[144:147], a[48:51], v[204:207]
    ds_read_b128 a[164:167], v240 offset:41984
    v_mfma_f32_16x16x32_bf16 v[156:159], a[148:151], a[52:55], v[156:159]
    v_exp_f32_e64 v135, v135
    v_mfma_f32_16x16x32_bf16 v[156:159], a[152:155], a[56:59], v[156:159]
    ds_read_b128 a[168:171], v240 offset:43008
    v_cvt_pk_bf16_f32 v165, v134, v135
    v_mfma_f32_16x16x32_bf16 v[156:159], a[156:159], a[60:63], v[156:159]
    v_exp_f32_e64 v148, v148
    v_mfma_f32_16x16x32_bf16 a[224:227], a[240:243], v[176:179], a[224:227]
    ds_read_b128 a[172:175], v240 offset:44032
    v_mfma_f32_16x16x32_bf16 a[228:231], a[240:243], v[180:183], a[228:231]
    s_waitcnt lgkmcnt(15)
    v_exp_f32 v149, v149
    v_mfma_f32_16x16x32_bf16 a[232:235], a[240:243], v[184:187], a[232:235]
    ds_read_b128 a[176:179], v240 offset:45056
    v_cvt_pk_bf16_f32 v166, v148, v149
    v_mfma_f32_16x16x32_bf16 a[236:239], a[240:243], v[188:191], a[236:239]
    v_exp_f32_e64 v150, v150
    v_mfma_f32_16x16x32_bf16 v[0:3], a[192:195], v[176:179], v[0:3]
    ds_read_b128 a[180:183], v240 offset:46080
    v_mfma_f32_16x16x32_bf16 v[4:7], a[192:195], v[180:183], v[4:7]
    s_waitcnt lgkmcnt(15)
    v_exp_f32 v151, v151
    v_mfma_f32_16x16x32_bf16 v[8:11], a[192:195], v[184:187], v[8:11]
    ds_read_b128 a[184:187], v240 offset:47104
    v_cvt_pk_bf16_f32 v167, v150, v151
    v_mfma_f32_16x16x32_bf16 v[12:15], a[192:195], v[188:191], v[12:15]
    v_exp_f32_e64 v136, v136
    v_mfma_f32_16x16x32_bf16 v[16:19], a[196:199], v[176:179], v[16:19]
    ds_read_b128 a[188:191], v240 offset:48128
    v_mfma_f32_16x16x32_bf16 v[20:23], a[196:199], v[180:183], v[20:23]
    s_waitcnt lgkmcnt(15)
    v_exp_f32 v137, v137
    v_mfma_f32_16x16x32_bf16 v[24:27], a[196:199], v[184:187], v[24:27]
    ds_read_b128 a[128:131], v240 offset:49152
    v_cvt_pk_bf16_f32 v168, v136, v137
    v_mfma_f32_16x16x32_bf16 v[28:31], a[196:199], v[188:191], v[28:31]
    v_exp_f32_e64 v138, v138
    v_mfma_f32_16x16x32_bf16 v[32:35], a[200:203], v[176:179], v[32:35]
    ds_read_b128 a[132:135], v240 offset:50176
    v_mfma_f32_16x16x32_bf16 v[36:39], a[200:203], v[180:183], v[36:39]
    s_waitcnt lgkmcnt(15)
    v_exp_f32 v139, v139
    v_mfma_f32_16x16x32_bf16 v[40:43], a[200:203], v[184:187], v[40:43]
    ds_read_b128 a[136:139], v240 offset:51200
    v_cvt_pk_bf16_f32 v169, v138, v139
    v_mfma_f32_16x16x32_bf16 v[44:47], a[200:203], v[188:191], v[44:47]
    v_exp_f32_e64 v152, v152
    v_mfma_f32_16x16x32_bf16 v[48:51], a[204:207], v[176:179], v[48:51]
    ds_read_b128 a[140:143], v240 offset:52224
    v_mfma_f32_16x16x32_bf16 v[52:55], a[204:207], v[180:183], v[52:55]
    s_waitcnt lgkmcnt(15)
    v_exp_f32 v153, v153
    v_mfma_f32_16x16x32_bf16 v[56:59], a[204:207], v[184:187], v[56:59]
    ds_read_b128 a[144:147], v240 offset:53248
    v_cvt_pk_bf16_f32 v170, v152, v153
    v_mfma_f32_16x16x32_bf16 v[60:63], a[204:207], v[188:191], v[60:63]
    v_exp_f32_e64 v154, v154
    v_mfma_f32_16x16x32_bf16 v[64:67], a[208:211], v[176:179], v[64:67]
    ds_read_b128 a[148:151], v240 offset:54272
    v_mfma_f32_16x16x32_bf16 v[68:71], a[208:211], v[180:183], v[68:71]
    s_waitcnt lgkmcnt(15)
    v_exp_f32 v155, v155
    v_mfma_f32_16x16x32_bf16 v[72:75], a[208:211], v[184:187], v[72:75]
    ds_read_b128 a[152:155], v240 offset:55296
    v_cvt_pk_bf16_f32 v171, v154, v155
    v_mfma_f32_16x16x32_bf16 v[76:79], a[208:211], v[188:191], v[76:79]
    v_exp_f32_e64 v140, v140
    v_mfma_f32_16x16x32_bf16 v[80:83], a[212:215], v[176:179], v[80:83]
    ds_read_b128 a[156:159], v240 offset:56320
    v_mfma_f32_16x16x32_bf16 v[84:87], a[212:215], v[180:183], v[84:87]
    s_waitcnt lgkmcnt(15)
    v_exp_f32 v141, v141
    v_mfma_f32_16x16x32_bf16 v[88:91], a[212:215], v[184:187], v[88:91]
    v_cvt_pk_bf16_f32 v172, v140, v141
    v_mfma_f32_16x16x32_bf16 v[92:95], a[212:215], v[188:191], v[92:95]
    v_exp_f32_e64 v142, v142
    v_mfma_f32_16x16x32_bf16 v[96:99], a[216:219], v[176:179], v[96:99]
    v_mfma_f32_16x16x32_bf16 v[100:103], a[216:219], v[180:183], v[100:103]
    s_waitcnt lgkmcnt(15)
    v_exp_f32 v143, v143
    v_mfma_f32_16x16x32_bf16 v[104:107], a[216:219], v[184:187], v[104:107]
    v_cvt_pk_bf16_f32 v173, v142, v143
    v_mfma_f32_16x16x32_bf16 v[108:111], a[216:219], v[188:191], v[108:111]
    v_exp_f32_e64 v156, v156
    v_mfma_f32_16x16x32_bf16 v[112:115], a[220:223], v[176:179], v[112:115]
    v_mfma_f32_16x16x32_bf16 v[116:119], a[220:223], v[180:183], v[116:119]
    s_waitcnt lgkmcnt(12)
    v_exp_f32 v157, v157
    v_mfma_f32_16x16x32_bf16 v[120:123], a[220:223], v[184:187], v[120:123]
    v_cvt_pk_bf16_f32 v174, v156, v157
    v_mfma_f32_16x16x32_bf16 v[124:127], a[220:223], v[188:191], v[124:127]
    v_exp_f32_e64 v158, v158
    v_mfma_f32_16x16x32_bf16 v[128:131], a[160:163], a[0:3], v[192:195]
    v_mfma_f32_16x16x32_bf16 v[128:131], a[164:167], a[4:7], v[128:131]
    s_waitcnt lgkmcnt(8)
    v_exp_f32 v159, v159
    v_mfma_f32_16x16x32_bf16 v[128:131], a[168:171], a[8:11], v[128:131]
    v_cvt_pk_bf16_f32 v175, v158, v159
    v_mfma_f32_16x16x32_bf16 v[128:131], a[172:175], a[12:15], v[128:131]
    v_mfma_f32_16x16x32_bf16 v[144:147], a[176:179], a[0:3], v[192:195]
    v_mfma_f32_16x16x32_bf16 v[144:147], a[180:183], a[4:7], v[144:147]
    v_mfma_f32_16x16x32_bf16 v[144:147], a[184:187], a[8:11], v[144:147]
    v_mfma_f32_16x16x32_bf16 v[144:147], a[188:191], a[12:15], v[144:147]
    v_mfma_f32_16x16x32_bf16 v[132:135], a[160:163], a[16:19], v[196:199]
    s_waitcnt vmcnt(6)
    v_mfma_f32_16x16x32_bf16 v[132:135], a[164:167], a[20:23], v[132:135]
    s_barrier
    v_mfma_f32_16x16x32_bf16 v[132:135], a[168:171], a[24:27], v[132:135]
    v_exp_f32_e64 v128, v128
    v_mfma_f32_16x16x32_bf16 v[132:135], a[172:175], a[28:31], v[132:135]
    buffer_load_dwordx4 v247, s[20:23], s39 offen offset:0 lds
    v_mfma_f32_16x16x32_bf16 v[148:151], a[176:179], a[16:19], v[196:199]
    v_exp_f32_e64 v129, v129
    v_mfma_f32_16x16x32_bf16 v[148:151], a[180:183], a[20:23], v[148:151]
    buffer_load_dwordx4 v247, s[20:23], s39 offen offset:1024 lds
    v_cvt_pk_bf16_f32 v176, v128, v129
    v_mfma_f32_16x16x32_bf16 v[148:151], a[184:187], a[24:27], v[148:151]
    s_add_u32 m0, s40, 24576
    v_exp_f32_e64 v130, v130
    v_mfma_f32_16x16x32_bf16 v[148:151], a[188:191], a[28:31], v[148:151]
    buffer_load_dwordx4 v247, s[20:23], s51 offen offset:0 lds
    v_mfma_f32_16x16x32_bf16 v[136:139], a[160:163], a[32:35], v[200:203]
    s_add_u32 s39, s38, 65536
    v_exp_f32_e64 v131, v131
    v_mfma_f32_16x16x32_bf16 v[136:139], a[164:167], a[36:39], v[136:139]
    buffer_load_dwordx4 v247, s[20:23], s51 offen offset:1024 lds
    v_cvt_pk_bf16_f32 v177, v130, v131
    v_mfma_f32_16x16x32_bf16 v[136:139], a[168:171], a[40:43], v[136:139]
    s_add_u32 m0, s40, 0
    v_exp_f32 v144, v144
    v_mfma_f32_16x16x32_bf16 v[136:139], a[172:175], a[44:47], v[136:139]
    ds_read_b64_tr_b16 a[192:193], v242 offset:0
    v_mfma_f32_16x16x32_bf16 v[152:155], a[176:179], a[32:35], v[200:203]
    s_add_u32 s51, s38, 73728
    v_exp_f32_e64 v145, v145
    v_mfma_f32_16x16x32_bf16 v[152:155], a[180:183], a[36:39], v[152:155]
    ds_read_b64_tr_b16 a[194:195], v242 offset:4096
    v_cvt_pk_bf16_f32 v178, v144, v145
    v_mfma_f32_16x16x32_bf16 v[152:155], a[184:187], a[40:43], v[152:155]
    v_exp_f32_e64 v146, v146
    v_mfma_f32_16x16x32_bf16 v[152:155], a[188:191], a[44:47], v[152:155]
    buffer_store_dwordx4 a[76:79], v246, s[24:27], s69 offen offset:0 sc1
    v_mfma_f32_16x16x32_bf16 v[140:143], a[160:163], a[48:51], v[204:207]
    v_exp_f32_e64 v147, v147
    v_mfma_f32_16x16x32_bf16 v[140:143], a[164:167], a[52:55], v[140:143]
    ds_read_b64_tr_b16 a[196:197], v242 offset:8
    v_cvt_pk_bf16_f32 v179, v146, v147
    v_mfma_f32_16x16x32_bf16 v[140:143], a[168:171], a[56:59], v[140:143]
    v_exp_f32_e64 v132, v132
    v_mfma_f32_16x16x32_bf16 v[140:143], a[172:175], a[60:63], v[140:143]
    ds_read_b64_tr_b16 a[198:199], v242 offset:4104
    v_mfma_f32_16x16x32_bf16 v[156:159], a[176:179], a[48:51], v[204:207]
    v_exp_f32_e64 v133, v133
    v_mfma_f32_16x16x32_bf16 v[156:159], a[180:183], a[52:55], v[156:159]
    ds_read_b64_tr_b16 a[200:201], v243 offset:0
    v_cvt_pk_bf16_f32 v180, v132, v133
    v_mfma_f32_16x16x32_bf16 v[156:159], a[184:187], a[56:59], v[156:159]
    v_exp_f32_e64 v134, v134
    v_mfma_f32_16x16x32_bf16 v[156:159], a[188:191], a[60:63], v[156:159]
    ds_read_b64_tr_b16 a[202:203], v243 offset:4096
    v_mfma_f32_16x16x32_bf16 a[224:227], a[240:243], v[160:163], a[224:227]
    v_exp_f32_e64 v135, v135
    v_mfma_f32_16x16x32_bf16 a[228:231], a[240:243], v[164:167], a[228:231]
    ds_read_b64_tr_b16 a[204:205], v243 offset:8
    v_cvt_pk_bf16_f32 v181, v134, v135
    v_mfma_f32_16x16x32_bf16 a[232:235], a[240:243], v[168:171], a[232:235]
    s_waitcnt lgkmcnt(5)
    v_exp_f32 v148, v148
    v_mfma_f32_16x16x32_bf16 a[236:239], a[240:243], v[172:175], a[236:239]
    buffer_store_dwordx4 a[92:95], v246, s[24:27], s69 offen offset:64 sc1
    v_mfma_f32_16x16x32_bf16 v[0:3], a[192:195], v[160:163], v[0:3]
    v_exp_f32_e64 v149, v149
    v_mfma_f32_16x16x32_bf16 v[4:7], a[192:195], v[164:167], v[4:7]
    ds_read_b64_tr_b16 a[206:207], v243 offset:4104
    v_cvt_pk_bf16_f32 v182, v148, v149
    v_mfma_f32_16x16x32_bf16 v[8:11], a[192:195], v[168:171], v[8:11]
    s_waitcnt lgkmcnt(4)
    v_exp_f32 v150, v150
    v_mfma_f32_16x16x32_bf16 v[12:15], a[192:195], v[172:175], v[12:15]
    ds_read_b64_tr_b16 a[208:209], v244 offset:0
    v_mfma_f32_16x16x32_bf16 v[16:19], a[196:199], v[160:163], v[16:19]
    v_exp_f32_e64 v151, v151
    v_mfma_f32_16x16x32_bf16 v[20:23], a[196:199], v[164:167], v[20:23]
    ds_read_b64_tr_b16 a[210:211], v244 offset:4096
    v_cvt_pk_bf16_f32 v183, v150, v151
    v_mfma_f32_16x16x32_bf16 v[24:27], a[196:199], v[168:171], v[24:27]
    s_waitcnt lgkmcnt(4)
    v_exp_f32 v136, v136
    v_mfma_f32_16x16x32_bf16 v[28:31], a[196:199], v[172:175], v[28:31]
    ds_read_b64_tr_b16 a[212:213], v244 offset:8
    v_mfma_f32_16x16x32_bf16 v[32:35], a[200:203], v[160:163], v[32:35]
    v_exp_f32_e64 v137, v137
    v_mfma_f32_16x16x32_bf16 v[36:39], a[200:203], v[164:167], v[36:39]
    ds_read_b64_tr_b16 a[214:215], v244 offset:4104
    v_cvt_pk_bf16_f32 v184, v136, v137
    v_mfma_f32_16x16x32_bf16 v[40:43], a[200:203], v[168:171], v[40:43]
    s_waitcnt lgkmcnt(4)
    v_exp_f32 v138, v138
    v_mfma_f32_16x16x32_bf16 v[44:47], a[200:203], v[172:175], v[44:47]
    buffer_store_dwordx4 a[108:111], v246, s[24:27], s69 offen offset:128 sc1
    v_mfma_f32_16x16x32_bf16 v[48:51], a[204:207], v[160:163], v[48:51]
    v_exp_f32_e64 v139, v139
    v_mfma_f32_16x16x32_bf16 v[52:55], a[204:207], v[164:167], v[52:55]
    ds_read_b64_tr_b16 a[216:217], v245 offset:0
    v_cvt_pk_bf16_f32 v185, v138, v139
    v_mfma_f32_16x16x32_bf16 v[56:59], a[204:207], v[168:171], v[56:59]
    s_waitcnt lgkmcnt(3)
    v_exp_f32 v152, v152
    v_mfma_f32_16x16x32_bf16 v[60:63], a[204:207], v[172:175], v[60:63]
    ds_read_b64_tr_b16 a[218:219], v245 offset:4096
    v_mfma_f32_16x16x32_bf16 v[64:67], a[208:211], v[160:163], v[64:67]
    v_exp_f32_e64 v153, v153
    v_mfma_f32_16x16x32_bf16 v[68:71], a[208:211], v[164:167], v[68:71]
    ds_read_b64_tr_b16 a[220:221], v245 offset:8
    v_cvt_pk_bf16_f32 v186, v152, v153
    v_mfma_f32_16x16x32_bf16 v[72:75], a[208:211], v[168:171], v[72:75]
    s_waitcnt lgkmcnt(3)
    v_exp_f32 v154, v154
    v_mfma_f32_16x16x32_bf16 v[76:79], a[208:211], v[172:175], v[76:79]
    ds_read_b64_tr_b16 a[222:223], v245 offset:4104
    v_mfma_f32_16x16x32_bf16 v[80:83], a[212:215], v[160:163], v[80:83]
    v_exp_f32_e64 v155, v155
    v_mfma_f32_16x16x32_bf16 v[84:87], a[212:215], v[164:167], v[84:87]
    buffer_store_dwordx4 a[124:127], v246, s[24:27], s69 offen offset:192 sc1
    v_cvt_pk_bf16_f32 v187, v154, v155
    v_mfma_f32_16x16x32_bf16 v[88:91], a[212:215], v[168:171], v[88:91]
    s_waitcnt lgkmcnt(2)
    v_exp_f32 v140, v140
    v_mfma_f32_16x16x32_bf16 v[92:95], a[212:215], v[172:175], v[92:95]
    ds_read_b64_tr_b16 a[192:193], v242 offset:8192
    v_mfma_f32_16x16x32_bf16 v[96:99], a[216:219], v[160:163], v[96:99]
    s_mov_b32 s69, s37
    v_exp_f32 v141, v141
    v_mfma_f32_16x16x32_bf16 v[100:103], a[216:219], v[164:167], v[100:103]
    ds_read_b64_tr_b16 a[194:195], v242 offset:12288
    v_cvt_pk_bf16_f32 v188, v140, v141
    v_mfma_f32_16x16x32_bf16 v[104:107], a[216:219], v[168:171], v[104:107]
    s_waitcnt lgkmcnt(2)
    v_exp_f32 v142, v142
    v_mfma_f32_16x16x32_bf16 v[108:111], a[216:219], v[172:175], v[108:111]
    ds_read_b64_tr_b16 a[196:197], v242 offset:8200
    v_mfma_f32_16x16x32_bf16 v[112:115], a[220:223], v[160:163], v[112:115]
    s_mov_b32 s37, s33
    v_exp_f32 v143, v143
    v_mfma_f32_16x16x32_bf16 v[116:119], a[220:223], v[164:167], v[116:119]
    ds_read_b64_tr_b16 a[198:199], v242 offset:12296
    v_cvt_pk_bf16_f32 v189, v142, v143
    v_mfma_f32_16x16x32_bf16 v[120:123], a[220:223], v[168:171], v[120:123]
    s_waitcnt lgkmcnt(15)
    v_exp_f32 v156, v156
    v_mfma_f32_16x16x32_bf16 v[124:127], a[220:223], v[172:175], v[124:127]
    ds_read_b64_tr_b16 a[200:201], v243 offset:8192
    v_mfma_f32_16x16x32_bf16 v[128:131], a[128:131], a[0:3], v[192:195]
    v_exp_f32_e64 v157, v157
    v_mfma_f32_16x16x32_bf16 v[128:131], a[132:135], a[4:7], v[128:131]
    ds_read_b64_tr_b16 a[202:203], v243 offset:12288
    v_cvt_pk_bf16_f32 v190, v156, v157
    v_mfma_f32_16x16x32_bf16 v[128:131], a[136:139], a[8:11], v[128:131]
    s_waitcnt lgkmcnt(15)
    v_exp_f32 v158, v158
    v_mfma_f32_16x16x32_bf16 v[128:131], a[140:143], a[12:15], v[128:131]
    ds_read_b64_tr_b16 a[204:205], v243 offset:8200
    v_mfma_f32_16x16x32_bf16 v[144:147], a[144:147], a[0:3], v[192:195]
    v_exp_f32_e64 v159, v159
    v_mfma_f32_16x16x32_bf16 v[144:147], a[148:151], a[4:7], v[144:147]
    ds_read_b64_tr_b16 a[206:207], v243 offset:12296
    v_cvt_pk_bf16_f32 v191, v158, v159
    v_mfma_f32_16x16x32_bf16 v[144:147], a[152:155], a[8:11], v[144:147]
    ds_read_b64_tr_b16 a[208:209], v244 offset:8192
    v_mfma_f32_16x16x32_bf16 v[144:147], a[156:159], a[12:15], v[144:147]
    v_exp_f32_e64 v128, v128
    v_mfma_f32_16x16x32_bf16 v[132:135], a[128:131], a[16:19], v[196:199]
    ds_read_b64_tr_b16 a[210:211], v244 offset:12288
    v_mfma_f32_16x16x32_bf16 v[132:135], a[132:135], a[20:23], v[132:135]
    v_exp_f32_e64 v129, v129
    v_mfma_f32_16x16x32_bf16 v[132:135], a[136:139], a[24:27], v[132:135]
    ds_read_b64_tr_b16 a[212:213], v244 offset:8200
    v_cvt_pk_bf16_f32 v160, v128, v129
    v_mfma_f32_16x16x32_bf16 v[132:135], a[140:143], a[28:31], v[132:135]
    v_exp_f32_e64 v130, v130
    v_mfma_f32_16x16x32_bf16 v[148:151], a[144:147], a[16:19], v[196:199]
    ds_read_b64_tr_b16 a[214:215], v244 offset:12296
    v_mfma_f32_16x16x32_bf16 v[148:151], a[148:151], a[20:23], v[148:151]
    v_exp_f32_e64 v131, v131
    v_mfma_f32_16x16x32_bf16 v[148:151], a[152:155], a[24:27], v[148:151]
    ds_read_b64_tr_b16 a[216:217], v245 offset:8192
    v_cvt_pk_bf16_f32 v161, v130, v131
    v_mfma_f32_16x16x32_bf16 v[148:151], a[156:159], a[28:31], v[148:151]
    v_exp_f32_e64 v144, v144
    v_mfma_f32_16x16x32_bf16 v[136:139], a[128:131], a[32:35], v[200:203]
    ds_read_b64_tr_b16 a[218:219], v245 offset:12288
    v_mfma_f32_16x16x32_bf16 v[136:139], a[132:135], a[36:39], v[136:139]
    v_exp_f32_e64 v145, v145
    v_mfma_f32_16x16x32_bf16 v[136:139], a[136:139], a[40:43], v[136:139]
    ds_read_b64_tr_b16 a[220:221], v245 offset:8200
    v_cvt_pk_bf16_f32 v162, v144, v145
    v_mfma_f32_16x16x32_bf16 v[136:139], a[140:143], a[44:47], v[136:139]
    v_exp_f32_e64 v146, v146
    v_mfma_f32_16x16x32_bf16 v[152:155], a[144:147], a[32:35], v[200:203]
    ds_read_b64_tr_b16 a[222:223], v245 offset:12296
    v_mfma_f32_16x16x32_bf16 v[152:155], a[148:151], a[36:39], v[152:155]
    v_exp_f32_e64 v147, v147
    v_mfma_f32_16x16x32_bf16 v[152:155], a[152:155], a[40:43], v[152:155]
    ds_read_b128 a[160:163], v240 offset:57344
    v_cvt_pk_bf16_f32 v163, v146, v147
    v_mfma_f32_16x16x32_bf16 v[152:155], a[156:159], a[44:47], v[152:155]
    v_exp_f32_e64 v132, v132
    v_mfma_f32_16x16x32_bf16 v[140:143], a[128:131], a[48:51], v[204:207]
    ds_read_b128 a[164:167], v240 offset:58368
    v_mfma_f32_16x16x32_bf16 v[140:143], a[132:135], a[52:55], v[140:143]
    v_exp_f32_e64 v133, v133
    v_mfma_f32_16x16x32_bf16 v[140:143], a[136:139], a[56:59], v[140:143]
    ds_read_b128 a[168:171], v240 offset:59392
    v_cvt_pk_bf16_f32 v164, v132, v133
    v_mfma_f32_16x16x32_bf16 v[140:143], a[140:143], a[60:63], v[140:143]
    v_exp_f32_e64 v134, v134
    v_mfma_f32_16x16x32_bf16 v[156:159], a[144:147], a[48:51], v[204:207]
    ds_read_b128 a[172:175], v240 offset:60416
    v_mfma_f32_16x16x32_bf16 v[156:159], a[148:151], a[52:55], v[156:159]
    v_exp_f32_e64 v135, v135
    v_mfma_f32_16x16x32_bf16 v[156:159], a[152:155], a[56:59], v[156:159]
    ds_read_b128 a[176:179], v240 offset:61440
    v_cvt_pk_bf16_f32 v165, v134, v135
    v_mfma_f32_16x16x32_bf16 v[156:159], a[156:159], a[60:63], v[156:159]
    v_exp_f32_e64 v148, v148
    v_mfma_f32_16x16x32_bf16 a[224:227], a[240:243], v[176:179], a[224:227]
    ds_read_b128 a[180:183], v240 offset:62464
    v_mfma_f32_16x16x32_bf16 a[228:231], a[240:243], v[180:183], a[228:231]
    s_waitcnt lgkmcnt(15)
    v_exp_f32 v149, v149
    v_mfma_f32_16x16x32_bf16 a[232:235], a[240:243], v[184:187], a[232:235]
    ds_read_b128 a[184:187], v240 offset:63488
    v_cvt_pk_bf16_f32 v166, v148, v149
    v_mfma_f32_16x16x32_bf16 a[236:239], a[240:243], v[188:191], a[236:239]
    v_exp_f32_e64 v150, v150
    v_mfma_f32_16x16x32_bf16 v[0:3], a[192:195], v[176:179], v[0:3]
    ds_read_b128 a[188:191], v240 offset:64512
    v_mfma_f32_16x16x32_bf16 v[4:7], a[192:195], v[180:183], v[4:7]
    s_waitcnt lgkmcnt(15)
    v_exp_f32 v151, v151
    v_mfma_f32_16x16x32_bf16 v[8:11], a[192:195], v[184:187], v[8:11]
    ds_read_b128 a[128:131], v241 offset:0
    v_cvt_pk_bf16_f32 v167, v150, v151
    v_mfma_f32_16x16x32_bf16 v[12:15], a[192:195], v[188:191], v[12:15]
    v_exp_f32_e64 v136, v136
    v_mfma_f32_16x16x32_bf16 v[16:19], a[196:199], v[176:179], v[16:19]
    ds_read_b128 a[132:135], v241 offset:1024
    v_mfma_f32_16x16x32_bf16 v[20:23], a[196:199], v[180:183], v[20:23]
    s_waitcnt lgkmcnt(15)
    v_exp_f32 v137, v137
    v_mfma_f32_16x16x32_bf16 v[24:27], a[196:199], v[184:187], v[24:27]
    ds_read_b128 a[136:139], v241 offset:2048
    v_cvt_pk_bf16_f32 v168, v136, v137
    v_mfma_f32_16x16x32_bf16 v[28:31], a[196:199], v[188:191], v[28:31]
    v_exp_f32_e64 v138, v138
    v_mfma_f32_16x16x32_bf16 v[32:35], a[200:203], v[176:179], v[32:35]
    ds_read_b128 a[140:143], v241 offset:3072
    v_mfma_f32_16x16x32_bf16 v[36:39], a[200:203], v[180:183], v[36:39]
    s_waitcnt lgkmcnt(15)
    v_exp_f32 v139, v139
    v_mfma_f32_16x16x32_bf16 v[40:43], a[200:203], v[184:187], v[40:43]
    ds_read_b128 a[144:147], v241 offset:4096
    v_cvt_pk_bf16_f32 v169, v138, v139
    v_mfma_f32_16x16x32_bf16 v[44:47], a[200:203], v[188:191], v[44:47]
    v_exp_f32_e64 v152, v152
    v_mfma_f32_16x16x32_bf16 v[48:51], a[204:207], v[176:179], v[48:51]
    ds_read_b128 a[148:151], v241 offset:5120
    v_mfma_f32_16x16x32_bf16 v[52:55], a[204:207], v[180:183], v[52:55]
    s_waitcnt lgkmcnt(15)
    v_exp_f32 v153, v153
    v_mfma_f32_16x16x32_bf16 v[56:59], a[204:207], v[184:187], v[56:59]
    ds_read_b128 a[152:155], v241 offset:6144
    v_cvt_pk_bf16_f32 v170, v152, v153
    v_mfma_f32_16x16x32_bf16 v[60:63], a[204:207], v[188:191], v[60:63]
    v_exp_f32_e64 v154, v154
    v_mfma_f32_16x16x32_bf16 v[64:67], a[208:211], v[176:179], v[64:67]
    ds_read_b128 a[156:159], v241 offset:7168
    v_mfma_f32_16x16x32_bf16 v[68:71], a[208:211], v[180:183], v[68:71]
    s_waitcnt lgkmcnt(15)
    v_exp_f32 v155, v155
    v_mfma_f32_16x16x32_bf16 v[72:75], a[208:211], v[184:187], v[72:75]
    v_cvt_pk_bf16_f32 v171, v154, v155
    v_mfma_f32_16x16x32_bf16 v[76:79], a[208:211], v[188:191], v[76:79]
    v_exp_f32_e64 v140, v140
    v_mfma_f32_16x16x32_bf16 v[80:83], a[212:215], v[176:179], v[80:83]
    v_mfma_f32_16x16x32_bf16 v[84:87], a[212:215], v[180:183], v[84:87]
    s_waitcnt lgkmcnt(15)
    v_exp_f32 v141, v141
    v_mfma_f32_16x16x32_bf16 v[88:91], a[212:215], v[184:187], v[88:91]
    v_cvt_pk_bf16_f32 v172, v140, v141
    v_mfma_f32_16x16x32_bf16 v[92:95], a[212:215], v[188:191], v[92:95]
    v_exp_f32_e64 v142, v142
    v_mfma_f32_16x16x32_bf16 v[96:99], a[216:219], v[176:179], v[96:99]
    v_mfma_f32_16x16x32_bf16 v[100:103], a[216:219], v[180:183], v[100:103]
    s_waitcnt lgkmcnt(15)
    v_exp_f32 v143, v143
    v_mfma_f32_16x16x32_bf16 v[104:107], a[216:219], v[184:187], v[104:107]
    v_cvt_pk_bf16_f32 v173, v142, v143
    v_mfma_f32_16x16x32_bf16 v[108:111], a[216:219], v[188:191], v[108:111]
    v_exp_f32_e64 v156, v156
    v_mfma_f32_16x16x32_bf16 v[112:115], a[220:223], v[176:179], v[112:115]
    v_mfma_f32_16x16x32_bf16 v[116:119], a[220:223], v[180:183], v[116:119]
    s_waitcnt lgkmcnt(12)
    v_exp_f32 v157, v157
    v_mfma_f32_16x16x32_bf16 v[120:123], a[220:223], v[184:187], v[120:123]
    v_cvt_pk_bf16_f32 v174, v156, v157
    v_mfma_f32_16x16x32_bf16 v[124:127], a[220:223], v[188:191], v[124:127]
    v_exp_f32_e64 v158, v158
    v_mfma_f32_16x16x32_bf16 v[128:131], a[160:163], a[0:3], v[192:195]
    v_mfma_f32_16x16x32_bf16 v[128:131], a[164:167], a[4:7], v[128:131]
    s_waitcnt lgkmcnt(8)
    v_exp_f32 v159, v159
    v_mfma_f32_16x16x32_bf16 v[128:131], a[168:171], a[8:11], v[128:131]
    v_cvt_pk_bf16_f32 v175, v158, v159
    v_mfma_f32_16x16x32_bf16 v[128:131], a[172:175], a[12:15], v[128:131]
    v_mfma_f32_16x16x32_bf16 v[144:147], a[176:179], a[0:3], v[192:195]
    v_mfma_f32_16x16x32_bf16 v[144:147], a[180:183], a[4:7], v[144:147]
    v_mfma_f32_16x16x32_bf16 v[144:147], a[184:187], a[8:11], v[144:147]
    v_mfma_f32_16x16x32_bf16 v[144:147], a[188:191], a[12:15], v[144:147]
    v_mfma_f32_16x16x32_bf16 v[132:135], a[160:163], a[16:19], v[196:199]
    s_waitcnt vmcnt(4)
    v_mfma_f32_16x16x32_bf16 v[132:135], a[164:167], a[20:23], v[132:135]
    s_barrier
    v_mfma_f32_16x16x32_bf16 v[132:135], a[168:171], a[24:27], v[132:135]
    v_exp_f32_e64 v128, v128
    v_mfma_f32_16x16x32_bf16 v[132:135], a[172:175], a[28:31], v[132:135]
    buffer_load_dwordx4 v247, s[20:23], s39 offen offset:0 lds
    v_mfma_f32_16x16x32_bf16 v[148:151], a[176:179], a[16:19], v[196:199]
    v_exp_f32_e64 v129, v129
    v_mfma_f32_16x16x32_bf16 v[148:151], a[180:183], a[20:23], v[148:151]
    buffer_load_dwordx4 v247, s[20:23], s39 offen offset:1024 lds
    v_cvt_pk_bf16_f32 v176, v128, v129
    v_mfma_f32_16x16x32_bf16 v[148:151], a[184:187], a[24:27], v[148:151]
    s_add_u32 m0, s40, 8192
    v_exp_f32_e64 v130, v130
    v_mfma_f32_16x16x32_bf16 v[148:151], a[188:191], a[28:31], v[148:151]
    buffer_load_dwordx4 v247, s[20:23], s51 offen offset:0 lds
    v_mfma_f32_16x16x32_bf16 v[136:139], a[160:163], a[32:35], v[200:203]
    s_add_u32 s39, s38, 81920
    v_exp_f32_e64 v131, v131
    v_mfma_f32_16x16x32_bf16 v[136:139], a[164:167], a[36:39], v[136:139]
    buffer_load_dwordx4 v247, s[20:23], s51 offen offset:1024 lds
    v_cvt_pk_bf16_f32 v177, v130, v131
    v_mfma_f32_16x16x32_bf16 v[136:139], a[168:171], a[40:43], v[136:139]
    s_add_u32 m0, s40, 16384
    v_exp_f32_e64 v144, v144
    v_mfma_f32_16x16x32_bf16 v[136:139], a[172:175], a[44:47], v[136:139]
    ds_read_b64_tr_b16 a[192:193], v242 offset:16384
    v_mfma_f32_16x16x32_bf16 v[152:155], a[176:179], a[32:35], v[200:203]
    s_add_u32 s51, s38, 90112
    v_exp_f32_e64 v145, v145
    v_mfma_f32_16x16x32_bf16 v[152:155], a[180:183], a[36:39], v[152:155]
    ds_read_b64_tr_b16 a[194:195], v242 offset:20480
    v_cvt_pk_bf16_f32 v178, v144, v145
    v_mfma_f32_16x16x32_bf16 v[152:155], a[184:187], a[40:43], v[152:155]
    v_exp_f32_e64 v146, v146
    v_mfma_f32_16x16x32_bf16 v[152:155], a[188:191], a[44:47], v[152:155]
    buffer_load_dwordx4 a[64:67], v246, s[12:15], s30 offen offset:0
    v_mfma_f32_16x16x32_bf16 v[140:143], a[160:163], a[48:51], v[204:207]
    v_exp_f32_e64 v147, v147
    v_mfma_f32_16x16x32_bf16 v[140:143], a[164:167], a[52:55], v[140:143]
    ds_read_b64_tr_b16 a[196:197], v242 offset:16392
    v_cvt_pk_bf16_f32 v179, v146, v147
    v_mfma_f32_16x16x32_bf16 v[140:143], a[168:171], a[56:59], v[140:143]
    v_exp_f32_e64 v132, v132
    v_mfma_f32_16x16x32_bf16 v[140:143], a[172:175], a[60:63], v[140:143]
    ds_read_b64_tr_b16 a[198:199], v242 offset:20488
    v_mfma_f32_16x16x32_bf16 v[156:159], a[176:179], a[48:51], v[204:207]
    v_exp_f32_e64 v133, v133
    v_mfma_f32_16x16x32_bf16 v[156:159], a[180:183], a[52:55], v[156:159]
    ds_read_b64_tr_b16 a[200:201], v243 offset:16384
    v_cvt_pk_bf16_f32 v180, v132, v133
    v_mfma_f32_16x16x32_bf16 v[156:159], a[184:187], a[56:59], v[156:159]
    v_exp_f32_e64 v134, v134
    v_mfma_f32_16x16x32_bf16 v[156:159], a[188:191], a[60:63], v[156:159]
    ds_read_b64_tr_b16 a[202:203], v243 offset:20480
    v_mfma_f32_16x16x32_bf16 a[224:227], a[240:243], v[160:163], a[224:227]
    v_exp_f32_e64 v135, v135
    v_mfma_f32_16x16x32_bf16 a[228:231], a[240:243], v[164:167], a[228:231]
    ds_read_b64_tr_b16 a[204:205], v243 offset:16392
    v_cvt_pk_bf16_f32 v181, v134, v135
    v_mfma_f32_16x16x32_bf16 a[232:235], a[240:243], v[168:171], a[232:235]
    s_waitcnt lgkmcnt(5)
    v_exp_f32 v148, v148
    v_mfma_f32_16x16x32_bf16 a[236:239], a[240:243], v[172:175], a[236:239]
    buffer_load_dwordx4 a[68:71], v246, s[12:15], s30 offen offset:64
    v_mfma_f32_16x16x32_bf16 v[0:3], a[192:195], v[160:163], v[0:3]
    v_exp_f32_e64 v149, v149
    v_mfma_f32_16x16x32_bf16 v[4:7], a[192:195], v[164:167], v[4:7]
    ds_read_b64_tr_b16 a[206:207], v243 offset:20488
    v_cvt_pk_bf16_f32 v182, v148, v149
    v_mfma_f32_16x16x32_bf16 v[8:11], a[192:195], v[168:171], v[8:11]
    s_waitcnt lgkmcnt(4)
    v_exp_f32 v150, v150
    v_mfma_f32_16x16x32_bf16 v[12:15], a[192:195], v[172:175], v[12:15]
    ds_read_b64_tr_b16 a[208:209], v244 offset:16384
    v_mfma_f32_16x16x32_bf16 v[16:19], a[196:199], v[160:163], v[16:19]
    v_exp_f32_e64 v151, v151
    v_mfma_f32_16x16x32_bf16 v[20:23], a[196:199], v[164:167], v[20:23]
    ds_read_b64_tr_b16 a[210:211], v244 offset:20480
    v_cvt_pk_bf16_f32 v183, v150, v151
    v_mfma_f32_16x16x32_bf16 v[24:27], a[196:199], v[168:171], v[24:27]
    s_waitcnt lgkmcnt(4)
    v_exp_f32 v136, v136
    v_mfma_f32_16x16x32_bf16 v[28:31], a[196:199], v[172:175], v[28:31]
    ds_read_b64_tr_b16 a[212:213], v244 offset:16392
    v_mfma_f32_16x16x32_bf16 v[32:35], a[200:203], v[160:163], v[32:35]
    v_exp_f32_e64 v137, v137
    v_mfma_f32_16x16x32_bf16 v[36:39], a[200:203], v[164:167], v[36:39]
    ds_read_b64_tr_b16 a[214:215], v244 offset:20488
    v_cvt_pk_bf16_f32 v184, v136, v137
    v_mfma_f32_16x16x32_bf16 v[40:43], a[200:203], v[168:171], v[40:43]
    s_waitcnt lgkmcnt(4)
    v_exp_f32 v138, v138
    v_mfma_f32_16x16x32_bf16 v[44:47], a[200:203], v[172:175], v[44:47]
    buffer_load_dwordx4 a[72:75], v246, s[12:15], s30 offen offset:128
    v_mfma_f32_16x16x32_bf16 v[48:51], a[204:207], v[160:163], v[48:51]
    v_exp_f32_e64 v139, v139
    v_mfma_f32_16x16x32_bf16 v[52:55], a[204:207], v[164:167], v[52:55]
    ds_read_b64_tr_b16 a[216:217], v245 offset:16384
    v_cvt_pk_bf16_f32 v185, v138, v139
    v_mfma_f32_16x16x32_bf16 v[56:59], a[204:207], v[168:171], v[56:59]
    s_waitcnt lgkmcnt(3)
    v_exp_f32 v152, v152
    v_mfma_f32_16x16x32_bf16 v[60:63], a[204:207], v[172:175], v[60:63]
    ds_read_b64_tr_b16 a[218:219], v245 offset:20480
    v_mfma_f32_16x16x32_bf16 v[64:67], a[208:211], v[160:163], v[64:67]
    v_exp_f32_e64 v153, v153
    v_mfma_f32_16x16x32_bf16 v[68:71], a[208:211], v[164:167], v[68:71]
    ds_read_b64_tr_b16 a[220:221], v245 offset:16392
    v_cvt_pk_bf16_f32 v186, v152, v153
    v_mfma_f32_16x16x32_bf16 v[72:75], a[208:211], v[168:171], v[72:75]
    s_waitcnt lgkmcnt(3)
    v_exp_f32 v154, v154
    v_mfma_f32_16x16x32_bf16 v[76:79], a[208:211], v[172:175], v[76:79]
    ds_read_b64_tr_b16 a[222:223], v245 offset:20488
    v_mfma_f32_16x16x32_bf16 v[80:83], a[212:215], v[160:163], v[80:83]
    v_exp_f32_e64 v155, v155
    v_mfma_f32_16x16x32_bf16 v[84:87], a[212:215], v[164:167], v[84:87]
    buffer_load_dwordx4 a[76:79], v246, s[12:15], s30 offen offset:192
    v_cvt_pk_bf16_f32 v187, v154, v155
    v_mfma_f32_16x16x32_bf16 v[88:91], a[212:215], v[168:171], v[88:91]
    s_waitcnt lgkmcnt(2)
    v_exp_f32 v140, v140
    v_mfma_f32_16x16x32_bf16 v[92:95], a[212:215], v[172:175], v[92:95]
    ds_read_b64_tr_b16 a[192:193], v242 offset:24576
    v_mfma_f32_16x16x32_bf16 v[96:99], a[216:219], v[160:163], v[96:99]
    s_add_u32 s45, s44, 0
    s_lshl_b32 s46, s45, 8
    s_add_u32 s46, s46, s41
    s_cmp_lt_u32 s45, 992
    s_cselect_b32 s30, s46, s50
    v_exp_f32_e64 v141, v141
    v_mfma_f32_16x16x32_bf16 v[100:103], a[216:219], v[164:167], v[100:103]
    ds_read_b64_tr_b16 a[194:195], v242 offset:28672
    v_cvt_pk_bf16_f32 v188, v140, v141
    v_mfma_f32_16x16x32_bf16 v[104:107], a[216:219], v[168:171], v[104:107]
    s_waitcnt lgkmcnt(2)
    v_exp_f32 v142, v142
    v_mfma_f32_16x16x32_bf16 v[108:111], a[216:219], v[172:175], v[108:111]
    ds_read_b64_tr_b16 a[196:197], v242 offset:24584
    v_mfma_f32_16x16x32_bf16 v[112:115], a[220:223], v[160:163], v[112:115]
    v_exp_f32_e64 v143, v143
    v_mfma_f32_16x16x32_bf16 v[116:119], a[220:223], v[164:167], v[116:119]
    ds_read_b64_tr_b16 a[198:199], v242 offset:28680
    v_cvt_pk_bf16_f32 v189, v142, v143
    v_mfma_f32_16x16x32_bf16 v[120:123], a[220:223], v[168:171], v[120:123]
    s_waitcnt lgkmcnt(15)
    v_exp_f32 v156, v156
    v_mfma_f32_16x16x32_bf16 v[124:127], a[220:223], v[172:175], v[124:127]
    buffer_load_dwordx4 a[80:83], v246, s[12:15], s31 offen offset:0
    v_mfma_f32_16x16x32_bf16 v[128:131], a[128:131], a[0:3], v[192:195]
    v_exp_f32_e64 v157, v157
    v_mfma_f32_16x16x32_bf16 v[128:131], a[132:135], a[4:7], v[128:131]
    ds_read_b64_tr_b16 a[200:201], v243 offset:24576
    v_cvt_pk_bf16_f32 v190, v156, v157
    v_mfma_f32_16x16x32_bf16 v[128:131], a[136:139], a[8:11], v[128:131]
    s_waitcnt lgkmcnt(15)
    v_exp_f32 v158, v158
    v_mfma_f32_16x16x32_bf16 v[128:131], a[140:143], a[12:15], v[128:131]
    ds_read_b64_tr_b16 a[202:203], v243 offset:28672
    v_mfma_f32_16x16x32_bf16 v[144:147], a[144:147], a[0:3], v[192:195]
    v_exp_f32_e64 v159, v159
    v_mfma_f32_16x16x32_bf16 v[144:147], a[148:151], a[4:7], v[144:147]
    ds_read_b64_tr_b16 a[204:205], v243 offset:24584
    v_cvt_pk_bf16_f32 v191, v158, v159
    v_mfma_f32_16x16x32_bf16 v[144:147], a[152:155], a[8:11], v[144:147]
    ds_read_b64_tr_b16 a[206:207], v243 offset:28680
    v_mfma_f32_16x16x32_bf16 v[144:147], a[156:159], a[12:15], v[144:147]
    v_exp_f32_e64 v128, v128
    v_mfma_f32_16x16x32_bf16 v[132:135], a[128:131], a[16:19], v[196:199]
    ds_read_b64_tr_b16 a[208:209], v244 offset:24576
    v_mfma_f32_16x16x32_bf16 v[132:135], a[132:135], a[20:23], v[132:135]
    v_exp_f32_e64 v129, v129
    v_mfma_f32_16x16x32_bf16 v[132:135], a[136:139], a[24:27], v[132:135]
    buffer_load_dwordx4 a[84:87], v246, s[12:15], s31 offen offset:64
    v_cvt_pk_bf16_f32 v160, v128, v129
    v_mfma_f32_16x16x32_bf16 v[132:135], a[140:143], a[28:31], v[132:135]
    v_exp_f32_e64 v130, v130
    v_mfma_f32_16x16x32_bf16 v[148:151], a[144:147], a[16:19], v[196:199]
    ds_read_b64_tr_b16 a[210:211], v244 offset:28672
    v_mfma_f32_16x16x32_bf16 v[148:151], a[148:151], a[20:23], v[148:151]
    v_exp_f32_e64 v131, v131
    v_mfma_f32_16x16x32_bf16 v[148:151], a[152:155], a[24:27], v[148:151]
    ds_read_b64_tr_b16 a[212:213], v244 offset:24584
    v_cvt_pk_bf16_f32 v161, v130, v131
    v_mfma_f32_16x16x32_bf16 v[148:151], a[156:159], a[28:31], v[148:151]
    v_exp_f32_e64 v144, v144
    v_mfma_f32_16x16x32_bf16 v[136:139], a[128:131], a[32:35], v[200:203]
    ds_read_b64_tr_b16 a[214:215], v244 offset:28680
    v_mfma_f32_16x16x32_bf16 v[136:139], a[132:135], a[36:39], v[136:139]
    v_exp_f32_e64 v145, v145
    v_mfma_f32_16x16x32_bf16 v[136:139], a[136:139], a[40:43], v[136:139]
    ds_read_b64_tr_b16 a[216:217], v245 offset:24576
    v_cvt_pk_bf16_f32 v162, v144, v145
    v_mfma_f32_16x16x32_bf16 v[136:139], a[140:143], a[44:47], v[136:139]
    v_exp_f32_e64 v146, v146
    v_mfma_f32_16x16x32_bf16 v[152:155], a[144:147], a[32:35], v[200:203]
    ds_read_b64_tr_b16 a[218:219], v245 offset:28672
    v_mfma_f32_16x16x32_bf16 v[152:155], a[148:151], a[36:39], v[152:155]
    v_exp_f32_e64 v147, v147
    v_mfma_f32_16x16x32_bf16 v[152:155], a[152:155], a[40:43], v[152:155]
    ds_read_b64_tr_b16 a[220:221], v245 offset:24584
    v_cvt_pk_bf16_f32 v163, v146, v147
    v_mfma_f32_16x16x32_bf16 v[152:155], a[156:159], a[44:47], v[152:155]
    v_exp_f32_e64 v132, v132
    v_mfma_f32_16x16x32_bf16 v[140:143], a[128:131], a[48:51], v[204:207]
    ds_read_b64_tr_b16 a[222:223], v245 offset:28680
    v_mfma_f32_16x16x32_bf16 v[140:143], a[132:135], a[52:55], v[140:143]
    v_exp_f32_e64 v133, v133
    v_mfma_f32_16x16x32_bf16 v[140:143], a[136:139], a[56:59], v[140:143]
    ds_read_b128 a[160:163], v241 offset:8192
    v_cvt_pk_bf16_f32 v164, v132, v133
    v_mfma_f32_16x16x32_bf16 v[140:143], a[140:143], a[60:63], v[140:143]
    v_exp_f32_e64 v134, v134
    v_mfma_f32_16x16x32_bf16 v[156:159], a[144:147], a[48:51], v[204:207]
    ds_read_b128 a[164:167], v241 offset:9216
    v_mfma_f32_16x16x32_bf16 v[156:159], a[148:151], a[52:55], v[156:159]
    v_exp_f32_e64 v135, v135
    v_mfma_f32_16x16x32_bf16 v[156:159], a[152:155], a[56:59], v[156:159]
    ds_read_b128 a[168:171], v241 offset:10240
    v_cvt_pk_bf16_f32 v165, v134, v135
    v_mfma_f32_16x16x32_bf16 v[156:159], a[156:159], a[60:63], v[156:159]
    v_exp_f32_e64 v148, v148
    v_mfma_f32_16x16x32_bf16 a[224:227], a[240:243], v[176:179], a[224:227]
    ds_read_b128 a[172:175], v241 offset:11264
    v_mfma_f32_16x16x32_bf16 a[228:231], a[240:243], v[180:183], a[228:231]
    s_waitcnt lgkmcnt(15)
    v_exp_f32 v149, v149
    v_mfma_f32_16x16x32_bf16 a[232:235], a[240:243], v[184:187], a[232:235]
    ds_read_b128 a[176:179], v241 offset:12288
    v_cvt_pk_bf16_f32 v166, v148, v149
    v_mfma_f32_16x16x32_bf16 a[236:239], a[240:243], v[188:191], a[236:239]
    v_exp_f32_e64 v150, v150
    v_mfma_f32_16x16x32_bf16 v[0:3], a[192:195], v[176:179], v[0:3]
    ds_read_b128 a[180:183], v241 offset:13312
    v_mfma_f32_16x16x32_bf16 v[4:7], a[192:195], v[180:183], v[4:7]
    s_waitcnt lgkmcnt(15)
    v_exp_f32 v151, v151
    v_mfma_f32_16x16x32_bf16 v[8:11], a[192:195], v[184:187], v[8:11]
    ds_read_b128 a[184:187], v241 offset:14336
    v_cvt_pk_bf16_f32 v167, v150, v151
    v_mfma_f32_16x16x32_bf16 v[12:15], a[192:195], v[188:191], v[12:15]
    v_exp_f32_e64 v136, v136
    v_mfma_f32_16x16x32_bf16 v[16:19], a[196:199], v[176:179], v[16:19]
    ds_read_b128 a[188:191], v241 offset:15360
    v_mfma_f32_16x16x32_bf16 v[20:23], a[196:199], v[180:183], v[20:23]
    s_waitcnt lgkmcnt(15)
    v_exp_f32 v137, v137
    v_mfma_f32_16x16x32_bf16 v[24:27], a[196:199], v[184:187], v[24:27]
    ds_read_b128 a[128:131], v241 offset:16384
    v_cvt_pk_bf16_f32 v168, v136, v137
    v_mfma_f32_16x16x32_bf16 v[28:31], a[196:199], v[188:191], v[28:31]
    v_exp_f32_e64 v138, v138
    v_mfma_f32_16x16x32_bf16 v[32:35], a[200:203], v[176:179], v[32:35]
    ds_read_b128 a[132:135], v241 offset:17408
    v_mfma_f32_16x16x32_bf16 v[36:39], a[200:203], v[180:183], v[36:39]
    s_waitcnt lgkmcnt(15)
    v_exp_f32 v139, v139
    v_mfma_f32_16x16x32_bf16 v[40:43], a[200:203], v[184:187], v[40:43]
    ds_read_b128 a[136:139], v241 offset:18432
    v_cvt_pk_bf16_f32 v169, v138, v139
    v_mfma_f32_16x16x32_bf16 v[44:47], a[200:203], v[188:191], v[44:47]
    v_exp_f32_e64 v152, v152
    v_mfma_f32_16x16x32_bf16 v[48:51], a[204:207], v[176:179], v[48:51]
    ds_read_b128 a[140:143], v241 offset:19456
    v_mfma_f32_16x16x32_bf16 v[52:55], a[204:207], v[180:183], v[52:55]
    s_waitcnt lgkmcnt(15)
    v_exp_f32 v153, v153
    v_mfma_f32_16x16x32_bf16 v[56:59], a[204:207], v[184:187], v[56:59]
    ds_read_b128 a[144:147], v241 offset:20480
    v_cvt_pk_bf16_f32 v170, v152, v153
    v_mfma_f32_16x16x32_bf16 v[60:63], a[204:207], v[188:191], v[60:63]
    v_exp_f32_e64 v154, v154
    v_mfma_f32_16x16x32_bf16 v[64:67], a[208:211], v[176:179], v[64:67]
    ds_read_b128 a[148:151], v241 offset:21504
    v_mfma_f32_16x16x32_bf16 v[68:71], a[208:211], v[180:183], v[68:71]
    s_waitcnt lgkmcnt(15)
    v_exp_f32 v155, v155
    v_mfma_f32_16x16x32_bf16 v[72:75], a[208:211], v[184:187], v[72:75]
    ds_read_b128 a[152:155], v241 offset:22528
    v_cvt_pk_bf16_f32 v171, v154, v155
    v_mfma_f32_16x16x32_bf16 v[76:79], a[208:211], v[188:191], v[76:79]
    v_exp_f32_e64 v140, v140
    v_mfma_f32_16x16x32_bf16 v[80:83], a[212:215], v[176:179], v[80:83]
    ds_read_b128 a[156:159], v241 offset:23552
    v_mfma_f32_16x16x32_bf16 v[84:87], a[212:215], v[180:183], v[84:87]
    s_waitcnt lgkmcnt(15)
    v_exp_f32 v141, v141
    v_mfma_f32_16x16x32_bf16 v[88:91], a[212:215], v[184:187], v[88:91]
    v_cvt_pk_bf16_f32 v172, v140, v141
    v_mfma_f32_16x16x32_bf16 v[92:95], a[212:215], v[188:191], v[92:95]
    v_exp_f32_e64 v142, v142
    v_mfma_f32_16x16x32_bf16 v[96:99], a[216:219], v[176:179], v[96:99]
    v_mfma_f32_16x16x32_bf16 v[100:103], a[216:219], v[180:183], v[100:103]
    s_waitcnt lgkmcnt(15)
    v_exp_f32 v143, v143
    v_mfma_f32_16x16x32_bf16 v[104:107], a[216:219], v[184:187], v[104:107]
    v_cvt_pk_bf16_f32 v173, v142, v143
    v_mfma_f32_16x16x32_bf16 v[108:111], a[216:219], v[188:191], v[108:111]
    v_exp_f32_e64 v156, v156
    v_mfma_f32_16x16x32_bf16 v[112:115], a[220:223], v[176:179], v[112:115]
    v_mfma_f32_16x16x32_bf16 v[116:119], a[220:223], v[180:183], v[116:119]
    s_waitcnt lgkmcnt(12)
    v_exp_f32 v157, v157
    v_mfma_f32_16x16x32_bf16 v[120:123], a[220:223], v[184:187], v[120:123]
    v_cvt_pk_bf16_f32 v174, v156, v157
    v_mfma_f32_16x16x32_bf16 v[124:127], a[220:223], v[188:191], v[124:127]
    v_exp_f32_e64 v158, v158
    v_mfma_f32_16x16x32_bf16 v[128:131], a[160:163], a[0:3], v[192:195]
    v_mfma_f32_16x16x32_bf16 v[128:131], a[164:167], a[4:7], v[128:131]
    s_waitcnt lgkmcnt(8)
    v_exp_f32 v159, v159
    v_mfma_f32_16x16x32_bf16 v[128:131], a[168:171], a[8:11], v[128:131]
    v_cvt_pk_bf16_f32 v175, v158, v159
    v_mfma_f32_16x16x32_bf16 v[128:131], a[172:175], a[12:15], v[128:131]
    v_mfma_f32_16x16x32_bf16 v[144:147], a[176:179], a[0:3], v[192:195]
    v_mfma_f32_16x16x32_bf16 v[144:147], a[180:183], a[4:7], v[144:147]
    v_mfma_f32_16x16x32_bf16 v[144:147], a[184:187], a[8:11], v[144:147]
    v_mfma_f32_16x16x32_bf16 v[144:147], a[188:191], a[12:15], v[144:147]
    v_mfma_f32_16x16x32_bf16 v[132:135], a[160:163], a[16:19], v[196:199]
    s_waitcnt vmcnt(6)
    v_mfma_f32_16x16x32_bf16 v[132:135], a[164:167], a[20:23], v[132:135]
    s_barrier
    v_mfma_f32_16x16x32_bf16 v[132:135], a[168:171], a[24:27], v[132:135]
    v_exp_f32_e64 v128, v128
    v_mfma_f32_16x16x32_bf16 v[132:135], a[172:175], a[28:31], v[132:135]
    buffer_load_dwordx4 v247, s[20:23], s39 offen offset:0 lds
    v_mfma_f32_16x16x32_bf16 v[148:151], a[176:179], a[16:19], v[196:199]
    v_exp_f32_e64 v129, v129
    v_mfma_f32_16x16x32_bf16 v[148:151], a[180:183], a[20:23], v[148:151]
    buffer_load_dwordx4 v247, s[20:23], s39 offen offset:1024 lds
    v_cvt_pk_bf16_f32 v176, v128, v129
    v_mfma_f32_16x16x32_bf16 v[148:151], a[184:187], a[24:27], v[148:151]
    s_add_u32 m0, s40, 24576
    v_exp_f32_e64 v130, v130
    v_mfma_f32_16x16x32_bf16 v[148:151], a[188:191], a[28:31], v[148:151]
    buffer_load_dwordx4 v247, s[20:23], s51 offen offset:0 lds
    v_mfma_f32_16x16x32_bf16 v[136:139], a[160:163], a[32:35], v[200:203]
    s_add_u32 s39, s38, 98304
    v_exp_f32_e64 v131, v131
    v_mfma_f32_16x16x32_bf16 v[136:139], a[164:167], a[36:39], v[136:139]
    buffer_load_dwordx4 v247, s[20:23], s51 offen offset:1024 lds
    v_cvt_pk_bf16_f32 v177, v130, v131
    v_mfma_f32_16x16x32_bf16 v[136:139], a[168:171], a[40:43], v[136:139]
    s_add_u32 m0, s40, 0
    v_exp_f32 v144, v144
    v_mfma_f32_16x16x32_bf16 v[136:139], a[172:175], a[44:47], v[136:139]
    ds_read_b64_tr_b16 a[192:193], v242 offset:0
    v_mfma_f32_16x16x32_bf16 v[152:155], a[176:179], a[32:35], v[200:203]
    s_add_u32 s51, s38, 106496
    v_exp_f32_e64 v145, v145
    v_mfma_f32_16x16x32_bf16 v[152:155], a[180:183], a[36:39], v[152:155]
    ds_read_b64_tr_b16 a[194:195], v242 offset:4096
    v_cvt_pk_bf16_f32 v178, v144, v145
    v_mfma_f32_16x16x32_bf16 v[152:155], a[184:187], a[40:43], v[152:155]
    v_exp_f32_e64 v146, v146
    v_mfma_f32_16x16x32_bf16 v[152:155], a[188:191], a[44:47], v[152:155]
    buffer_load_dwordx4 a[88:91], v246, s[12:15], s31 offen offset:128
    v_mfma_f32_16x16x32_bf16 v[140:143], a[160:163], a[48:51], v[204:207]
    v_exp_f32_e64 v147, v147
    v_mfma_f32_16x16x32_bf16 v[140:143], a[164:167], a[52:55], v[140:143]
    ds_read_b64_tr_b16 a[196:197], v242 offset:8
    v_cvt_pk_bf16_f32 v179, v146, v147
    v_mfma_f32_16x16x32_bf16 v[140:143], a[168:171], a[56:59], v[140:143]
    v_exp_f32_e64 v132, v132
    v_mfma_f32_16x16x32_bf16 v[140:143], a[172:175], a[60:63], v[140:143]
    ds_read_b64_tr_b16 a[198:199], v242 offset:4104
    v_mfma_f32_16x16x32_bf16 v[156:159], a[176:179], a[48:51], v[204:207]
    v_exp_f32_e64 v133, v133
    v_mfma_f32_16x16x32_bf16 v[156:159], a[180:183], a[52:55], v[156:159]
    ds_read_b64_tr_b16 a[200:201], v243 offset:0
    v_cvt_pk_bf16_f32 v180, v132, v133
    v_mfma_f32_16x16x32_bf16 v[156:159], a[184:187], a[56:59], v[156:159]
    v_exp_f32_e64 v134, v134
    v_mfma_f32_16x16x32_bf16 v[156:159], a[188:191], a[60:63], v[156:159]
    ds_read_b64_tr_b16 a[202:203], v243 offset:4096
    v_mfma_f32_16x16x32_bf16 a[224:227], a[240:243], v[160:163], a[224:227]
    v_exp_f32_e64 v135, v135
    v_mfma_f32_16x16x32_bf16 a[228:231], a[240:243], v[164:167], a[228:231]
    ds_read_b64_tr_b16 a[204:205], v243 offset:8
    v_cvt_pk_bf16_f32 v181, v134, v135
    v_mfma_f32_16x16x32_bf16 a[232:235], a[240:243], v[168:171], a[232:235]
    s_waitcnt lgkmcnt(5)
    v_exp_f32 v148, v148
    v_mfma_f32_16x16x32_bf16 a[236:239], a[240:243], v[172:175], a[236:239]
    buffer_load_dwordx4 a[92:95], v246, s[12:15], s31 offen offset:192
    v_mfma_f32_16x16x32_bf16 v[0:3], a[192:195], v[160:163], v[0:3]
    s_add_u32 s45, s44, 16
    s_lshl_b32 s46, s45, 8
    s_add_u32 s46, s46, s41
    s_cmp_lt_u32 s45, 992
    s_cselect_b32 s31, s46, s50
    v_exp_f32_e64 v149, v149
    v_mfma_f32_16x16x32_bf16 v[4:7], a[192:195], v[164:167], v[4:7]
    ds_read_b64_tr_b16 a[206:207], v243 offset:4104
    v_cvt_pk_bf16_f32 v182, v148, v149
    v_mfma_f32_16x16x32_bf16 v[8:11], a[192:195], v[168:171], v[8:11]
    s_waitcnt lgkmcnt(4)
    v_exp_f32 v150, v150
    v_mfma_f32_16x16x32_bf16 v[12:15], a[192:195], v[172:175], v[12:15]
    ds_read_b64_tr_b16 a[208:209], v244 offset:0
    v_mfma_f32_16x16x32_bf16 v[16:19], a[196:199], v[160:163], v[16:19]
    v_exp_f32_e64 v151, v151
    v_mfma_f32_16x16x32_bf16 v[20:23], a[196:199], v[164:167], v[20:23]
    ds_read_b64_tr_b16 a[210:211], v244 offset:4096
    v_cvt_pk_bf16_f32 v183, v150, v151
    v_mfma_f32_16x16x32_bf16 v[24:27], a[196:199], v[168:171], v[24:27]
    s_waitcnt lgkmcnt(4)
    v_exp_f32 v136, v136
    v_mfma_f32_16x16x32_bf16 v[28:31], a[196:199], v[172:175], v[28:31]
    ds_read_b64_tr_b16 a[212:213], v244 offset:8
    v_mfma_f32_16x16x32_bf16 v[32:35], a[200:203], v[160:163], v[32:35]
    v_exp_f32_e64 v137, v137
    v_mfma_f32_16x16x32_bf16 v[36:39], a[200:203], v[164:167], v[36:39]
    ds_read_b64_tr_b16 a[214:215], v244 offset:4104
    v_cvt_pk_bf16_f32 v184, v136, v137
    v_mfma_f32_16x16x32_bf16 v[40:43], a[200:203], v[168:171], v[40:43]
    s_waitcnt lgkmcnt(4)
    v_exp_f32 v138, v138
    v_mfma_f32_16x16x32_bf16 v[44:47], a[200:203], v[172:175], v[44:47]
    buffer_load_dwordx4 a[96:99], v246, s[12:15], s32 offen offset:0
    v_mfma_f32_16x16x32_bf16 v[48:51], a[204:207], v[160:163], v[48:51]
    v_exp_f32_e64 v139, v139
    v_mfma_f32_16x16x32_bf16 v[52:55], a[204:207], v[164:167], v[52:55]
    ds_read_b64_tr_b16 a[216:217], v245 offset:0
    v_cvt_pk_bf16_f32 v185, v138, v139
    v_mfma_f32_16x16x32_bf16 v[56:59], a[204:207], v[168:171], v[56:59]
    s_waitcnt lgkmcnt(3)
    v_exp_f32 v152, v152
    v_mfma_f32_16x16x32_bf16 v[60:63], a[204:207], v[172:175], v[60:63]
    ds_read_b64_tr_b16 a[218:219], v245 offset:4096
    v_mfma_f32_16x16x32_bf16 v[64:67], a[208:211], v[160:163], v[64:67]
    v_exp_f32_e64 v153, v153
    v_mfma_f32_16x16x32_bf16 v[68:71], a[208:211], v[164:167], v[68:71]
    ds_read_b64_tr_b16 a[220:221], v245 offset:8
    v_cvt_pk_bf16_f32 v186, v152, v153
    v_mfma_f32_16x16x32_bf16 v[72:75], a[208:211], v[168:171], v[72:75]
    s_waitcnt lgkmcnt(3)
    v_exp_f32 v154, v154
    v_mfma_f32_16x16x32_bf16 v[76:79], a[208:211], v[172:175], v[76:79]
    ds_read_b64_tr_b16 a[222:223], v245 offset:4104
    v_mfma_f32_16x16x32_bf16 v[80:83], a[212:215], v[160:163], v[80:83]
    v_exp_f32_e64 v155, v155
    v_mfma_f32_16x16x32_bf16 v[84:87], a[212:215], v[164:167], v[84:87]
    buffer_load_dwordx4 a[100:103], v246, s[12:15], s32 offen offset:64
    v_cvt_pk_bf16_f32 v187, v154, v155
    v_mfma_f32_16x16x32_bf16 v[88:91], a[212:215], v[168:171], v[88:91]
    s_waitcnt lgkmcnt(2)
    v_exp_f32 v140, v140
    v_mfma_f32_16x16x32_bf16 v[92:95], a[212:215], v[172:175], v[92:95]
    ds_read_b64_tr_b16 a[192:193], v242 offset:8192
    v_mfma_f32_16x16x32_bf16 v[96:99], a[216:219], v[160:163], v[96:99]
    v_exp_f32_e64 v141, v141
    v_mfma_f32_16x16x32_bf16 v[100:103], a[216:219], v[164:167], v[100:103]
    ds_read_b64_tr_b16 a[194:195], v242 offset:12288
    v_cvt_pk_bf16_f32 v188, v140, v141
    v_mfma_f32_16x16x32_bf16 v[104:107], a[216:219], v[168:171], v[104:107]
    s_waitcnt lgkmcnt(2)
    v_exp_f32 v142, v142
    v_mfma_f32_16x16x32_bf16 v[108:111], a[216:219], v[172:175], v[108:111]
    ds_read_b64_tr_b16 a[196:197], v242 offset:8200
    v_mfma_f32_16x16x32_bf16 v[112:115], a[220:223], v[160:163], v[112:115]
    v_exp_f32_e64 v143, v143
    v_mfma_f32_16x16x32_bf16 v[116:119], a[220:223], v[164:167], v[116:119]
    ds_read_b64_tr_b16 a[198:199], v242 offset:12296
    v_cvt_pk_bf16_f32 v189, v142, v143
    v_mfma_f32_16x16x32_bf16 v[120:123], a[220:223], v[168:171], v[120:123]
    s_waitcnt lgkmcnt(15)
    v_exp_f32 v156, v156
    v_mfma_f32_16x16x32_bf16 v[124:127], a[220:223], v[172:175], v[124:127]
    buffer_load_dwordx4 a[104:107], v246, s[12:15], s32 offen offset:128
    v_mfma_f32_16x16x32_bf16 v[128:131], a[128:131], a[0:3], v[192:195]
    v_exp_f32_e64 v157, v157
    v_mfma_f32_16x16x32_bf16 v[128:131], a[132:135], a[4:7], v[128:131]
    ds_read_b64_tr_b16 a[200:201], v243 offset:8192
    v_cvt_pk_bf16_f32 v190, v156, v157
    v_mfma_f32_16x16x32_bf16 v[128:131], a[136:139], a[8:11], v[128:131]
    s_waitcnt lgkmcnt(15)
    v_exp_f32 v158, v158
    v_mfma_f32_16x16x32_bf16 v[128:131], a[140:143], a[12:15], v[128:131]
    ds_read_b64_tr_b16 a[202:203], v243 offset:12288
    v_mfma_f32_16x16x32_bf16 v[144:147], a[144:147], a[0:3], v[192:195]
    v_exp_f32_e64 v159, v159
    v_mfma_f32_16x16x32_bf16 v[144:147], a[148:151], a[4:7], v[144:147]
    ds_read_b64_tr_b16 a[204:205], v243 offset:8200
    v_cvt_pk_bf16_f32 v191, v158, v159
    v_mfma_f32_16x16x32_bf16 v[144:147], a[152:155], a[8:11], v[144:147]
    ds_read_b64_tr_b16 a[206:207], v243 offset:12296
    v_mfma_f32_16x16x32_bf16 v[144:147], a[156:159], a[12:15], v[144:147]
    v_exp_f32_e64 v128, v128
    v_mfma_f32_16x16x32_bf16 v[132:135], a[128:131], a[16:19], v[196:199]
    ds_read_b64_tr_b16 a[208:209], v244 offset:8192
    v_mfma_f32_16x16x32_bf16 v[132:135], a[132:135], a[20:23], v[132:135]
    v_exp_f32_e64 v129, v129
    v_mfma_f32_16x16x32_bf16 v[132:135], a[136:139], a[24:27], v[132:135]
    buffer_load_dwordx4 a[108:111], v246, s[12:15], s32 offen offset:192
    v_cvt_pk_bf16_f32 v160, v128, v129
    v_mfma_f32_16x16x32_bf16 v[132:135], a[140:143], a[28:31], v[132:135]
    s_add_u32 s45, s44, 32
    s_lshl_b32 s46, s45, 8
    s_add_u32 s46, s46, s41
    s_cmp_lt_u32 s45, 992
    s_cselect_b32 s32, s46, s50
    v_exp_f32_e64 v130, v130
    v_mfma_f32_16x16x32_bf16 v[148:151], a[144:147], a[16:19], v[196:199]
    ds_read_b64_tr_b16 a[210:211], v244 offset:12288
    v_mfma_f32_16x16x32_bf16 v[148:151], a[148:151], a[20:23], v[148:151]
    v_exp_f32_e64 v131, v131
    v_mfma_f32_16x16x32_bf16 v[148:151], a[152:155], a[24:27], v[148:151]
    ds_read_b64_tr_b16 a[212:213], v244 offset:8200
    v_cvt_pk_bf16_f32 v161, v130, v131
    v_mfma_f32_16x16x32_bf16 v[148:151], a[156:159], a[28:31], v[148:151]
    v_exp_f32_e64 v144, v144
    v_mfma_f32_16x16x32_bf16 v[136:139], a[128:131], a[32:35], v[200:203]
    ds_read_b64_tr_b16 a[214:215], v244 offset:12296
    v_mfma_f32_16x16x32_bf16 v[136:139], a[132:135], a[36:39], v[136:139]
    v_exp_f32_e64 v145, v145
    v_mfma_f32_16x16x32_bf16 v[136:139], a[136:139], a[40:43], v[136:139]
    ds_read_b64_tr_b16 a[216:217], v245 offset:8192
    v_cvt_pk_bf16_f32 v162, v144, v145
    v_mfma_f32_16x16x32_bf16 v[136:139], a[140:143], a[44:47], v[136:139]
    v_exp_f32_e64 v146, v146
    v_mfma_f32_16x16x32_bf16 v[152:155], a[144:147], a[32:35], v[200:203]
    ds_read_b64_tr_b16 a[218:219], v245 offset:12288
    v_mfma_f32_16x16x32_bf16 v[152:155], a[148:151], a[36:39], v[152:155]
    v_exp_f32_e64 v147, v147
    v_mfma_f32_16x16x32_bf16 v[152:155], a[152:155], a[40:43], v[152:155]
    ds_read_b64_tr_b16 a[220:221], v245 offset:8200
    v_cvt_pk_bf16_f32 v163, v146, v147
    v_mfma_f32_16x16x32_bf16 v[152:155], a[156:159], a[44:47], v[152:155]
    v_exp_f32_e64 v132, v132
    v_mfma_f32_16x16x32_bf16 v[140:143], a[128:131], a[48:51], v[204:207]
    ds_read_b64_tr_b16 a[222:223], v245 offset:12296
    v_mfma_f32_16x16x32_bf16 v[140:143], a[132:135], a[52:55], v[140:143]
    v_exp_f32_e64 v133, v133
    v_mfma_f32_16x16x32_bf16 v[140:143], a[136:139], a[56:59], v[140:143]
    ds_read_b128 a[160:163], v241 offset:24576
    v_cvt_pk_bf16_f32 v164, v132, v133
    v_mfma_f32_16x16x32_bf16 v[140:143], a[140:143], a[60:63], v[140:143]
    v_exp_f32_e64 v134, v134
    v_mfma_f32_16x16x32_bf16 v[156:159], a[144:147], a[48:51], v[204:207]
    ds_read_b128 a[164:167], v241 offset:25600
    v_mfma_f32_16x16x32_bf16 v[156:159], a[148:151], a[52:55], v[156:159]
    v_exp_f32_e64 v135, v135
    v_mfma_f32_16x16x32_bf16 v[156:159], a[152:155], a[56:59], v[156:159]
    ds_read_b128 a[168:171], v241 offset:26624
    v_cvt_pk_bf16_f32 v165, v134, v135
    v_mfma_f32_16x16x32_bf16 v[156:159], a[156:159], a[60:63], v[156:159]
    v_exp_f32_e64 v148, v148
    v_mfma_f32_16x16x32_bf16 a[224:227], a[240:243], v[176:179], a[224:227]
    ds_read_b128 a[172:175], v241 offset:27648
    v_mfma_f32_16x16x32_bf16 a[228:231], a[240:243], v[180:183], a[228:231]
    s_waitcnt lgkmcnt(15)
    v_exp_f32 v149, v149
    v_mfma_f32_16x16x32_bf16 a[232:235], a[240:243], v[184:187], a[232:235]
    ds_read_b128 a[176:179], v241 offset:28672
    v_cvt_pk_bf16_f32 v166, v148, v149
    v_mfma_f32_16x16x32_bf16 a[236:239], a[240:243], v[188:191], a[236:239]
    v_exp_f32_e64 v150, v150
    v_mfma_f32_16x16x32_bf16 v[0:3], a[192:195], v[176:179], v[0:3]
    ds_read_b128 a[180:183], v241 offset:29696
    v_mfma_f32_16x16x32_bf16 v[4:7], a[192:195], v[180:183], v[4:7]
    s_waitcnt lgkmcnt(15)
    v_exp_f32 v151, v151
    v_mfma_f32_16x16x32_bf16 v[8:11], a[192:195], v[184:187], v[8:11]
    ds_read_b128 a[184:187], v241 offset:30720
    v_cvt_pk_bf16_f32 v167, v150, v151
    v_mfma_f32_16x16x32_bf16 v[12:15], a[192:195], v[188:191], v[12:15]
    v_exp_f32_e64 v136, v136
    v_mfma_f32_16x16x32_bf16 v[16:19], a[196:199], v[176:179], v[16:19]
    ds_read_b128 a[188:191], v241 offset:31744
    v_mfma_f32_16x16x32_bf16 v[20:23], a[196:199], v[180:183], v[20:23]
    s_waitcnt lgkmcnt(15)
    v_exp_f32 v137, v137
    v_mfma_f32_16x16x32_bf16 v[24:27], a[196:199], v[184:187], v[24:27]
    ds_read_b128 a[128:131], v241 offset:32768
    v_cvt_pk_bf16_f32 v168, v136, v137
    v_mfma_f32_16x16x32_bf16 v[28:31], a[196:199], v[188:191], v[28:31]
    v_exp_f32_e64 v138, v138
    v_mfma_f32_16x16x32_bf16 v[32:35], a[200:203], v[176:179], v[32:35]
    ds_read_b128 a[132:135], v241 offset:33792
    v_mfma_f32_16x16x32_bf16 v[36:39], a[200:203], v[180:183], v[36:39]
    s_waitcnt lgkmcnt(15)
    v_exp_f32 v139, v139
    v_mfma_f32_16x16x32_bf16 v[40:43], a[200:203], v[184:187], v[40:43]
    ds_read_b128 a[136:139], v241 offset:34816
    v_cvt_pk_bf16_f32 v169, v138, v139
    v_mfma_f32_16x16x32_bf16 v[44:47], a[200:203], v[188:191], v[44:47]
    v_exp_f32_e64 v152, v152
    v_mfma_f32_16x16x32_bf16 v[48:51], a[204:207], v[176:179], v[48:51]
    ds_read_b128 a[140:143], v241 offset:35840
    v_mfma_f32_16x16x32_bf16 v[52:55], a[204:207], v[180:183], v[52:55]
    s_waitcnt lgkmcnt(15)
    v_exp_f32 v153, v153
    v_mfma_f32_16x16x32_bf16 v[56:59], a[204:207], v[184:187], v[56:59]
    ds_read_b128 a[144:147], v241 offset:36864
    v_cvt_pk_bf16_f32 v170, v152, v153
    v_mfma_f32_16x16x32_bf16 v[60:63], a[204:207], v[188:191], v[60:63]
    v_exp_f32_e64 v154, v154
    v_mfma_f32_16x16x32_bf16 v[64:67], a[208:211], v[176:179], v[64:67]
    ds_read_b128 a[148:151], v241 offset:37888
    v_mfma_f32_16x16x32_bf16 v[68:71], a[208:211], v[180:183], v[68:71]
    s_waitcnt lgkmcnt(15)
    v_exp_f32 v155, v155
    v_mfma_f32_16x16x32_bf16 v[72:75], a[208:211], v[184:187], v[72:75]
    ds_read_b128 a[152:155], v241 offset:38912
    v_cvt_pk_bf16_f32 v171, v154, v155
    v_mfma_f32_16x16x32_bf16 v[76:79], a[208:211], v[188:191], v[76:79]
    v_exp_f32_e64 v140, v140
    v_mfma_f32_16x16x32_bf16 v[80:83], a[212:215], v[176:179], v[80:83]
    ds_read_b128 a[156:159], v241 offset:39936
    v_mfma_f32_16x16x32_bf16 v[84:87], a[212:215], v[180:183], v[84:87]
    s_waitcnt lgkmcnt(15)
    v_exp_f32 v141, v141
    v_mfma_f32_16x16x32_bf16 v[88:91], a[212:215], v[184:187], v[88:91]
    v_cvt_pk_bf16_f32 v172, v140, v141
    v_mfma_f32_16x16x32_bf16 v[92:95], a[212:215], v[188:191], v[92:95]
    v_exp_f32_e64 v142, v142
    v_mfma_f32_16x16x32_bf16 v[96:99], a[216:219], v[176:179], v[96:99]
    v_mfma_f32_16x16x32_bf16 v[100:103], a[216:219], v[180:183], v[100:103]
    s_waitcnt lgkmcnt(15)
    v_exp_f32 v143, v143
    v_mfma_f32_16x16x32_bf16 v[104:107], a[216:219], v[184:187], v[104:107]
    v_cvt_pk_bf16_f32 v173, v142, v143
    v_mfma_f32_16x16x32_bf16 v[108:111], a[216:219], v[188:191], v[108:111]
    v_exp_f32_e64 v156, v156
    v_mfma_f32_16x16x32_bf16 v[112:115], a[220:223], v[176:179], v[112:115]
    v_mfma_f32_16x16x32_bf16 v[116:119], a[220:223], v[180:183], v[116:119]
    s_waitcnt lgkmcnt(12)
    v_exp_f32 v157, v157
    v_mfma_f32_16x16x32_bf16 v[120:123], a[220:223], v[184:187], v[120:123]
    v_cvt_pk_bf16_f32 v174, v156, v157
    v_mfma_f32_16x16x32_bf16 v[124:127], a[220:223], v[188:191], v[124:127]
    v_exp_f32_e64 v158, v158
    v_mfma_f32_16x16x32_bf16 v[128:131], a[160:163], a[0:3], v[192:195]
    v_mfma_f32_16x16x32_bf16 v[128:131], a[164:167], a[4:7], v[128:131]
    s_waitcnt lgkmcnt(8)
    v_exp_f32 v159, v159
    v_mfma_f32_16x16x32_bf16 v[128:131], a[168:171], a[8:11], v[128:131]
    v_cvt_pk_bf16_f32 v175, v158, v159
    v_mfma_f32_16x16x32_bf16 v[128:131], a[172:175], a[12:15], v[128:131]
    v_mfma_f32_16x16x32_bf16 v[144:147], a[176:179], a[0:3], v[192:195]
    v_mfma_f32_16x16x32_bf16 v[144:147], a[180:183], a[4:7], v[144:147]
    v_mfma_f32_16x16x32_bf16 v[144:147], a[184:187], a[8:11], v[144:147]
    v_mfma_f32_16x16x32_bf16 v[144:147], a[188:191], a[12:15], v[144:147]
    v_mfma_f32_16x16x32_bf16 v[132:135], a[160:163], a[16:19], v[196:199]
    s_waitcnt vmcnt(6)
    v_mfma_f32_16x16x32_bf16 v[132:135], a[164:167], a[20:23], v[132:135]
    s_barrier
    v_mfma_f32_16x16x32_bf16 v[132:135], a[168:171], a[24:27], v[132:135]
    v_exp_f32_e64 v128, v128
    v_mfma_f32_16x16x32_bf16 v[132:135], a[172:175], a[28:31], v[132:135]
    buffer_load_dwordx4 v247, s[20:23], s39 offen offset:0 lds
    v_mfma_f32_16x16x32_bf16 v[148:151], a[176:179], a[16:19], v[196:199]
    v_exp_f32_e64 v129, v129
    v_mfma_f32_16x16x32_bf16 v[148:151], a[180:183], a[20:23], v[148:151]
    buffer_load_dwordx4 v247, s[20:23], s39 offen offset:1024 lds
    v_cvt_pk_bf16_f32 v176, v128, v129
    v_mfma_f32_16x16x32_bf16 v[148:151], a[184:187], a[24:27], v[148:151]
    s_add_u32 m0, s40, 8192
    v_exp_f32_e64 v130, v130
    v_mfma_f32_16x16x32_bf16 v[148:151], a[188:191], a[28:31], v[148:151]
    buffer_load_dwordx4 v247, s[20:23], s51 offen offset:0 lds
    v_mfma_f32_16x16x32_bf16 v[136:139], a[160:163], a[32:35], v[200:203]
    s_add_u32 s39, s38, 114688
    v_exp_f32_e64 v131, v131
    v_mfma_f32_16x16x32_bf16 v[136:139], a[164:167], a[36:39], v[136:139]
    buffer_load_dwordx4 v247, s[20:23], s51 offen offset:1024 lds
    v_cvt_pk_bf16_f32 v177, v130, v131
    v_mfma_f32_16x16x32_bf16 v[136:139], a[168:171], a[40:43], v[136:139]
    s_add_u32 m0, s40, 16384
    v_exp_f32_e64 v144, v144
    v_mfma_f32_16x16x32_bf16 v[136:139], a[172:175], a[44:47], v[136:139]
    ds_read_b64_tr_b16 a[192:193], v242 offset:16384
    v_mfma_f32_16x16x32_bf16 v[152:155], a[176:179], a[32:35], v[200:203]
    s_add_u32 s51, s38, 122880
    v_exp_f32_e64 v145, v145
    v_mfma_f32_16x16x32_bf16 v[152:155], a[180:183], a[36:39], v[152:155]
    ds_read_b64_tr_b16 a[194:195], v242 offset:20480
    v_cvt_pk_bf16_f32 v178, v144, v145
    v_mfma_f32_16x16x32_bf16 v[152:155], a[184:187], a[40:43], v[152:155]
    v_exp_f32_e64 v146, v146
    v_mfma_f32_16x16x32_bf16 v[152:155], a[188:191], a[44:47], v[152:155]
    buffer_load_dwordx4 a[112:115], v246, s[12:15], s33 offen offset:0
    v_mfma_f32_16x16x32_bf16 v[140:143], a[160:163], a[48:51], v[204:207]
    v_exp_f32_e64 v147, v147
    v_mfma_f32_16x16x32_bf16 v[140:143], a[164:167], a[52:55], v[140:143]
    ds_read_b64_tr_b16 a[196:197], v242 offset:16392
    v_cvt_pk_bf16_f32 v179, v146, v147
    v_mfma_f32_16x16x32_bf16 v[140:143], a[168:171], a[56:59], v[140:143]
    v_exp_f32_e64 v132, v132
    v_mfma_f32_16x16x32_bf16 v[140:143], a[172:175], a[60:63], v[140:143]
    ds_read_b64_tr_b16 a[198:199], v242 offset:20488
    v_mfma_f32_16x16x32_bf16 v[156:159], a[176:179], a[48:51], v[204:207]
    v_exp_f32_e64 v133, v133
    v_mfma_f32_16x16x32_bf16 v[156:159], a[180:183], a[52:55], v[156:159]
    ds_read_b64_tr_b16 a[200:201], v243 offset:16384
    v_cvt_pk_bf16_f32 v180, v132, v133
    v_mfma_f32_16x16x32_bf16 v[156:159], a[184:187], a[56:59], v[156:159]
    v_exp_f32_e64 v134, v134
    v_mfma_f32_16x16x32_bf16 v[156:159], a[188:191], a[60:63], v[156:159]
    ds_read_b64_tr_b16 a[202:203], v243 offset:20480
    v_mfma_f32_16x16x32_bf16 a[224:227], a[240:243], v[160:163], a[224:227]
    v_exp_f32_e64 v135, v135
    v_mfma_f32_16x16x32_bf16 a[228:231], a[240:243], v[164:167], a[228:231]
    ds_read_b64_tr_b16 a[204:205], v243 offset:16392
    v_cvt_pk_bf16_f32 v181, v134, v135
    v_mfma_f32_16x16x32_bf16 a[232:235], a[240:243], v[168:171], a[232:235]
    s_waitcnt lgkmcnt(5)
    v_exp_f32 v148, v148
    v_mfma_f32_16x16x32_bf16 a[236:239], a[240:243], v[172:175], a[236:239]
    buffer_load_dwordx4 a[116:119], v246, s[12:15], s33 offen offset:64
    v_mfma_f32_16x16x32_bf16 v[0:3], a[192:195], v[160:163], v[0:3]
    v_exp_f32_e64 v149, v149
    v_mfma_f32_16x16x32_bf16 v[4:7], a[192:195], v[164:167], v[4:7]
    ds_read_b64_tr_b16 a[206:207], v243 offset:20488
    v_cvt_pk_bf16_f32 v182, v148, v149
    v_mfma_f32_16x16x32_bf16 v[8:11], a[192:195], v[168:171], v[8:11]
    s_waitcnt lgkmcnt(4)
    v_exp_f32 v150, v150
    v_mfma_f32_16x16x32_bf16 v[12:15], a[192:195], v[172:175], v[12:15]
    ds_read_b64_tr_b16 a[208:209], v244 offset:16384
    v_mfma_f32_16x16x32_bf16 v[16:19], a[196:199], v[160:163], v[16:19]
    v_exp_f32_e64 v151, v151
    v_mfma_f32_16x16x32_bf16 v[20:23], a[196:199], v[164:167], v[20:23]
    ds_read_b64_tr_b16 a[210:211], v244 offset:20480
    v_cvt_pk_bf16_f32 v183, v150, v151
    v_mfma_f32_16x16x32_bf16 v[24:27], a[196:199], v[168:171], v[24:27]
    s_waitcnt lgkmcnt(4)
    v_exp_f32 v136, v136
    v_mfma_f32_16x16x32_bf16 v[28:31], a[196:199], v[172:175], v[28:31]
    ds_read_b64_tr_b16 a[212:213], v244 offset:16392
    v_mfma_f32_16x16x32_bf16 v[32:35], a[200:203], v[160:163], v[32:35]
    v_exp_f32_e64 v137, v137
    v_mfma_f32_16x16x32_bf16 v[36:39], a[200:203], v[164:167], v[36:39]
    ds_read_b64_tr_b16 a[214:215], v244 offset:20488
    v_cvt_pk_bf16_f32 v184, v136, v137
    v_mfma_f32_16x16x32_bf16 v[40:43], a[200:203], v[168:171], v[40:43]
    s_waitcnt lgkmcnt(4)
    v_exp_f32 v138, v138
    v_mfma_f32_16x16x32_bf16 v[44:47], a[200:203], v[172:175], v[44:47]
    buffer_load_dwordx4 a[120:123], v246, s[12:15], s33 offen offset:128
    v_mfma_f32_16x16x32_bf16 v[48:51], a[204:207], v[160:163], v[48:51]
    v_exp_f32_e64 v139, v139
    v_mfma_f32_16x16x32_bf16 v[52:55], a[204:207], v[164:167], v[52:55]
    ds_read_b64_tr_b16 a[216:217], v245 offset:16384
    v_cvt_pk_bf16_f32 v185, v138, v139
    v_mfma_f32_16x16x32_bf16 v[56:59], a[204:207], v[168:171], v[56:59]
    s_waitcnt lgkmcnt(3)
    v_exp_f32 v152, v152
    v_mfma_f32_16x16x32_bf16 v[60:63], a[204:207], v[172:175], v[60:63]
    ds_read_b64_tr_b16 a[218:219], v245 offset:20480
    v_mfma_f32_16x16x32_bf16 v[64:67], a[208:211], v[160:163], v[64:67]
    v_exp_f32_e64 v153, v153
    v_mfma_f32_16x16x32_bf16 v[68:71], a[208:211], v[164:167], v[68:71]
    ds_read_b64_tr_b16 a[220:221], v245 offset:16392
    v_cvt_pk_bf16_f32 v186, v152, v153
    v_mfma_f32_16x16x32_bf16 v[72:75], a[208:211], v[168:171], v[72:75]
    s_waitcnt lgkmcnt(3)
    v_exp_f32 v154, v154
    v_mfma_f32_16x16x32_bf16 v[76:79], a[208:211], v[172:175], v[76:79]
    ds_read_b64_tr_b16 a[222:223], v245 offset:20488
    v_mfma_f32_16x16x32_bf16 v[80:83], a[212:215], v[160:163], v[80:83]
    v_exp_f32_e64 v155, v155
    v_mfma_f32_16x16x32_bf16 v[84:87], a[212:215], v[164:167], v[84:87]
    buffer_load_dwordx4 a[124:127], v246, s[12:15], s33 offen offset:192
    v_cvt_pk_bf16_f32 v187, v154, v155
    v_mfma_f32_16x16x32_bf16 v[88:91], a[212:215], v[168:171], v[88:91]
    s_waitcnt lgkmcnt(2)
    v_exp_f32 v140, v140
    v_mfma_f32_16x16x32_bf16 v[92:95], a[212:215], v[172:175], v[92:95]
    ds_read_b64_tr_b16 a[192:193], v242 offset:24576
    v_mfma_f32_16x16x32_bf16 v[96:99], a[216:219], v[160:163], v[96:99]
    s_add_u32 s45, s44, 48
    s_lshl_b32 s46, s45, 8
    s_add_u32 s46, s46, s41
    s_cmp_lt_u32 s45, 992
    s_cselect_b32 s33, s46, s50
    v_exp_f32_e64 v141, v141
    v_mfma_f32_16x16x32_bf16 v[100:103], a[216:219], v[164:167], v[100:103]
    ds_read_b64_tr_b16 a[194:195], v242 offset:28672
    v_cvt_pk_bf16_f32 v188, v140, v141
    v_mfma_f32_16x16x32_bf16 v[104:107], a[216:219], v[168:171], v[104:107]
    s_waitcnt lgkmcnt(2)
    v_exp_f32 v142, v142
    v_mfma_f32_16x16x32_bf16 v[108:111], a[216:219], v[172:175], v[108:111]
    ds_read_b64_tr_b16 a[196:197], v242 offset:24584
    v_mfma_f32_16x16x32_bf16 v[112:115], a[220:223], v[160:163], v[112:115]
    v_exp_f32_e64 v143, v143
    v_mfma_f32_16x16x32_bf16 v[116:119], a[220:223], v[164:167], v[116:119]
    ds_read_b64_tr_b16 a[198:199], v242 offset:28680
    v_cvt_pk_bf16_f32 v189, v142, v143
    v_mfma_f32_16x16x32_bf16 v[120:123], a[220:223], v[168:171], v[120:123]
    s_waitcnt lgkmcnt(15)
    v_exp_f32 v156, v156
    v_mfma_f32_16x16x32_bf16 v[124:127], a[220:223], v[172:175], v[124:127]
    ds_read_b64_tr_b16 a[200:201], v243 offset:24576
    v_mfma_f32_16x16x32_bf16 v[128:131], a[128:131], a[0:3], v[192:195]
    v_exp_f32_e64 v157, v157
    v_mfma_f32_16x16x32_bf16 v[128:131], a[132:135], a[4:7], v[128:131]
    ds_read_b64_tr_b16 a[202:203], v243 offset:28672
    v_cvt_pk_bf16_f32 v190, v156, v157
    v_mfma_f32_16x16x32_bf16 v[128:131], a[136:139], a[8:11], v[128:131]
    s_waitcnt lgkmcnt(15)
    v_exp_f32 v158, v158
    v_mfma_f32_16x16x32_bf16 v[128:131], a[140:143], a[12:15], v[128:131]
    ds_read_b64_tr_b16 a[204:205], v243 offset:24584
    v_mfma_f32_16x16x32_bf16 v[144:147], a[144:147], a[0:3], v[192:195]
    v_exp_f32_e64 v159, v159
    v_mfma_f32_16x16x32_bf16 v[144:147], a[148:151], a[4:7], v[144:147]
    ds_read_b64_tr_b16 a[206:207], v243 offset:28680
    v_cvt_pk_bf16_f32 v191, v158, v159
    v_mfma_f32_16x16x32_bf16 v[144:147], a[152:155], a[8:11], v[144:147]
    ds_read_b64_tr_b16 a[208:209], v244 offset:24576
    v_mfma_f32_16x16x32_bf16 v[144:147], a[156:159], a[12:15], v[144:147]
    v_exp_f32_e64 v128, v128
    v_mfma_f32_16x16x32_bf16 v[132:135], a[128:131], a[16:19], v[196:199]
    ds_read_b64_tr_b16 a[210:211], v244 offset:28672
    v_mfma_f32_16x16x32_bf16 v[132:135], a[132:135], a[20:23], v[132:135]
    v_exp_f32_e64 v129, v129
    v_mfma_f32_16x16x32_bf16 v[132:135], a[136:139], a[24:27], v[132:135]
    ds_read_b64_tr_b16 a[212:213], v244 offset:24584
    v_cvt_pk_bf16_f32 v160, v128, v129
    v_mfma_f32_16x16x32_bf16 v[132:135], a[140:143], a[28:31], v[132:135]
    v_exp_f32_e64 v130, v130
    v_mfma_f32_16x16x32_bf16 v[148:151], a[144:147], a[16:19], v[196:199]
    ds_read_b64_tr_b16 a[214:215], v244 offset:28680
    v_mfma_f32_16x16x32_bf16 v[148:151], a[148:151], a[20:23], v[148:151]
    v_exp_f32_e64 v131, v131
    v_mfma_f32_16x16x32_bf16 v[148:151], a[152:155], a[24:27], v[148:151]
    ds_read_b64_tr_b16 a[216:217], v245 offset:24576
    v_cvt_pk_bf16_f32 v161, v130, v131
    v_mfma_f32_16x16x32_bf16 v[148:151], a[156:159], a[28:31], v[148:151]
    v_exp_f32_e64 v144, v144
    v_mfma_f32_16x16x32_bf16 v[136:139], a[128:131], a[32:35], v[200:203]
    ds_read_b64_tr_b16 a[218:219], v245 offset:28672
    v_mfma_f32_16x16x32_bf16 v[136:139], a[132:135], a[36:39], v[136:139]
    v_exp_f32_e64 v145, v145
    v_mfma_f32_16x16x32_bf16 v[136:139], a[136:139], a[40:43], v[136:139]
    ds_read_b64_tr_b16 a[220:221], v245 offset:24584
    v_cvt_pk_bf16_f32 v162, v144, v145
    v_mfma_f32_16x16x32_bf16 v[136:139], a[140:143], a[44:47], v[136:139]
    v_exp_f32_e64 v146, v146
    v_mfma_f32_16x16x32_bf16 v[152:155], a[144:147], a[32:35], v[200:203]
    ds_read_b64_tr_b16 a[222:223], v245 offset:28680
    v_mfma_f32_16x16x32_bf16 v[152:155], a[148:151], a[36:39], v[152:155]
    v_exp_f32_e64 v147, v147
    v_mfma_f32_16x16x32_bf16 v[152:155], a[152:155], a[40:43], v[152:155]
    ds_read_b128 a[160:163], v241 offset:40960
    v_cvt_pk_bf16_f32 v163, v146, v147
    v_mfma_f32_16x16x32_bf16 v[152:155], a[156:159], a[44:47], v[152:155]
    v_exp_f32_e64 v132, v132
    v_mfma_f32_16x16x32_bf16 v[140:143], a[128:131], a[48:51], v[204:207]
    ds_read_b128 a[164:167], v241 offset:41984
    v_mfma_f32_16x16x32_bf16 v[140:143], a[132:135], a[52:55], v[140:143]
    v_exp_f32_e64 v133, v133
    v_mfma_f32_16x16x32_bf16 v[140:143], a[136:139], a[56:59], v[140:143]
    ds_read_b128 a[168:171], v241 offset:43008
    v_cvt_pk_bf16_f32 v164, v132, v133
    v_mfma_f32_16x16x32_bf16 v[140:143], a[140:143], a[60:63], v[140:143]
    v_exp_f32_e64 v134, v134
    v_mfma_f32_16x16x32_bf16 v[156:159], a[144:147], a[48:51], v[204:207]
    ds_read_b128 a[172:175], v241 offset:44032
    v_mfma_f32_16x16x32_bf16 v[156:159], a[148:151], a[52:55], v[156:159]
    v_exp_f32_e64 v135, v135
    v_mfma_f32_16x16x32_bf16 v[156:159], a[152:155], a[56:59], v[156:159]
    ds_read_b128 a[176:179], v241 offset:45056
    v_cvt_pk_bf16_f32 v165, v134, v135
    v_mfma_f32_16x16x32_bf16 v[156:159], a[156:159], a[60:63], v[156:159]
    v_exp_f32_e64 v148, v148
    v_mfma_f32_16x16x32_bf16 a[224:227], a[240:243], v[176:179], a[224:227]
    ds_read_b128 a[180:183], v241 offset:46080
    v_mfma_f32_16x16x32_bf16 a[228:231], a[240:243], v[180:183], a[228:231]
    s_waitcnt lgkmcnt(15)
    v_exp_f32 v149, v149
    v_mfma_f32_16x16x32_bf16 a[232:235], a[240:243], v[184:187], a[232:235]
    ds_read_b128 a[184:187], v241 offset:47104
    v_cvt_pk_bf16_f32 v166, v148, v149
    v_mfma_f32_16x16x32_bf16 a[236:239], a[240:243], v[188:191], a[236:239]
    v_exp_f32_e64 v150, v150
    v_mfma_f32_16x16x32_bf16 v[0:3], a[192:195], v[176:179], v[0:3]
    ds_read_b128 a[188:191], v241 offset:48128
    v_mfma_f32_16x16x32_bf16 v[4:7], a[192:195], v[180:183], v[4:7]
    s_waitcnt lgkmcnt(15)
    v_exp_f32 v151, v151
    v_mfma_f32_16x16x32_bf16 v[8:11], a[192:195], v[184:187], v[8:11]
    ds_read_b128 a[128:131], v241 offset:49152
    v_cvt_pk_bf16_f32 v167, v150, v151
    v_mfma_f32_16x16x32_bf16 v[12:15], a[192:195], v[188:191], v[12:15]
    v_exp_f32_e64 v136, v136
    v_mfma_f32_16x16x32_bf16 v[16:19], a[196:199], v[176:179], v[16:19]
    ds_read_b128 a[132:135], v241 offset:50176
    v_mfma_f32_16x16x32_bf16 v[20:23], a[196:199], v[180:183], v[20:23]
    s_waitcnt lgkmcnt(15)
    v_exp_f32 v137, v137
    v_mfma_f32_16x16x32_bf16 v[24:27], a[196:199], v[184:187], v[24:27]
    ds_read_b128 a[136:139], v241 offset:51200
    v_cvt_pk_bf16_f32 v168, v136, v137
    v_mfma_f32_16x16x32_bf16 v[28:31], a[196:199], v[188:191], v[28:31]
    v_exp_f32_e64 v138, v138
    v_mfma_f32_16x16x32_bf16 v[32:35], a[200:203], v[176:179], v[32:35]
    ds_read_b128 a[140:143], v241 offset:52224
    v_mfma_f32_16x16x32_bf16 v[36:39], a[200:203], v[180:183], v[36:39]
    s_waitcnt lgkmcnt(15)
    v_exp_f32 v139, v139
    v_mfma_f32_16x16x32_bf16 v[40:43], a[200:203], v[184:187], v[40:43]
    ds_read_b128 a[144:147], v241 offset:53248
    v_cvt_pk_bf16_f32 v169, v138, v139
    v_mfma_f32_16x16x32_bf16 v[44:47], a[200:203], v[188:191], v[44:47]
    v_exp_f32_e64 v152, v152
    v_mfma_f32_16x16x32_bf16 v[48:51], a[204:207], v[176:179], v[48:51]
    ds_read_b128 a[148:151], v241 offset:54272
    v_mfma_f32_16x16x32_bf16 v[52:55], a[204:207], v[180:183], v[52:55]
    s_waitcnt lgkmcnt(15)
    v_exp_f32 v153, v153
    v_mfma_f32_16x16x32_bf16 v[56:59], a[204:207], v[184:187], v[56:59]
    ds_read_b128 a[152:155], v241 offset:55296
    v_cvt_pk_bf16_f32 v170, v152, v153
    v_mfma_f32_16x16x32_bf16 v[60:63], a[204:207], v[188:191], v[60:63]
    v_exp_f32_e64 v154, v154
    v_mfma_f32_16x16x32_bf16 v[64:67], a[208:211], v[176:179], v[64:67]
    ds_read_b128 a[156:159], v241 offset:56320
    v_mfma_f32_16x16x32_bf16 v[68:71], a[208:211], v[180:183], v[68:71]
    s_waitcnt lgkmcnt(15)
    v_exp_f32 v155, v155
    v_mfma_f32_16x16x32_bf16 v[72:75], a[208:211], v[184:187], v[72:75]
    v_cvt_pk_bf16_f32 v171, v154, v155
    v_mfma_f32_16x16x32_bf16 v[76:79], a[208:211], v[188:191], v[76:79]
    v_exp_f32_e64 v140, v140
    v_mfma_f32_16x16x32_bf16 v[80:83], a[212:215], v[176:179], v[80:83]
    v_mfma_f32_16x16x32_bf16 v[84:87], a[212:215], v[180:183], v[84:87]
    s_waitcnt lgkmcnt(15)
    v_exp_f32 v141, v141
    v_mfma_f32_16x16x32_bf16 v[88:91], a[212:215], v[184:187], v[88:91]
    v_cvt_pk_bf16_f32 v172, v140, v141
    v_mfma_f32_16x16x32_bf16 v[92:95], a[212:215], v[188:191], v[92:95]
    v_exp_f32_e64 v142, v142
    v_mfma_f32_16x16x32_bf16 v[96:99], a[216:219], v[176:179], v[96:99]
    v_mfma_f32_16x16x32_bf16 v[100:103], a[216:219], v[180:183], v[100:103]
    s_waitcnt lgkmcnt(15)
    v_exp_f32 v143, v143
    v_mfma_f32_16x16x32_bf16 v[104:107], a[216:219], v[184:187], v[104:107]
    v_cvt_pk_bf16_f32 v173, v142, v143
    v_mfma_f32_16x16x32_bf16 v[108:111], a[216:219], v[188:191], v[108:111]
    v_exp_f32_e64 v156, v156
    v_mfma_f32_16x16x32_bf16 v[112:115], a[220:223], v[176:179], v[112:115]
    v_mfma_f32_16x16x32_bf16 v[116:119], a[220:223], v[180:183], v[116:119]
    s_waitcnt lgkmcnt(12)
    v_exp_f32 v157, v157
    v_mfma_f32_16x16x32_bf16 v[120:123], a[220:223], v[184:187], v[120:123]
    v_cvt_pk_bf16_f32 v174, v156, v157
    v_mfma_f32_16x16x32_bf16 v[124:127], a[220:223], v[188:191], v[124:127]
    v_exp_f32_e64 v158, v158
    v_mfma_f32_16x16x32_bf16 v[128:131], a[160:163], a[0:3], v[192:195]
    v_mfma_f32_16x16x32_bf16 v[128:131], a[164:167], a[4:7], v[128:131]
    s_waitcnt lgkmcnt(8)
    v_exp_f32 v159, v159
    v_mfma_f32_16x16x32_bf16 v[128:131], a[168:171], a[8:11], v[128:131]
    v_cvt_pk_bf16_f32 v175, v158, v159
    v_mfma_f32_16x16x32_bf16 v[128:131], a[172:175], a[12:15], v[128:131]
    v_mfma_f32_16x16x32_bf16 v[144:147], a[176:179], a[0:3], v[192:195]
    v_mfma_f32_16x16x32_bf16 v[144:147], a[180:183], a[4:7], v[144:147]
    v_mfma_f32_16x16x32_bf16 v[144:147], a[184:187], a[8:11], v[144:147]
    v_mfma_f32_16x16x32_bf16 v[144:147], a[188:191], a[12:15], v[144:147]
    v_mfma_f32_16x16x32_bf16 v[132:135], a[160:163], a[16:19], v[196:199]
    s_waitcnt vmcnt(4)
    v_mfma_f32_16x16x32_bf16 v[132:135], a[164:167], a[20:23], v[132:135]
    s_barrier
    v_mfma_f32_16x16x32_bf16 v[132:135], a[168:171], a[24:27], v[132:135]
    v_exp_f32_e64 v128, v128
    v_mfma_f32_16x16x32_bf16 v[132:135], a[172:175], a[28:31], v[132:135]
    buffer_load_dwordx4 v247, s[20:23], s39 offen offset:0 lds
    v_mfma_f32_16x16x32_bf16 v[148:151], a[176:179], a[16:19], v[196:199]
    v_exp_f32_e64 v129, v129
    v_mfma_f32_16x16x32_bf16 v[148:151], a[180:183], a[20:23], v[148:151]
    buffer_load_dwordx4 v247, s[20:23], s39 offen offset:1024 lds
    v_cvt_pk_bf16_f32 v176, v128, v129
    v_mfma_f32_16x16x32_bf16 v[148:151], a[184:187], a[24:27], v[148:151]
    s_add_u32 m0, s40, 24576
    v_exp_f32_e64 v130, v130
    v_mfma_f32_16x16x32_bf16 v[148:151], a[188:191], a[28:31], v[148:151]
    buffer_load_dwordx4 v247, s[20:23], s51 offen offset:0 lds
    v_mfma_f32_16x16x32_bf16 v[136:139], a[160:163], a[32:35], v[200:203]
    s_add_u32 s39, s38, 0
    v_exp_f32 v131, v131
    v_mfma_f32_16x16x32_bf16 v[136:139], a[164:167], a[36:39], v[136:139]
    buffer_load_dwordx4 v247, s[20:23], s51 offen offset:1024 lds
    v_cvt_pk_bf16_f32 v177, v130, v131
    v_mfma_f32_16x16x32_bf16 v[136:139], a[168:171], a[40:43], v[136:139]
    s_add_u32 m0, s40, 0
    v_exp_f32 v144, v144
    v_mfma_f32_16x16x32_bf16 v[136:139], a[172:175], a[44:47], v[136:139]
    ds_read_b64_tr_b16 a[192:193], v242 offset:0
    v_mfma_f32_16x16x32_bf16 v[152:155], a[176:179], a[32:35], v[200:203]
    s_add_u32 s51, s38, 8192
    v_exp_f32_e64 v145, v145
    v_mfma_f32_16x16x32_bf16 v[152:155], a[180:183], a[36:39], v[152:155]
    ds_read_b64_tr_b16 a[194:195], v242 offset:4096
    v_cvt_pk_bf16_f32 v178, v144, v145
    v_mfma_f32_16x16x32_bf16 v[152:155], a[184:187], a[40:43], v[152:155]
    v_exp_f32_e64 v146, v146
    v_mfma_f32_16x16x32_bf16 v[152:155], a[188:191], a[44:47], v[152:155]
    ds_read_b64_tr_b16 a[196:197], v242 offset:8
    v_mfma_f32_16x16x32_bf16 v[140:143], a[160:163], a[48:51], v[204:207]
    v_exp_f32_e64 v147, v147
    v_mfma_f32_16x16x32_bf16 v[140:143], a[164:167], a[52:55], v[140:143]
    ds_read_b64_tr_b16 a[198:199], v242 offset:4104
    v_cvt_pk_bf16_f32 v179, v146, v147
    v_mfma_f32_16x16x32_bf16 v[140:143], a[168:171], a[56:59], v[140:143]
    v_exp_f32_e64 v132, v132
    v_mfma_f32_16x16x32_bf16 v[140:143], a[172:175], a[60:63], v[140:143]
    ds_read_b64_tr_b16 a[200:201], v243 offset:0
    v_mfma_f32_16x16x32_bf16 v[156:159], a[176:179], a[48:51], v[204:207]
    v_exp_f32_e64 v133, v133
    v_mfma_f32_16x16x32_bf16 v[156:159], a[180:183], a[52:55], v[156:159]
    ds_read_b64_tr_b16 a[202:203], v243 offset:4096
    v_cvt_pk_bf16_f32 v180, v132, v133
    v_mfma_f32_16x16x32_bf16 v[156:159], a[184:187], a[56:59], v[156:159]
    v_exp_f32_e64 v134, v134
    v_mfma_f32_16x16x32_bf16 v[156:159], a[188:191], a[60:63], v[156:159]
    ds_read_b64_tr_b16 a[204:205], v243 offset:8
    v_mfma_f32_16x16x32_bf16 a[224:227], a[240:243], v[160:163], a[224:227]
    v_exp_f32_e64 v135, v135
    v_mfma_f32_16x16x32_bf16 a[228:231], a[240:243], v[164:167], a[228:231]
    ds_read_b64_tr_b16 a[206:207], v243 offset:4104
    v_cvt_pk_bf16_f32 v181, v134, v135
    v_mfma_f32_16x16x32_bf16 a[232:235], a[240:243], v[168:171], a[232:235]
    s_waitcnt lgkmcnt(6)
    v_exp_f32 v148, v148
    v_mfma_f32_16x16x32_bf16 a[236:239], a[240:243], v[172:175], a[236:239]
    ds_read_b64_tr_b16 a[208:209], v244 offset:0
    v_mfma_f32_16x16x32_bf16 v[0:3], a[192:195], v[160:163], v[0:3]
    v_exp_f32_e64 v149, v149
    v_mfma_f32_16x16x32_bf16 v[4:7], a[192:195], v[164:167], v[4:7]
    ds_read_b64_tr_b16 a[210:211], v244 offset:4096
    v_cvt_pk_bf16_f32 v182, v148, v149
    v_mfma_f32_16x16x32_bf16 v[8:11], a[192:195], v[168:171], v[8:11]
    s_waitcnt lgkmcnt(6)
    v_exp_f32 v150, v150
    v_mfma_f32_16x16x32_bf16 v[12:15], a[192:195], v[172:175], v[12:15]
    ds_read_b64_tr_b16 a[212:213], v244 offset:8
    v_mfma_f32_16x16x32_bf16 v[16:19], a[196:199], v[160:163], v[16:19]
    v_exp_f32_e64 v151, v151
    v_mfma_f32_16x16x32_bf16 v[20:23], a[196:199], v[164:167], v[20:23]
    ds_read_b64_tr_b16 a[214:215], v244 offset:4104
    v_cvt_pk_bf16_f32 v183, v150, v151
    v_mfma_f32_16x16x32_bf16 v[24:27], a[196:199], v[168:171], v[24:27]
    s_waitcnt lgkmcnt(6)
    v_exp_f32 v136, v136
    v_mfma_f32_16x16x32_bf16 v[28:31], a[196:199], v[172:175], v[28:31]
    ds_read_b64_tr_b16 a[216:217], v245 offset:0
    v_mfma_f32_16x16x32_bf16 v[32:35], a[200:203], v[160:163], v[32:35]
    v_exp_f32_e64 v137, v137
    v_mfma_f32_16x16x32_bf16 v[36:39], a[200:203], v[164:167], v[36:39]
    ds_read_b64_tr_b16 a[218:219], v245 offset:4096
    v_cvt_pk_bf16_f32 v184, v136, v137
    v_mfma_f32_16x16x32_bf16 v[40:43], a[200:203], v[168:171], v[40:43]
    s_waitcnt lgkmcnt(6)
    v_exp_f32 v138, v138
    v_mfma_f32_16x16x32_bf16 v[44:47], a[200:203], v[172:175], v[44:47]
    ds_read_b64_tr_b16 a[220:221], v245 offset:8
    v_mfma_f32_16x16x32_bf16 v[48:51], a[204:207], v[160:163], v[48:51]
    v_exp_f32_e64 v139, v139
    v_mfma_f32_16x16x32_bf16 v[52:55], a[204:207], v[164:167], v[52:55]
    ds_read_b64_tr_b16 a[222:223], v245 offset:4104
    v_cvt_pk_bf16_f32 v185, v138, v139
    v_mfma_f32_16x16x32_bf16 v[56:59], a[204:207], v[168:171], v[56:59]
    s_waitcnt lgkmcnt(6)
    v_exp_f32 v152, v152
    v_mfma_f32_16x16x32_bf16 v[60:63], a[204:207], v[172:175], v[60:63]
    ds_read_b64_tr_b16 a[192:193], v242 offset:8192
    v_mfma_f32_16x16x32_bf16 v[64:67], a[208:211], v[160:163], v[64:67]
    v_exp_f32_e64 v153, v153
    v_mfma_f32_16x16x32_bf16 v[68:71], a[208:211], v[164:167], v[68:71]
    ds_read_b64_tr_b16 a[194:195], v242 offset:12288
    v_cvt_pk_bf16_f32 v186, v152, v153
    v_mfma_f32_16x16x32_bf16 v[72:75], a[208:211], v[168:171], v[72:75]
    s_waitcnt lgkmcnt(6)
    v_exp_f32 v154, v154
    v_mfma_f32_16x16x32_bf16 v[76:79], a[208:211], v[172:175], v[76:79]
    ds_read_b64_tr_b16 a[196:197], v242 offset:8200
    v_mfma_f32_16x16x32_bf16 v[80:83], a[212:215], v[160:163], v[80:83]
    v_exp_f32_e64 v155, v155
    v_mfma_f32_16x16x32_bf16 v[84:87], a[212:215], v[164:167], v[84:87]
    ds_read_b64_tr_b16 a[198:199], v242 offset:12296
    v_cvt_pk_bf16_f32 v187, v154, v155
    v_mfma_f32_16x16x32_bf16 v[88:91], a[212:215], v[168:171], v[88:91]
    s_waitcnt lgkmcnt(6)
    v_exp_f32 v140, v140
    v_mfma_f32_16x16x32_bf16 v[92:95], a[212:215], v[172:175], v[92:95]
    ds_read_b64_tr_b16 a[200:201], v243 offset:8192
    v_mfma_f32_16x16x32_bf16 v[96:99], a[216:219], v[160:163], v[96:99]
    v_exp_f32_e64 v141, v141
    v_mfma_f32_16x16x32_bf16 v[100:103], a[216:219], v[164:167], v[100:103]
    ds_read_b64_tr_b16 a[202:203], v243 offset:12288
    v_cvt_pk_bf16_f32 v188, v140, v141
    v_mfma_f32_16x16x32_bf16 v[104:107], a[216:219], v[168:171], v[104:107]
    s_waitcnt lgkmcnt(6)
    v_exp_f32 v142, v142
    v_mfma_f32_16x16x32_bf16 v[108:111], a[216:219], v[172:175], v[108:111]
    ds_read_b64_tr_b16 a[204:205], v243 offset:8200
    v_mfma_f32_16x16x32_bf16 v[112:115], a[220:223], v[160:163], v[112:115]
    v_exp_f32_e64 v143, v143
    v_mfma_f32_16x16x32_bf16 v[116:119], a[220:223], v[164:167], v[116:119]
    ds_read_b64_tr_b16 a[206:207], v243 offset:12296
    v_cvt_pk_bf16_f32 v189, v142, v143
    v_mfma_f32_16x16x32_bf16 v[120:123], a[220:223], v[168:171], v[120:123]
    s_waitcnt lgkmcnt(15)
    v_exp_f32 v156, v156
    v_mfma_f32_16x16x32_bf16 v[124:127], a[220:223], v[172:175], v[124:127]
    ds_read_b64_tr_b16 a[208:209], v244 offset:8192
    v_mfma_f32_16x16x32_bf16 v[128:131], a[128:131], a[0:3], v[192:195]
    v_exp_f32_e64 v157, v157
    v_mfma_f32_16x16x32_bf16 v[128:131], a[132:135], a[4:7], v[128:131]
    ds_read_b64_tr_b16 a[210:211], v244 offset:12288
    v_cvt_pk_bf16_f32 v190, v156, v157
    v_mfma_f32_16x16x32_bf16 v[128:131], a[136:139], a[8:11], v[128:131]
    s_waitcnt lgkmcnt(15)
    v_exp_f32 v158, v158
    v_mfma_f32_16x16x32_bf16 v[128:131], a[140:143], a[12:15], v[128:131]
    ds_read_b64_tr_b16 a[212:213], v244 offset:8200
    v_mfma_f32_16x16x32_bf16 v[144:147], a[144:147], a[0:3], v[192:195]
    v_exp_f32_e64 v159, v159
    v_mfma_f32_16x16x32_bf16 v[144:147], a[148:151], a[4:7], v[144:147]
    ds_read_b64_tr_b16 a[214:215], v244 offset:12296
    v_cvt_pk_bf16_f32 v191, v158, v159
    v_mfma_f32_16x16x32_bf16 v[144:147], a[152:155], a[8:11], v[144:147]
    ds_read_b64_tr_b16 a[216:217], v245 offset:8192
    v_mfma_f32_16x16x32_bf16 v[144:147], a[156:159], a[12:15], v[144:147]
    v_exp_f32_e64 v128, v128
    v_mfma_f32_16x16x32_bf16 v[132:135], a[128:131], a[16:19], v[196:199]
    ds_read_b64_tr_b16 a[218:219], v245 offset:12288
    v_mfma_f32_16x16x32_bf16 v[132:135], a[132:135], a[20:23], v[132:135]
    v_exp_f32_e64 v129, v129
    v_mfma_f32_16x16x32_bf16 v[132:135], a[136:139], a[24:27], v[132:135]
    ds_read_b64_tr_b16 a[220:221], v245 offset:8200
    v_cvt_pk_bf16_f32 v160, v128, v129
    v_mfma_f32_16x16x32_bf16 v[132:135], a[140:143], a[28:31], v[132:135]
    v_exp_f32_e64 v130, v130
    v_mfma_f32_16x16x32_bf16 v[148:151], a[144:147], a[16:19], v[196:199]
    ds_read_b64_tr_b16 a[222:223], v245 offset:12296
    v_mfma_f32_16x16x32_bf16 v[148:151], a[148:151], a[20:23], v[148:151]
    v_exp_f32_e64 v131, v131
    v_mfma_f32_16x16x32_bf16 v[148:151], a[152:155], a[24:27], v[148:151]
    ds_read_b128 a[160:163], v241 offset:57344
    v_cvt_pk_bf16_f32 v161, v130, v131
    v_mfma_f32_16x16x32_bf16 v[148:151], a[156:159], a[28:31], v[148:151]
    v_exp_f32_e64 v144, v144
    v_mfma_f32_16x16x32_bf16 v[136:139], a[128:131], a[32:35], v[200:203]
    ds_read_b128 a[164:167], v241 offset:58368
    v_mfma_f32_16x16x32_bf16 v[136:139], a[132:135], a[36:39], v[136:139]
    v_exp_f32_e64 v145, v145
    v_mfma_f32_16x16x32_bf16 v[136:139], a[136:139], a[40:43], v[136:139]
    ds_read_b128 a[168:171], v241 offset:59392
    v_cvt_pk_bf16_f32 v162, v144, v145
    v_mfma_f32_16x16x32_bf16 v[136:139], a[140:143], a[44:47], v[136:139]
    v_exp_f32_e64 v146, v146
    v_mfma_f32_16x16x32_bf16 v[152:155], a[144:147], a[32:35], v[200:203]
    ds_read_b128 a[172:175], v241 offset:60416
    v_mfma_f32_16x16x32_bf16 v[152:155], a[148:151], a[36:39], v[152:155]
    v_exp_f32_e64 v147, v147
    v_mfma_f32_16x16x32_bf16 v[152:155], a[152:155], a[40:43], v[152:155]
    ds_read_b128 a[176:179], v241 offset:61440
    v_cvt_pk_bf16_f32 v163, v146, v147
    v_mfma_f32_16x16x32_bf16 v[152:155], a[156:159], a[44:47], v[152:155]
    v_exp_f32_e64 v132, v132
    v_mfma_f32_16x16x32_bf16 v[140:143], a[128:131], a[48:51], v[204:207]
    ds_read_b128 a[180:183], v241 offset:62464
    v_mfma_f32_16x16x32_bf16 v[140:143], a[132:135], a[52:55], v[140:143]
    v_exp_f32_e64 v133, v133
    v_mfma_f32_16x16x32_bf16 v[140:143], a[136:139], a[56:59], v[140:143]
    ds_read_b128 a[184:187], v241 offset:63488
    v_cvt_pk_bf16_f32 v164, v132, v133
    v_mfma_f32_16x16x32_bf16 v[140:143], a[140:143], a[60:63], v[140:143]
    v_exp_f32_e64 v134, v134
    v_mfma_f32_16x16x32_bf16 v[156:159], a[144:147], a[48:51], v[204:207]
    ds_read_b128 a[188:191], v241 offset:64512
    v_mfma_f32_16x16x32_bf16 v[156:159], a[148:151], a[52:55], v[156:159]
    v_exp_f32_e64 v135, v135
    v_mfma_f32_16x16x32_bf16 v[156:159], a[152:155], a[56:59], v[156:159]
    ds_read_b128 a[128:131], v240 offset:0
    v_cvt_pk_bf16_f32 v165, v134, v135
    v_mfma_f32_16x16x32_bf16 v[156:159], a[156:159], a[60:63], v[156:159]
    v_exp_f32_e64 v148, v148
    v_mfma_f32_16x16x32_bf16 a[224:227], a[240:243], v[176:179], a[224:227]
    ds_read_b128 a[132:135], v240 offset:1024
    v_mfma_f32_16x16x32_bf16 a[228:231], a[240:243], v[180:183], a[228:231]
    s_waitcnt lgkmcnt(15)
    v_exp_f32 v149, v149
    v_mfma_f32_16x16x32_bf16 a[232:235], a[240:243], v[184:187], a[232:235]
    ds_read_b128 a[136:139], v240 offset:2048
    v_cvt_pk_bf16_f32 v166, v148, v149
    v_mfma_f32_16x16x32_bf16 a[236:239], a[240:243], v[188:191], a[236:239]
    v_exp_f32_e64 v150, v150
    v_mfma_f32_16x16x32_bf16 v[0:3], a[192:195], v[176:179], v[0:3]
    ds_read_b128 a[140:143], v240 offset:3072
    v_mfma_f32_16x16x32_bf16 v[4:7], a[192:195], v[180:183], v[4:7]
    s_waitcnt lgkmcnt(15)
    v_exp_f32 v151, v151
    v_mfma_f32_16x16x32_bf16 v[8:11], a[192:195], v[184:187], v[8:11]
    ds_read_b128 a[144:147], v240 offset:4096
    v_cvt_pk_bf16_f32 v167, v150, v151
    v_mfma_f32_16x16x32_bf16 v[12:15], a[192:195], v[188:191], v[12:15]
    v_exp_f32_e64 v136, v136
    v_mfma_f32_16x16x32_bf16 v[16:19], a[196:199], v[176:179], v[16:19]
    ds_read_b128 a[148:151], v240 offset:5120
    v_mfma_f32_16x16x32_bf16 v[20:23], a[196:199], v[180:183], v[20:23]
    s_waitcnt lgkmcnt(15)
    v_exp_f32 v137, v137
    v_mfma_f32_16x16x32_bf16 v[24:27], a[196:199], v[184:187], v[24:27]
    ds_read_b128 a[152:155], v240 offset:6144
    v_cvt_pk_bf16_f32 v168, v136, v137
    v_mfma_f32_16x16x32_bf16 v[28:31], a[196:199], v[188:191], v[28:31]
    v_exp_f32_e64 v138, v138
    v_mfma_f32_16x16x32_bf16 v[32:35], a[200:203], v[176:179], v[32:35]
    ds_read_b128 a[156:159], v240 offset:7168
    v_mfma_f32_16x16x32_bf16 v[36:39], a[200:203], v[180:183], v[36:39]
    s_waitcnt lgkmcnt(15)
    v_exp_f32 v139, v139
    v_mfma_f32_16x16x32_bf16 v[40:43], a[200:203], v[184:187], v[40:43]
    v_cvt_pk_bf16_f32 v169, v138, v139
    v_mfma_f32_16x16x32_bf16 v[44:47], a[200:203], v[188:191], v[44:47]
    v_exp_f32_e64 v152, v152
    v_mfma_f32_16x16x32_bf16 v[48:51], a[204:207], v[176:179], v[48:51]
    v_mfma_f32_16x16x32_bf16 v[52:55], a[204:207], v[180:183], v[52:55]
    s_waitcnt lgkmcnt(15)
    v_exp_f32 v153, v153
    v_mfma_f32_16x16x32_bf16 v[56:59], a[204:207], v[184:187], v[56:59]
    v_cvt_pk_bf16_f32 v170, v152, v153
    v_mfma_f32_16x16x32_bf16 v[60:63], a[204:207], v[188:191], v[60:63]
    v_exp_f32_e64 v154, v154
    v_mfma_f32_16x16x32_bf16 v[64:67], a[208:211], v[176:179], v[64:67]
    v_mfma_f32_16x16x32_bf16 v[68:71], a[208:211], v[180:183], v[68:71]
    s_waitcnt lgkmcnt(15)
    v_exp_f32 v155, v155
    v_mfma_f32_16x16x32_bf16 v[72:75], a[208:211], v[184:187], v[72:75]
    v_cvt_pk_bf16_f32 v171, v154, v155
    v_mfma_f32_16x16x32_bf16 v[76:79], a[208:211], v[188:191], v[76:79]
    v_exp_f32_e64 v140, v140
    v_mfma_f32_16x16x32_bf16 v[80:83], a[212:215], v[176:179], v[80:83]
    v_mfma_f32_16x16x32_bf16 v[84:87], a[212:215], v[180:183], v[84:87]
    s_waitcnt lgkmcnt(15)
    v_exp_f32 v141, v141
    v_mfma_f32_16x16x32_bf16 v[88:91], a[212:215], v[184:187], v[88:91]
    v_cvt_pk_bf16_f32 v172, v140, v141
    v_mfma_f32_16x16x32_bf16 v[92:95], a[212:215], v[188:191], v[92:95]
    v_exp_f32_e64 v142, v142
    v_mfma_f32_16x16x32_bf16 v[96:99], a[216:219], v[176:179], v[96:99]
    v_mfma_f32_16x16x32_bf16 v[100:103], a[216:219], v[180:183], v[100:103]
    s_waitcnt lgkmcnt(15)
    v_exp_f32 v143, v143
    v_mfma_f32_16x16x32_bf16 v[104:107], a[216:219], v[184:187], v[104:107]
    v_cvt_pk_bf16_f32 v173, v142, v143
    v_mfma_f32_16x16x32_bf16 v[108:111], a[216:219], v[188:191], v[108:111]
    v_exp_f32_e64 v156, v156
    v_mfma_f32_16x16x32_bf16 v[112:115], a[220:223], v[176:179], v[112:115]
    v_mfma_f32_16x16x32_bf16 v[116:119], a[220:223], v[180:183], v[116:119]
    s_waitcnt lgkmcnt(12)
    v_exp_f32 v157, v157
    v_mfma_f32_16x16x32_bf16 v[120:123], a[220:223], v[184:187], v[120:123]
    v_cvt_pk_bf16_f32 v174, v156, v157
    v_mfma_f32_16x16x32_bf16 v[124:127], a[220:223], v[188:191], v[124:127]
    v_exp_f32_e64 v158, v158
    v_mfma_f32_16x16x32_bf16 v[128:131], a[160:163], a[0:3], v[192:195]
    v_mfma_f32_16x16x32_bf16 v[128:131], a[164:167], a[4:7], v[128:131]
    s_waitcnt lgkmcnt(8)
    v_exp_f32 v159, v159
    v_mfma_f32_16x16x32_bf16 v[128:131], a[168:171], a[8:11], v[128:131]
    s_waitcnt vmcnt(63)
    v_cvt_pk_bf16_f32 v175, v158, v159
    v_mfma_f32_16x16x32_bf16 v[128:131], a[172:175], a[12:15], v[128:131]
    v_mfma_f32_16x16x32_bf16 v[144:147], a[176:179], a[0:3], v[192:195]
    v_accvgpr_mov_b32 a0, a64
    v_accvgpr_mov_b32 a1, a65
    v_mfma_f32_16x16x32_bf16 v[144:147], a[180:183], a[4:7], v[144:147]
    v_accvgpr_mov_b32 a2, a66
    v_accvgpr_mov_b32 a3, a67
    v_mfma_f32_16x16x32_bf16 v[144:147], a[184:187], a[8:11], v[144:147]
    v_accvgpr_mov_b32 a4, a68
    v_accvgpr_mov_b32 a5, a69
    v_mfma_f32_16x16x32_bf16 v[144:147], a[188:191], a[12:15], v[144:147]
    v_exp_f32 v128, v128
    v_mfma_f32_16x16x32_bf16 v[132:135], a[160:163], a[16:19], v[196:199]
    s_waitcnt vmcnt(0)
    v_accvgpr_mov_b32 a6, a70
    v_accvgpr_mov_b32 a7, a71
    v_mfma_f32_16x16x32_bf16 v[132:135], a[164:167], a[20:23], v[132:135]
    v_exp_f32 v129, v129
    v_mfma_f32_16x16x32_bf16 v[132:135], a[168:171], a[24:27], v[132:135]
    s_barrier
    v_accvgpr_mov_b32 a8, a72
    v_mfma_f32_16x16x32_bf16 v[132:135], a[172:175], a[28:31], v[132:135]
    s_waitcnt vmcnt(63)
    v_exp_f32 v130, v130
    v_mfma_f32_16x16x32_bf16 v[148:151], a[176:179], a[16:19], v[196:199]
    buffer_load_dwordx4 v247, s[20:23], s39 offen offset:0 lds
    v_accvgpr_mov_b32 a16, a80
    v_mfma_f32_16x16x32_bf16 v[148:151], a[180:183], a[20:23], v[148:151]
    v_exp_f32 v131, v131
    v_mfma_f32_16x16x32_bf16 v[148:151], a[184:187], a[24:27], v[148:151]
    buffer_load_dwordx4 v247, s[20:23], s39 offen offset:1024 lds
    v_accvgpr_mov_b32 a17, a81
    v_mfma_f32_16x16x32_bf16 v[148:151], a[188:191], a[28:31], v[148:151]
    s_add_u32 m0, s40, 8192
    v_exp_f32 v132, v132
    v_mfma_f32_16x16x32_bf16 v[136:139], a[160:163], a[32:35], v[200:203]
    buffer_load_dwordx4 v247, s[20:23], s51 offen offset:0 lds
    v_accvgpr_mov_b32 a18, a82
    v_mfma_f32_16x16x32_bf16 v[136:139], a[164:167], a[36:39], v[136:139]
    v_exp_f32 v133, v133
    v_mfma_f32_16x16x32_bf16 v[136:139], a[168:171], a[40:43], v[136:139]
    buffer_load_dwordx4 v247, s[20:23], s51 offen offset:1024 lds
    v_accvgpr_mov_b32 a19, a83
    v_mfma_f32_16x16x32_bf16 v[136:139], a[172:175], a[44:47], v[136:139]
    s_waitcnt vmcnt(63)
    v_exp_f32_e64 v134, v134
    v_mfma_f32_16x16x32_bf16 v[152:155], a[176:179], a[32:35], v[200:203]
    ds_read_b64_tr_b16 a[192:193], v242 offset:16384
    v_accvgpr_mov_b32 a32, a96
    v_mfma_f32_16x16x32_bf16 v[152:155], a[180:183], a[36:39], v[152:155]
    v_exp_f32 v135, v135
    v_mfma_f32_16x16x32_bf16 v[152:155], a[184:187], a[40:43], v[152:155]
    ds_read_b64_tr_b16 a[194:195], v242 offset:20480
    v_accvgpr_mov_b32 a33, a97
    v_mfma_f32_16x16x32_bf16 v[152:155], a[188:191], a[44:47], v[152:155]
    v_exp_f32 v136, v136
    v_mfma_f32_16x16x32_bf16 v[140:143], a[160:163], a[48:51], v[204:207]
    ds_read_b64_tr_b16 a[196:197], v242 offset:16392
    v_accvgpr_mov_b32 a34, a98
    v_mfma_f32_16x16x32_bf16 v[140:143], a[164:167], a[52:55], v[140:143]
    v_exp_f32 v137, v137
    v_mfma_f32_16x16x32_bf16 v[140:143], a[168:171], a[56:59], v[140:143]
    ds_read_b64_tr_b16 a[198:199], v242 offset:20488
    v_accvgpr_mov_b32 a20, a84
    v_mfma_f32_16x16x32_bf16 v[140:143], a[172:175], a[60:63], v[140:143]
    s_waitcnt vmcnt(63)
    v_exp_f32_e64 v138, v138
    v_mfma_f32_16x16x32_bf16 v[156:159], a[176:179], a[48:51], v[204:207]
    ds_read_b64_tr_b16 a[200:201], v243 offset:16384
    v_accvgpr_mov_b32 a48, a112
    v_mfma_f32_16x16x32_bf16 v[156:159], a[180:183], a[52:55], v[156:159]
    v_exp_f32 v139, v139
    v_mfma_f32_16x16x32_bf16 v[156:159], a[184:187], a[56:59], v[156:159]
    ds_read_b64_tr_b16 a[202:203], v243 offset:20480
    v_accvgpr_mov_b32 a49, a113
    v_mfma_f32_16x16x32_bf16 v[156:159], a[188:191], a[60:63], v[156:159]
    v_exp_f32 v140, v140
    v_mfma_f32_16x16x32_bf16 a[224:227], a[240:243], v[160:163], a[224:227]
    ds_read_b64_tr_b16 a[204:205], v243 offset:16392
    v_accvgpr_mov_b32 a21, a85
    v_accvgpr_mov_b32 a35, a99
    v_mfma_f32_16x16x32_bf16 a[228:231], a[240:243], v[164:167], a[228:231]
    s_waitcnt lgkmcnt(5)
    v_exp_f32 v141, v141
    v_mfma_f32_16x16x32_bf16 a[232:235], a[240:243], v[168:171], a[232:235]
    ds_read_b64_tr_b16 a[206:207], v243 offset:20488
    v_accvgpr_mov_b32 a50, a114
    v_mfma_f32_16x16x32_bf16 a[236:239], a[240:243], v[172:175], a[236:239]
    v_exp_f32 v142, v142
    v_mfma_f32_16x16x32_bf16 v[0:3], a[192:195], v[160:163], v[0:3]
    ds_read_b64_tr_b16 a[208:209], v244 offset:16384
    v_accvgpr_mov_b32 a36, a100
    v_accvgpr_mov_b32 a22, a86
    v_mfma_f32_16x16x32_bf16 v[4:7], a[192:195], v[164:167], v[4:7]
    s_waitcnt lgkmcnt(5)
    v_exp_f32 v143, v143
    v_mfma_f32_16x16x32_bf16 v[8:11], a[192:195], v[168:171], v[8:11]
    ds_read_b64_tr_b16 a[210:211], v244 offset:20480
    v_accvgpr_mov_b32 a37, a101
    v_mfma_f32_16x16x32_bf16 v[12:15], a[192:195], v[172:175], v[12:15]
    v_exp_f32 v144, v144
    v_mfma_f32_16x16x32_bf16 v[16:19], a[196:199], v[160:163], v[16:19]
    ds_read_b64_tr_b16 a[212:213], v244 offset:16392
    v_accvgpr_mov_b32 a51, a115
    v_accvgpr_mov_b32 a23, a87
    v_mfma_f32_16x16x32_bf16 v[20:23], a[196:199], v[164:167], v[20:23]
    s_waitcnt lgkmcnt(5)
    v_exp_f32 v145, v145
    v_mfma_f32_16x16x32_bf16 v[24:27], a[196:199], v[168:171], v[24:27]
    ds_read_b64_tr_b16 a[214:215], v244 offset:20488
    v_accvgpr_mov_b32 a9, a73
    v_accvgpr_mov_b32 a52, a116
    v_mfma_f32_16x16x32_bf16 v[28:31], a[196:199], v[172:175], v[28:31]
    v_exp_f32_e64 v146, v146
    v_mfma_f32_16x16x32_bf16 v[32:35], a[200:203], v[160:163], v[32:35]
    ds_read_b64_tr_b16 a[216:217], v245 offset:16384
    v_accvgpr_mov_b32 a38, a102
    v_accvgpr_mov_b32 a10, a74
    v_mfma_f32_16x16x32_bf16 v[36:39], a[200:203], v[164:167], v[36:39]
    s_waitcnt lgkmcnt(5)
    v_exp_f32 v147, v147
    v_mfma_f32_16x16x32_bf16 v[40:43], a[200:203], v[168:171], v[40:43]
    ds_read_b64_tr_b16 a[218:219], v245 offset:20480
    v_accvgpr_mov_b32 a24, a88
    v_accvgpr_mov_b32 a53, a117
    v_mfma_f32_16x16x32_bf16 v[44:47], a[200:203], v[172:175], v[44:47]
    v_exp_f32_e64 v148, v148
    v_mfma_f32_16x16x32_bf16 v[48:51], a[204:207], v[160:163], v[48:51]
    ds_read_b64_tr_b16 a[220:221], v245 offset:16392
    v_accvgpr_mov_b32 a39, a103
    v_mfma_f32_16x16x32_bf16 v[52:55], a[204:207], v[164:167], v[52:55]
    s_waitcnt lgkmcnt(5)
    v_exp_f32_e64 v149, v149
    v_mfma_f32_16x16x32_bf16 v[56:59], a[204:207], v[168:171], v[56:59]
    ds_read_b64_tr_b16 a[222:223], v245 offset:20488
    v_accvgpr_mov_b32 a25, a89
    v_accvgpr_mov_b32 a11, a75
    v_mfma_f32_16x16x32_bf16 v[60:63], a[204:207], v[172:175], v[60:63]
    v_exp_f32_e64 v150, v150
    v_mfma_f32_16x16x32_bf16 v[64:67], a[208:211], v[160:163], v[64:67]
    ds_read_b64_tr_b16 a[192:193], v242 offset:24576
    v_accvgpr_mov_b32 a54, a118
    v_accvgpr_mov_b32 a26, a90
    v_mfma_f32_16x16x32_bf16 v[68:71], a[208:211], v[164:167], v[68:71]
    s_waitcnt lgkmcnt(5)
    v_exp_f32 v151, v151
    v_mfma_f32_16x16x32_bf16 v[72:75], a[208:211], v[168:171], v[72:75]
    ds_read_b64_tr_b16 a[194:195], v242 offset:28672
    v_accvgpr_mov_b32 a40, a104
    v_accvgpr_mov_b32 a12, a76
    v_mfma_f32_16x16x32_bf16 v[76:79], a[208:211], v[172:175], v[76:79]
    v_exp_f32_e64 v152, v152
    v_mfma_f32_16x16x32_bf16 v[80:83], a[212:215], v[160:163], v[80:83]
    ds_read_b64_tr_b16 a[196:197], v242 offset:24584
    v_accvgpr_mov_b32 a55, a119
    v_accvgpr_mov_b32 a41, a105
    v_mfma_f32_16x16x32_bf16 v[84:87], a[212:215], v[164:167], v[84:87]
    s_waitcnt lgkmcnt(5)
    v_exp_f32 v153, v153
    v_mfma_f32_16x16x32_bf16 v[88:91], a[212:215], v[168:171], v[88:91]
    ds_read_b64_tr_b16 a[198:199], v242 offset:28680
    v_accvgpr_mov_b32 a13, a77
    v_accvgpr_mov_b32 a27, a91
    v_mfma_f32_16x16x32_bf16 v[92:95], a[212:215], v[172:175], v[92:95]
    v_exp_f32_e64 v154, v154
    v_mfma_f32_16x16x32_bf16 v[96:99], a[216:219], v[160:163], v[96:99]
    ds_read_b64_tr_b16 a[200:201], v243 offset:24576
    v_cvt_pk_bf16_f32 v176, v128, v129
    v_cvt_pk_bf16_f32 v177, v130, v131
    v_mfma_f32_16x16x32_bf16 v[100:103], a[216:219], v[164:167], v[100:103]
    s_waitcnt lgkmcnt(5)
    v_exp_f32 v155, v155
    v_mfma_f32_16x16x32_bf16 v[104:107], a[216:219], v[168:171], v[104:107]
    ds_read_b64_tr_b16 a[202:203], v243 offset:28672
    v_accvgpr_mov_b32 a42, a106
    v_accvgpr_mov_b32 a56, a120
    v_mfma_f32_16x16x32_bf16 v[108:111], a[216:219], v[172:175], v[108:111]
    v_exp_f32_e64 v156, v156
    v_mfma_f32_16x16x32_bf16 v[112:115], a[220:223], v[160:163], v[112:115]
    ds_read_b64_tr_b16 a[204:205], v243 offset:24584
    v_accvgpr_mov_b32 a28, a92
    v_cvt_pk_bf16_f32 v180, v132, v133
    v_mfma_f32_16x16x32_bf16 v[116:119], a[220:223], v[164:167], v[116:119]
    s_waitcnt lgkmcnt(15)
    v_exp_f32_e64 v157, v157
    v_mfma_f32_16x16x32_bf16 v[120:123], a[220:223], v[168:171], v[120:123]
    ds_read_b64_tr_b16 a[206:207], v243 offset:28680
    v_cvt_pk_bf16_f32 v181, v134, v135
    v_accvgpr_mov_b32 a14, a78
    v_mfma_f32_16x16x32_bf16 v[124:127], a[220:223], v[172:175], v[124:127]
    v_exp_f32 v158, v158
    v_mfma_f32_16x16x32_bf16 v[128:131], a[128:131], a[64:67], 0
    ds_read_b64_tr_b16 a[208:209], v244 offset:24576
    v_accvgpr_mov_b32 a57, a121
    v_accvgpr_mov_b32 a29, a93
    v_mfma_f32_16x16x32_bf16 v[128:131], a[132:135], a[68:71], v[128:131]
    v_exp_f32_e64 v159, v159
    v_mfma_f32_16x16x32_bf16 v[128:131], a[136:139], a[72:75], v[128:131]
    ds_read_b64_tr_b16 a[210:211], v244 offset:28672
    v_accvgpr_mov_b32 a43, a107
    v_cvt_pk_bf16_f32 v184, v136, v137
    v_mfma_f32_16x16x32_bf16 v[128:131], a[140:143], a[76:79], v[128:131]
    ds_read_b64_tr_b16 a[212:213], v244 offset:24584
    v_cvt_pk_bf16_f32 v185, v138, v139
    v_accvgpr_mov_b32 a15, a79
    v_mfma_f32_16x16x32_bf16 v[132:135], a[128:131], a[80:83], 0
    ds_read_b64_tr_b16 a[214:215], v244 offset:28680
    v_accvgpr_mov_b32 a58, a122
    v_accvgpr_mov_b32 a44, a108
    v_mfma_f32_16x16x32_bf16 v[132:135], a[132:135], a[84:87], v[132:135]
    ds_read_b64_tr_b16 a[216:217], v245 offset:24576
    v_cvt_pk_bf16_f32 v188, v140, v141
    v_cvt_pk_bf16_f32 v189, v142, v143
    v_mfma_f32_16x16x32_bf16 v[132:135], a[136:139], a[88:91], v[132:135]
    ds_read_b64_tr_b16 a[218:219], v245 offset:28672
    v_accvgpr_mov_b32 a30, a94
    v_max3_f32 v216, v128, v129, v130
    v_mfma_f32_16x16x32_bf16 v[132:135], a[140:143], a[92:95], v[132:135]
    ds_read_b64_tr_b16 a[220:221], v245 offset:24584
    v_max_f32 v216, v216, v131
    v_mov_b32_e64 v217, v216
    v_mfma_f32_16x16x32_bf16 v[136:139], a[128:131], a[96:99], 0
    ds_read_b64_tr_b16 a[222:223], v245 offset:28680
    v_permlane16_swap_b32 v216, v217
    v_max_f32 v216, v216, v217
    v_mfma_f32_16x16x32_bf16 v[136:139], a[132:135], a[100:103], v[136:139]
    ds_read_b128 a[160:163], v240 offset:8192
    v_mov_b32 v217, v216
    v_accvgpr_mov_b32 a45, a109
    v_mfma_f32_16x16x32_bf16 v[136:139], a[136:139], a[104:107], v[136:139]
    ds_read_b128 a[164:167], v240 offset:9216
    v_accvgpr_mov_b32 a59, a123
    v_cvt_pk_bf16_f32 v178, v144, v145
    v_mfma_f32_16x16x32_bf16 v[136:139], a[140:143], a[108:111], v[136:139]
    ds_read_b128 a[168:171], v240 offset:10240
    v_cvt_pk_bf16_f32 v179, v146, v147
    v_permlane32_swap_b32 v216, v217
    v_mfma_f32_16x16x32_bf16 v[140:143], a[128:131], a[112:115], 0
    ds_read_b128 a[172:175], v240 offset:11264
    v_max_f32 v216, v216, v217
    v_sub_f32 v192, 0, v216
    v_mfma_f32_16x16x32_bf16 v[140:143], a[132:135], a[116:119], v[140:143]
    ds_read_b128 a[176:179], v240 offset:12288
    v_sub_f32 v193, 0, v216
    v_sub_f32 v194, 0, v216
    v_mfma_f32_16x16x32_bf16 v[140:143], a[136:139], a[120:123], v[140:143]
    ds_read_b128 a[180:183], v240 offset:13312
    v_sub_f32 v195, 0, v216
    v_accvgpr_mov_b32 a31, a95
    v_mfma_f32_16x16x32_bf16 v[140:143], a[140:143], a[124:127], v[140:143]
    ds_read_b128 a[184:187], v240 offset:14336
    v_max3_f32 v218, v132, v133, v134
    v_max_f32 v218, v218, v135
    s_waitcnt lgkmcnt(15)
    v_mfma_f32_16x16x32_bf16 v[144:147], a[144:147], a[64:67], v[192:195]
    ds_read_b128 a[188:191], v240 offset:15360
    v_mov_b32 v219, v218
    v_accvgpr_mov_b32 a60, a124
    v_mfma_f32_16x16x32_bf16 v[144:147], a[148:151], a[68:71], v[144:147]
    v_permlane16_swap_b32 v218, v219
    v_max_f32 v218, v218, v219
    v_mov_b32_e64 v219, v218
    v_mfma_f32_16x16x32_bf16 v[144:147], a[152:155], a[72:75], v[144:147]
    v_cvt_pk_bf16_f32 v182, v148, v149
    v_cvt_pk_bf16_f32 v183, v150, v151
    v_permlane32_swap_b32 v218, v219
    v_mfma_f32_16x16x32_bf16 v[144:147], a[156:159], a[76:79], v[144:147]
    v_max_f32 v218, v218, v219
    v_sub_f32 v196, 0, v218
    v_sub_f32 v197, 0, v218
    v_sub_f32 v198, 0, v218
    v_sub_f32 v199, 0, v218
    v_accvgpr_mov_b32 a46, a110
    s_nop 0
    v_mfma_f32_16x16x32_bf16 v[148:151], a[144:147], a[80:83], v[196:199]
    v_exp_f32_e64 v144, v144
    v_mfma_f32_16x16x32_bf16 v[148:151], a[148:151], a[84:87], v[148:151]
    v_max3_f32 v220, v136, v137, v138
    v_max_f32 v220, v220, v139
    v_mov_b32 v221, v220
    v_mfma_f32_16x16x32_bf16 v[148:151], a[152:155], a[88:91], v[148:151]
    v_exp_f32 v145, v145
    v_permlane16_swap_b32 v220, v221
    v_max_f32 v220, v220, v221
    v_mov_b32 v221, v220
    v_accvgpr_mov_b32 a61, a125
    v_mfma_f32_16x16x32_bf16 v[148:151], a[156:159], a[92:95], v[148:151]
    v_cvt_pk_bf16_f32 v186, v152, v153
    v_cvt_pk_bf16_f32 v187, v154, v155
    v_permlane32_swap_b32 v220, v221
    v_max_f32 v220, v220, v221
    v_sub_f32 v200, 0, v220
    v_sub_f32 v201, 0, v220
    v_sub_f32 v202, 0, v220
    v_sub_f32 v203, 0, v220
    v_accvgpr_mov_b32 a47, a111
    s_nop 0
    v_mfma_f32_16x16x32_bf16 v[152:155], a[144:147], a[96:99], v[200:203]
    v_exp_f32 v146, v146
    v_mfma_f32_16x16x32_bf16 v[152:155], a[148:151], a[100:103], v[152:155]
    v_max3_f32 v222, v140, v141, v142
    v_max_f32 v222, v222, v143
    v_mov_b32 v223, v222
    v_mfma_f32_16x16x32_bf16 v[152:155], a[152:155], a[104:107], v[152:155]
    v_exp_f32 v147, v147
    v_permlane16_swap_b32 v222, v223
    v_max_f32 v222, v222, v223
    v_mov_b32 v223, v222
    v_mfma_f32_16x16x32_bf16 v[152:155], a[156:159], a[108:111], v[152:155]
    v_cvt_pk_bf16_f32 v190, v156, v157
    v_cvt_pk_bf16_f32 v191, v158, v159
    v_permlane32_swap_b32 v222, v223
    v_max_f32 v222, v222, v223
    v_sub_f32 v204, 0, v222
    v_sub_f32 v205, 0, v222
    v_sub_f32 v206, 0, v222
    v_sub_f32 v207, 0, v222
    v_accvgpr_mov_b32 a62, a126
    s_nop 0
    v_mfma_f32_16x16x32_bf16 v[156:159], a[144:147], a[112:115], v[204:207]
    v_exp_f32_e64 v148, v148
    v_mfma_f32_16x16x32_bf16 v[156:159], a[148:151], a[116:119], v[156:159]
    v_accvgpr_mov_b32 a63, a127
    v_sub_f32 v128, v128, v216
    v_mfma_f32_16x16x32_bf16 v[156:159], a[152:155], a[120:123], v[156:159]
    v_exp_f32_e64 v128, v128
    v_mfma_f32_16x16x32_bf16 v[156:159], a[156:159], a[124:127], v[156:159]
    v_sub_f32 v129, v129, v216
    v_sub_f32 v130, v130, v216
    v_mfma_f32_16x16x32_bf16 a[224:227], a[240:243], v[176:179], a[224:227]
    v_exp_f32_e64 v129, v129
    v_mfma_f32_16x16x32_bf16 a[228:231], a[240:243], v[180:183], a[228:231]
    s_waitcnt lgkmcnt(15)
    v_sub_f32 v131, v131, v216
    v_sub_f32_e64 v132, v132, v218
    v_mfma_f32_16x16x32_bf16 a[232:235], a[240:243], v[184:187], a[232:235]
    v_exp_f32_e64 v130, v130
    v_mfma_f32_16x16x32_bf16 a[236:239], a[240:243], v[188:191], a[236:239]
    v_sub_f32 v133, v133, v218
    v_sub_f32 v134, v134, v218
    v_mfma_f32_16x16x32_bf16 v[0:3], a[192:195], v[176:179], v[0:3]
    v_exp_f32_e64 v131, v131
    v_mfma_f32_16x16x32_bf16 v[4:7], a[192:195], v[180:183], v[4:7]
    s_waitcnt lgkmcnt(15)
    v_sub_f32 v135, v135, v218
    v_sub_f32_e64 v136, v136, v220
    v_mfma_f32_16x16x32_bf16 v[8:11], a[192:195], v[184:187], v[8:11]
    v_exp_f32_e64 v132, v132
    v_mfma_f32_16x16x32_bf16 v[12:15], a[192:195], v[188:191], v[12:15]
    v_sub_f32 v137, v137, v220
    v_sub_f32 v138, v138, v220
    v_mfma_f32_16x16x32_bf16 v[16:19], a[196:199], v[176:179], v[16:19]
    v_exp_f32_e64 v133, v133
    v_mfma_f32_16x16x32_bf16 v[20:23], a[196:199], v[180:183], v[20:23]
    s_waitcnt lgkmcnt(15)
    v_sub_f32 v139, v139, v220
    v_sub_f32_e64 v140, v140, v222
    v_mfma_f32_16x16x32_bf16 v[24:27], a[196:199], v[184:187], v[24:27]
    v_exp_f32_e64 v134, v134
    v_mfma_f32_16x16x32_bf16 v[28:31], a[196:199], v[188:191], v[28:31]
    v_sub_f32 v141, v141, v222
    v_sub_f32 v142, v142, v222
    v_mfma_f32_16x16x32_bf16 v[32:35], a[200:203], v[176:179], v[32:35]
    v_exp_f32_e64 v135, v135
    v_mfma_f32_16x16x32_bf16 v[36:39], a[200:203], v[180:183], v[36:39]
    s_waitcnt lgkmcnt(15)
    v_sub_f32 v143, v143, v222
    v_cvt_pk_bf16_f32 v160, v128, v129
    v_mfma_f32_16x16x32_bf16 v[40:43], a[200:203], v[184:187], v[40:43]
    v_exp_f32_e64 v149, v149
    v_mfma_f32_16x16x32_bf16 v[44:47], a[200:203], v[188:191], v[44:47]
    v_cvt_pk_bf16_f32 v161, v130, v131
    v_cvt_pk_bf16_f32 v162, v144, v145
    v_mfma_f32_16x16x32_bf16 v[48:51], a[204:207], v[176:179], v[48:51]
    v_exp_f32_e64 v150, v150
    v_mfma_f32_16x16x32_bf16 v[52:55], a[204:207], v[180:183], v[52:55]
    s_waitcnt lgkmcnt(14)
    v_cvt_pk_bf16_f32 v163, v146, v147
    v_cvt_pk_bf16_f32 v164, v132, v133
    v_mfma_f32_16x16x32_bf16 v[56:59], a[204:207], v[184:187], v[56:59]
    v_exp_f32 v151, v151
    v_mfma_f32_16x16x32_bf16 v[60:63], a[204:207], v[188:191], v[60:63]
    v_cvt_pk_bf16_f32 v165, v134, v135
    v_cvt_pk_bf16_f32 v166, v148, v149
    v_mfma_f32_16x16x32_bf16 v[64:67], a[208:211], v[176:179], v[64:67]
    v_exp_f32_e64 v136, v136
    v_mfma_f32_16x16x32_bf16 v[68:71], a[208:211], v[180:183], v[68:71]
    s_waitcnt lgkmcnt(12)
    v_cvt_pk_bf16_f32 v167, v150, v151
    v_accvgpr_read_b32 v224, a224
    v_mfma_f32_16x16x32_bf16 v[72:75], a[208:211], v[184:187], v[72:75]
    v_exp_f32 v137, v137
    v_mfma_f32_16x16x32_bf16 v[76:79], a[208:211], v[188:191], v[76:79]
    v_cvt_pk_bf16_f32 v168, v136, v137
    v_cmp_nle_f32 vcc, v224, v255
    v_mfma_f32_16x16x32_bf16 v[80:83], a[212:215], v[176:179], v[80:83]
    v_exp_f32 v138, v138
    v_mfma_f32_16x16x32_bf16 v[84:87], a[212:215], v[180:183], v[84:87]
    s_waitcnt lgkmcnt(10)
    v_accvgpr_read_b32 v226, a228
    v_accvgpr_read_b32 v228, a232
    v_mfma_f32_16x16x32_bf16 v[88:91], a[212:215], v[184:187], v[88:91]
    s_or_b64 s[42:43], s[42:43], vcc
    v_exp_f32_e64 v139, v139
    v_mfma_f32_16x16x32_bf16 v[92:95], a[212:215], v[188:191], v[92:95]
    v_cvt_pk_bf16_f32 v169, v138, v139
    v_cmp_nle_f32 vcc, v226, v255
    v_mfma_f32_16x16x32_bf16 v[96:99], a[216:219], v[176:179], v[96:99]
    v_exp_f32 v152, v152
    v_mfma_f32_16x16x32_bf16 v[100:103], a[216:219], v[180:183], v[100:103]
    s_waitcnt lgkmcnt(8)
    v_accvgpr_read_b32 v230, a236
    v_mfma_f32_16x16x32_bf16 v[104:107], a[216:219], v[184:187], v[104:107]
    s_or_b64 s[42:43], s[42:43], vcc
    v_exp_f32_e64 v153, v153
    v_mfma_f32_16x16x32_bf16 v[108:111], a[216:219], v[188:191], v[108:111]
    v_cvt_pk_bf16_f32 v170, v152, v153
    v_cmp_nle_f32 vcc, v228, v255
    v_mfma_f32_16x16x32_bf16 v[112:115], a[220:223], v[176:179], v[112:115]
    v_exp_f32 v154, v154
    v_mfma_f32_16x16x32_bf16 v[116:119], a[220:223], v[180:183], v[116:119]
    v_mfma_f32_16x16x32_bf16 v[120:123], a[220:223], v[184:187], v[120:123]
    s_or_b64 s[42:43], s[42:43], vcc
    v_exp_f32 v155, v155
    v_mfma_f32_16x16x32_bf16 v[124:127], a[220:223], v[188:191], v[124:127]
    v_cvt_pk_bf16_f32 v171, v154, v155
    v_cmp_nle_f32 vcc, v230, v255
    v_exp_f32 v140, v140
    v_exp_f32 v141, v141
    v_exp_f32 v142, v142
    v_cvt_pk_bf16_f32 v172, v140, v141
    v_exp_f32 v143, v143
    v_exp_f32 v156, v156
    v_cvt_pk_bf16_f32 v173, v142, v143
    v_exp_f32 v157, v157
    v_exp_f32 v158, v158
    v_cvt_pk_bf16_f32 v174, v156, v157
    v_exp_f32 v159, v159
    s_waitcnt lgkmcnt(4)
    v_cvt_pk_bf16_f32 v175, v158, v159
    s_waitcnt lgkmcnt(0)
    v_rcp_f32 v248, v224
    v_rcp_f32 v249, v226
    v_rcp_f32 v250, v228
    v_rcp_f32 v251, v230
    s_or_b64 s[42:43], s[42:43], vcc
    v_pk_mul_f32 v[0:1], v[0:1], v[248:249] op_sel:[0,0] op_sel_hi:[1,0]
    v_pk_mul_f32 v[2:3], v[2:3], v[248:249] op_sel:[0,0] op_sel_hi:[1,0]
    v_cvt_pk_bf16_f32 v232, v0, v1
    v_cvt_pk_bf16_f32 v233, v2, v3
    v_pk_mul_f32 v[16:17], v[16:17], v[248:249] op_sel:[0,0] op_sel_hi:[1,0]
    v_pk_mul_f32 v[18:19], v[18:19], v[248:249] op_sel:[0,0] op_sel_hi:[1,0]
    v_cvt_pk_bf16_f32 v234, v16, v17
    v_cvt_pk_bf16_f32 v235, v18, v19
    v_accvgpr_write_b32 a64, v232
    v_accvgpr_write_b32 a65, v233
    v_accvgpr_write_b32 a66, v234
    v_accvgpr_write_b32 a67, v235
    v_pk_mul_f32 v[4:5], v[4:5], v[248:249] op_sel:[0,1] op_sel_hi:[1,1]
    v_pk_mul_f32 v[6:7], v[6:7], v[248:249] op_sel:[0,1] op_sel_hi:[1,1]
    v_cvt_pk_bf16_f32 v236, v4, v5
    v_cvt_pk_bf16_f32 v237, v6, v7
    v_pk_mul_f32 v[20:21], v[20:21], v[248:249] op_sel:[0,1] op_sel_hi:[1,1]
    v_pk_mul_f32 v[22:23], v[22:23], v[248:249] op_sel:[0,1] op_sel_hi:[1,1]
    v_cvt_pk_bf16_f32 v238, v20, v21
    v_cvt_pk_bf16_f32 v239, v22, v23
    v_accvgpr_write_b32 a68, v236
    v_accvgpr_write_b32 a69, v237
    v_accvgpr_write_b32 a70, v238
    v_accvgpr_write_b32 a71, v239
    v_pk_mul_f32 v[8:9], v[8:9], v[250:251] op_sel:[0,0] op_sel_hi:[1,0]
    v_pk_mul_f32 v[10:11], v[10:11], v[250:251] op_sel:[0,0] op_sel_hi:[1,0]
    v_cvt_pk_bf16_f32 v232, v8, v9
    v_cvt_pk_bf16_f32 v233, v10, v11
    v_pk_mul_f32 v[24:25], v[24:25], v[250:251] op_sel:[0,0] op_sel_hi:[1,0]
    v_pk_mul_f32 v[26:27], v[26:27], v[250:251] op_sel:[0,0] op_sel_hi:[1,0]
    v_cvt_pk_bf16_f32 v234, v24, v25
    v_cvt_pk_bf16_f32 v235, v26, v27
    v_accvgpr_write_b32 a72, v232
    v_accvgpr_write_b32 a73, v233
    v_accvgpr_write_b32 a74, v234
    v_accvgpr_write_b32 a75, v235
    v_pk_mul_f32 v[12:13], v[12:13], v[250:251] op_sel:[0,1] op_sel_hi:[1,1]
    v_pk_mul_f32 v[14:15], v[14:15], v[250:251] op_sel:[0,1] op_sel_hi:[1,1]
    v_cvt_pk_bf16_f32 v236, v12, v13
    v_cvt_pk_bf16_f32 v237, v14, v15
    v_pk_mul_f32 v[28:29], v[28:29], v[250:251] op_sel:[0,1] op_sel_hi:[1,1]
    v_pk_mul_f32 v[30:31], v[30:31], v[250:251] op_sel:[0,1] op_sel_hi:[1,1]
    v_cvt_pk_bf16_f32 v238, v28, v29
    v_cvt_pk_bf16_f32 v239, v30, v31
    v_accvgpr_write_b32 a76, v236
    v_accvgpr_write_b32 a77, v237
    v_accvgpr_write_b32 a78, v238
    v_accvgpr_write_b32 a79, v239
    v_pk_mul_f32 v[32:33], v[32:33], v[248:249] op_sel:[0,0] op_sel_hi:[1,0]
    v_pk_mul_f32 v[34:35], v[34:35], v[248:249] op_sel:[0,0] op_sel_hi:[1,0]
    v_cvt_pk_bf16_f32 v232, v32, v33
    v_cvt_pk_bf16_f32 v233, v34, v35
    v_pk_mul_f32 v[48:49], v[48:49], v[248:249] op_sel:[0,0] op_sel_hi:[1,0]
    v_pk_mul_f32 v[50:51], v[50:51], v[248:249] op_sel:[0,0] op_sel_hi:[1,0]
    v_cvt_pk_bf16_f32 v234, v48, v49
    v_cvt_pk_bf16_f32 v235, v50, v51
    v_accvgpr_write_b32 a80, v232
    v_accvgpr_write_b32 a81, v233
    v_accvgpr_write_b32 a82, v234
    v_accvgpr_write_b32 a83, v235
    v_pk_mul_f32 v[36:37], v[36:37], v[248:249] op_sel:[0,1] op_sel_hi:[1,1]
    v_pk_mul_f32 v[38:39], v[38:39], v[248:249] op_sel:[0,1] op_sel_hi:[1,1]
    v_cvt_pk_bf16_f32 v236, v36, v37
    v_cvt_pk_bf16_f32 v237, v38, v39
    v_pk_mul_f32 v[52:53], v[52:53], v[248:249] op_sel:[0,1] op_sel_hi:[1,1]
    v_pk_mul_f32 v[54:55], v[54:55], v[248:249] op_sel:[0,1] op_sel_hi:[1,1]
    v_cvt_pk_bf16_f32 v238, v52, v53
    v_cvt_pk_bf16_f32 v239, v54, v55
    v_accvgpr_write_b32 a84, v236
    v_accvgpr_write_b32 a85, v237
    v_accvgpr_write_b32 a86, v238
    v_accvgpr_write_b32 a87, v239
    v_pk_mul_f32 v[40:41], v[40:41], v[250:251] op_sel:[0,0] op_sel_hi:[1,0]
    v_pk_mul_f32 v[42:43], v[42:43], v[250:251] op_sel:[0,0] op_sel_hi:[1,0]
    v_cvt_pk_bf16_f32 v232, v40, v41
    v_cvt_pk_bf16_f32 v233, v42, v43
    v_pk_mul_f32 v[56:57], v[56:57], v[250:251] op_sel:[0,0] op_sel_hi:[1,0]
    v_pk_mul_f32 v[58:59], v[58:59], v[250:251] op_sel:[0,0] op_sel_hi:[1,0]
    v_cvt_pk_bf16_f32 v234, v56, v57
    v_cvt_pk_bf16_f32 v235, v58, v59
    v_accvgpr_write_b32 a88, v232
    v_accvgpr_write_b32 a89, v233
    v_accvgpr_write_b32 a90, v234
    v_accvgpr_write_b32 a91, v235
    v_pk_mul_f32 v[44:45], v[44:45], v[250:251] op_sel:[0,1] op_sel_hi:[1,1]
    v_pk_mul_f32 v[46:47], v[46:47], v[250:251] op_sel:[0,1] op_sel_hi:[1,1]
    v_cvt_pk_bf16_f32 v236, v44, v45
    v_cvt_pk_bf16_f32 v237, v46, v47
    v_pk_mul_f32 v[60:61], v[60:61], v[250:251] op_sel:[0,1] op_sel_hi:[1,1]
    v_pk_mul_f32 v[62:63], v[62:63], v[250:251] op_sel:[0,1] op_sel_hi:[1,1]
    v_cvt_pk_bf16_f32 v238, v60, v61
    v_cvt_pk_bf16_f32 v239, v62, v63
    v_accvgpr_write_b32 a92, v236
    v_accvgpr_write_b32 a93, v237
    v_accvgpr_write_b32 a94, v238
    v_accvgpr_write_b32 a95, v239
    v_pk_mul_f32 v[64:65], v[64:65], v[248:249] op_sel:[0,0] op_sel_hi:[1,0]
    v_pk_mul_f32 v[66:67], v[66:67], v[248:249] op_sel:[0,0] op_sel_hi:[1,0]
    v_cvt_pk_bf16_f32 v232, v64, v65
    v_cvt_pk_bf16_f32 v233, v66, v67
    v_pk_mul_f32 v[80:81], v[80:81], v[248:249] op_sel:[0,0] op_sel_hi:[1,0]
    v_pk_mul_f32 v[82:83], v[82:83], v[248:249] op_sel:[0,0] op_sel_hi:[1,0]
    v_cvt_pk_bf16_f32 v234, v80, v81
    v_cvt_pk_bf16_f32 v235, v82, v83
    v_accvgpr_write_b32 a96, v232
    v_accvgpr_write_b32 a97, v233
    v_accvgpr_write_b32 a98, v234
    v_accvgpr_write_b32 a99, v235
    v_pk_mul_f32 v[68:69], v[68:69], v[248:249] op_sel:[0,1] op_sel_hi:[1,1]
    v_pk_mul_f32 v[70:71], v[70:71], v[248:249] op_sel:[0,1] op_sel_hi:[1,1]
    v_cvt_pk_bf16_f32 v236, v68, v69
    v_cvt_pk_bf16_f32 v237, v70, v71
    v_pk_mul_f32 v[84:85], v[84:85], v[248:249] op_sel:[0,1] op_sel_hi:[1,1]
    v_pk_mul_f32 v[86:87], v[86:87], v[248:249] op_sel:[0,1] op_sel_hi:[1,1]
    v_cvt_pk_bf16_f32 v238, v84, v85
    v_cvt_pk_bf16_f32 v239, v86, v87
    v_accvgpr_write_b32 a100, v236
    v_accvgpr_write_b32 a101, v237
    v_accvgpr_write_b32 a102, v238
    v_accvgpr_write_b32 a103, v239
    v_pk_mul_f32 v[72:73], v[72:73], v[250:251] op_sel:[0,0] op_sel_hi:[1,0]
    v_pk_mul_f32 v[74:75], v[74:75], v[250:251] op_sel:[0,0] op_sel_hi:[1,0]
    v_cvt_pk_bf16_f32 v232, v72, v73
    v_cvt_pk_bf16_f32 v233, v74, v75
    v_pk_mul_f32 v[88:89], v[88:89], v[250:251] op_sel:[0,0] op_sel_hi:[1,0]
    v_pk_mul_f32 v[90:91], v[90:91], v[250:251] op_sel:[0,0] op_sel_hi:[1,0]
    v_cvt_pk_bf16_f32 v234, v88, v89
    v_cvt_pk_bf16_f32 v235, v90, v91
    v_accvgpr_write_b32 a104, v232
    v_accvgpr_write_b32 a105, v233
    v_accvgpr_write_b32 a106, v234
    v_accvgpr_write_b32 a107, v235
    v_pk_mul_f32 v[76:77], v[76:77], v[250:251] op_sel:[0,1] op_sel_hi:[1,1]
    v_pk_mul_f32 v[78:79], v[78:79], v[250:251] op_sel:[0,1] op_sel_hi:[1,1]
    v_cvt_pk_bf16_f32 v236, v76, v77
    v_cvt_pk_bf16_f32 v237, v78, v79
    v_pk_mul_f32 v[92:93], v[92:93], v[250:251] op_sel:[0,1] op_sel_hi:[1,1]
    v_pk_mul_f32 v[94:95], v[94:95], v[250:251] op_sel:[0,1] op_sel_hi:[1,1]
    v_cvt_pk_bf16_f32 v238, v92, v93
    v_cvt_pk_bf16_f32 v239, v94, v95
    v_accvgpr_write_b32 a108, v236
    v_accvgpr_write_b32 a109, v237
    v_accvgpr_write_b32 a110, v238
    v_accvgpr_write_b32 a111, v239
    v_pk_mul_f32 v[96:97], v[96:97], v[248:249] op_sel:[0,0] op_sel_hi:[1,0]
    v_pk_mul_f32 v[98:99], v[98:99], v[248:249] op_sel:[0,0] op_sel_hi:[1,0]
    v_cvt_pk_bf16_f32 v232, v96, v97
    v_cvt_pk_bf16_f32 v233, v98, v99
    v_pk_mul_f32 v[112:113], v[112:113], v[248:249] op_sel:[0,0] op_sel_hi:[1,0]
    v_pk_mul_f32 v[114:115], v[114:115], v[248:249] op_sel:[0,0] op_sel_hi:[1,0]
    v_cvt_pk_bf16_f32 v234, v112, v113
    v_cvt_pk_bf16_f32 v235, v114, v115
    v_accvgpr_write_b32 a112, v232
    v_accvgpr_write_b32 a113, v233
    v_accvgpr_write_b32 a114, v234
    v_accvgpr_write_b32 a115, v235
    v_pk_mul_f32 v[100:101], v[100:101], v[248:249] op_sel:[0,1] op_sel_hi:[1,1]
    v_pk_mul_f32 v[102:103], v[102:103], v[248:249] op_sel:[0,1] op_sel_hi:[1,1]
    v_cvt_pk_bf16_f32 v236, v100, v101
    v_cvt_pk_bf16_f32 v237, v102, v103
    v_pk_mul_f32 v[116:117], v[116:117], v[248:249] op_sel:[0,1] op_sel_hi:[1,1]
    v_pk_mul_f32 v[118:119], v[118:119], v[248:249] op_sel:[0,1] op_sel_hi:[1,1]
    v_cvt_pk_bf16_f32 v238, v116, v117
    v_cvt_pk_bf16_f32 v239, v118, v119
    v_accvgpr_write_b32 a116, v236
    v_accvgpr_write_b32 a117, v237
    v_accvgpr_write_b32 a118, v238
    v_accvgpr_write_b32 a119, v239
    v_pk_mul_f32 v[104:105], v[104:105], v[250:251] op_sel:[0,0] op_sel_hi:[1,0]
    v_pk_mul_f32 v[106:107], v[106:107], v[250:251] op_sel:[0,0] op_sel_hi:[1,0]
    v_cvt_pk_bf16_f32 v232, v104, v105
    v_cvt_pk_bf16_f32 v233, v106, v107
    v_pk_mul_f32 v[120:121], v[120:121], v[250:251] op_sel:[0,0] op_sel_hi:[1,0]
    v_pk_mul_f32 v[122:123], v[122:123], v[250:251] op_sel:[0,0] op_sel_hi:[1,0]
    v_cvt_pk_bf16_f32 v234, v120, v121
    v_cvt_pk_bf16_f32 v235, v122, v123
    v_accvgpr_write_b32 a120, v232
    v_accvgpr_write_b32 a121, v233
    v_accvgpr_write_b32 a122, v234
    v_accvgpr_write_b32 a123, v235
    v_pk_mul_f32 v[108:109], v[108:109], v[250:251] op_sel:[0,1] op_sel_hi:[1,1]
    v_pk_mul_f32 v[110:111], v[110:111], v[250:251] op_sel:[0,1] op_sel_hi:[1,1]
    v_cvt_pk_bf16_f32 v236, v108, v109
    v_cvt_pk_bf16_f32 v237, v110, v111
    v_pk_mul_f32 v[124:125], v[124:125], v[250:251] op_sel:[0,1] op_sel_hi:[1,1]
    v_pk_mul_f32 v[126:127], v[126:127], v[250:251] op_sel:[0,1] op_sel_hi:[1,1]
    v_cvt_pk_bf16_f32 v238, v124, v125
    v_cvt_pk_bf16_f32 v239, v126, v127
    v_accvgpr_write_b32 a124, v236
    v_accvgpr_write_b32 a125, v237
    v_accvgpr_write_b32 a126, v238
    v_accvgpr_write_b32 a127, v239
    s_add_u32 s29, s29, 1
    s_cmp_lt_u32 s29, 4
    s_cbranch_scc1 L_pass
    buffer_store_dwordx4 a[64:67], v246, s[24:27], s66 offen offset:0 sc1
    buffer_store_dwordx4 a[80:83], v246, s[24:27], s66 offen offset:64 sc1
    buffer_store_dwordx4 a[96:99], v246, s[24:27], s66 offen offset:128 sc1
    buffer_store_dwordx4 a[112:115], v246, s[24:27], s66 offen offset:192 sc1
    buffer_store_dwordx4 a[68:71], v246, s[24:27], s67 offen offset:0 sc1
    buffer_store_dwordx4 a[84:87], v246, s[24:27], s67 offen offset:64 sc1
    buffer_store_dwordx4 a[100:103], v246, s[24:27], s67 offen offset:128 sc1
    buffer_store_dwordx4 a[116:119], v246, s[24:27], s67 offen offset:192 sc1
    buffer_store_dwordx4 a[72:75], v246, s[24:27], s68 offen offset:0 sc1
    buffer_store_dwordx4 a[88:91], v246, s[24:27], s68 offen offset:64 sc1
    buffer_store_dwordx4 a[104:107], v246, s[24:27], s68 offen offset:128 sc1
    buffer_store_dwordx4 a[120:123], v246, s[24:27], s68 offen offset:192 sc1
    buffer_store_dwordx4 a[76:79], v246, s[24:27], s69 offen offset:0 sc1
    buffer_store_dwordx4 a[92:95], v246, s[24:27], s69 offen offset:64 sc1
    buffer_store_dwordx4 a[108:111], v246, s[24:27], s69 offen offset:128 sc1
    buffer_store_dwordx4 a[124:127], v246, s[24:27], s69 offen offset:192 sc1
    s_cmp_lg_u64 s[42:43], 0
    s_cbranch_scc1 L_slow
L_end:
    s_endpgm
L_code_end:
L_slow:
    s_waitcnt vmcnt(0) lgkmcnt(0)
    v_mbcnt_lo_u32_b32 v226, -1, 0
    v_mbcnt_hi_u32_b32 v226, -1, v226
    v_lshrrev_b32 v217, 4, v226
    v_lshlrev_b32 v217, 10, v217
    v_bfe_u32 v227, v226, 2, 2
    v_lshl_add_u32 v217, v227, 4, v217
    v_and_b32 v227, 3, v226
    v_lshl_add_u32 v217, v227, 1, v217
    s_lshl_b32 s44, s28, 6
    s_mov_b32 s79, 0
L_slow_pass:
    s_add_u32 s45, s44, 0
    s_lshl_b32 s46, s45, 8
    s_add_u32 s46, s46, s41
    s_cmp_lt_u32 s45, 992
    s_cselect_b32 s30, s46, s50
    s_add_u32 s45, s44, 16
    s_lshl_b32 s46, s45, 8
    s_add_u32 s46, s46, s41
    s_cmp_lt_u32 s45, 992
    s_cselect_b32 s31, s46, s50
    s_add_u32 s45, s44, 32
    s_lshl_b32 s46, s45, 8
    s_add_u32 s46, s46, s41
    s_cmp_lt_u32 s45, 992
    s_cselect_b32 s32, s46, s50
    s_add_u32 s45, s44, 48
    s_lshl_b32 s46, s45, 8
    s_add_u32 s46, s46, s41
    s_cmp_lt_u32 s45, 992
    s_cselect_b32 s33, s46, s50
    buffer_load_dwordx4 a[0:3], v246, s[12:15], s30 offen offset:0
    buffer_load_dwordx4 a[4:7], v246, s[12:15], s30 offen offset:64
    buffer_load_dwordx4 a[8:11], v246, s[12:15], s30 offen offset:128
    buffer_load_dwordx4 a[12:15], v246, s[12:15], s30 offen offset:192
    buffer_load_dwordx4 a[16:19], v246, s[12:15], s31 offen offset:0
    buffer_load_dwordx4 a[20:23], v246, s[12:15], s31 offen offset:64
    buffer_load_dwordx4 a[24:27], v246, s[12:15], s31 offen offset:128
    buffer_load_dwordx4 a[28:31], v246, s[12:15], s31 offen offset:192
    buffer_load_dwordx4 a[32:35], v246, s[12:15], s32 offen offset:0
    buffer_load_dwordx4 a[36:39], v246, s[12:15], s32 offen offset:64
    buffer_load_dwordx4 a[40:43], v246, s[12:15], s32 offen offset:128
    buffer_load_dwordx4 a[44:47], v246, s[12:15], s32 offen offset:192
    buffer_load_dwordx4 a[48:51], v246, s[12:15], s33 offen offset:0
    buffer_load_dwordx4 a[52:55], v246, s[12:15], s33 offen offset:64
    buffer_load_dwordx4 a[56:59], v246, s[12:15], s33 offen offset:128
    buffer_load_dwordx4 a[60:63], v246, s[12:15], s33 offen offset:192
    v_mov_b32 v218, 0xff800000
    v_mov_b32 v219, 0xff800000
    v_mov_b32 v220, 0xff800000
    v_mov_b32 v221, 0xff800000
    s_waitcnt vmcnt(0)
    v_mov_b32 v216, v240
    s_mov_b32 s78, 0
L_slow_max:
    ds_read_b128 a[128:131], v216 offset:0
    ds_read_b128 a[132:135], v216 offset:1024
    ds_read_b128 a[136:139], v216 offset:2048
    ds_read_b128 a[140:143], v216 offset:3072
    ds_read_b128 a[144:147], v216 offset:4096
    ds_read_b128 a[148:151], v216 offset:5120
    ds_read_b128 a[152:155], v216 offset:6144
    ds_read_b128 a[156:159], v216 offset:7168
    s_waitcnt lgkmcnt(0)
    v_mfma_f32_16x16x32_bf16 v[128:131], a[128:131], a[0:3], 0
    v_mfma_f32_16x16x32_bf16 v[128:131], a[132:135], a[4:7], v[128:131]
    v_mfma_f32_16x16x32_bf16 v[128:131], a[136:139], a[8:11], v[128:131]
    v_mfma_f32_16x16x32_bf16 v[128:131], a[140:143], a[12:15], v[128:131]
    v_mfma_f32_16x16x32_bf16 v[132:135], a[128:131], a[16:19], 0
    v_mfma_f32_16x16x32_bf16 v[132:135], a[132:135], a[20:23], v[132:135]
    v_mfma_f32_16x16x32_bf16 v[132:135], a[136:139], a[24:27], v[132:135]
    v_mfma_f32_16x16x32_bf16 v[132:135], a[140:143], a[28:31], v[132:135]
    v_mfma_f32_16x16x32_bf16 v[136:139], a[128:131], a[32:35], 0
    v_mfma_f32_16x16x32_bf16 v[136:139], a[132:135], a[36:39], v[136:139]
    v_mfma_f32_16x16x32_bf16 v[136:139], a[136:139], a[40:43], v[136:139]
    v_mfma_f32_16x16x32_bf16 v[136:139], a[140:143], a[44:47], v[136:139]
    v_mfma_f32_16x16x32_bf16 v[140:143], a[128:131], a[48:51], 0
    v_mfma_f32_16x16x32_bf16 v[140:143], a[132:135], a[52:55], v[140:143]
    v_mfma_f32_16x16x32_bf16 v[140:143], a[136:139], a[56:59], v[140:143]
    v_mfma_f32_16x16x32_bf16 v[140:143], a[140:143], a[60:63], v[140:143]
    v_mfma_f32_16x16x32_bf16 v[144:147], a[144:147], a[0:3], 0
    v_mfma_f32_16x16x32_bf16 v[144:147], a[148:151], a[4:7], v[144:147]
    v_mfma_f32_16x16x32_bf16 v[144:147], a[152:155], a[8:11], v[144:147]
    v_mfma_f32_16x16x32_bf16 v[144:147], a[156:159], a[12:15], v[144:147]
    v_mfma_f32_16x16x32_bf16 v[148:151], a[144:147], a[16:19], 0
    v_mfma_f32_16x16x32_bf16 v[148:151], a[148:151], a[20:23], v[148:151]
    v_mfma_f32_16x16x32_bf16 v[148:151], a[152:155], a[24:27], v[148:151]
    v_mfma_f32_16x16x32_bf16 v[148:151], a[156:159], a[28:31], v[148:151]
    v_mfma_f32_16x16x32_bf16 v[152:155], a[144:147], a[32:35], 0
    v_mfma_f32_16x16x32_bf16 v[152:155], a[148:151], a[36:39], v[152:155]
    v_mfma_f32_16x16x32_bf16 v[152:155], a[152:155], a[40:43], v[152:155]
    v_mfma_f32_16x16x32_bf16 v[152:155], a[156:159], a[44:47], v[152:155]
    v_mfma_f32_16x16x32_bf16 v[156:159], a[144:147], a[48:51], 0
    v_mfma_f32_16x16x32_bf16 v[156:159], a[148:151], a[52:55], v[156:159]
    v_mfma_f32_16x16x32_bf16 v[156:159], a[152:155], a[56:59], v[156:159]
    v_mfma_f32_16x16x32_bf16 v[156:159], a[156:159], a[60:63], v[156:159]
    s_nop 15
    v_max3_f32 v218, v218, v128, v129
    v_max3_f32 v218, v218, v130, v131
    v_max3_f32 v218, v218, v144, v145
    v_max3_f32 v218, v218, v146, v147
    v_max3_f32 v219, v219, v132, v133
    v_max3_f32 v219, v219, v134, v135
    v_max3_f32 v219, v219, v148, v149
    v_max3_f32 v219, v219, v150, v151
    v_max3_f32 v220, v220, v136, v137
    v_max3_f32 v220, v220, v138, v139
    v_max3_f32 v220, v220, v152, v153
    v_max3_f32 v220, v220, v154, v155
    v_max3_f32 v221, v221, v140, v141
    v_max3_f32 v221, v221, v142, v143
    v_max3_f32 v221, v221, v156, v157
    v_max3_f32 v221, v221, v158, v159
    v_add_u32 v216, 8192, v216
    s_add_u32 s78, s78, 1
    s_cmp_lt_u32 s78, 16
    s_nop 7
    s_cbranch_scc1 L_slow_max
    v_mov_b32 v226, v218
    s_nop 1
    v_permlane16_swap_b32 v218, v226
    s_nop 1
    v_max_f32 v218, v218, v226
    v_mov_b32 v226, v218
    s_nop 1
    v_permlane32_swap_b32 v218, v226
    s_nop 1
    v_max_f32 v218, v218, v226
    v_sub_f32 v192, 0, v218
    v_sub_f32 v193, 0, v218
    v_sub_f32 v194, 0, v218
    v_sub_f32 v195, 0, v218
    v_mov_b32 v222, 0
    v_mov_b32 v226, v219
    s_nop 1
    v_permlane16_swap_b32 v219, v226
    s_nop 1
    v_max_f32 v219, v219, v226
    v_mov_b32 v226, v219
    s_nop 1
    v_permlane32_swap_b32 v219, v226
    s_nop 1
    v_max_f32 v219, v219, v226
    v_sub_f32 v196, 0, v219
    v_sub_f32 v197, 0, v219
    v_sub_f32 v198, 0, v219
    v_sub_f32 v199, 0, v219
    v_mov_b32 v223, 0
    v_mov_b32 v226, v220
    s_nop 1
    v_permlane16_swap_b32 v220, v226
    s_nop 1
    v_max_f32 v220, v220, v226
    v_mov_b32 v226, v220
    s_nop 1
    v_permlane32_swap_b32 v220, v226
    s_nop 1
    v_max_f32 v220, v220, v226
    v_sub_f32 v200, 0, v220
    v_sub_f32 v201, 0, v220
    v_sub_f32 v202, 0, v220
    v_sub_f32 v203, 0, v220
    v_mov_b32 v224, 0
    v_mov_b32 v226, v221
    s_nop 1
    v_permlane16_swap_b32 v221, v226
    s_nop 1
    v_max_f32 v221, v221, v226
    v_mov_b32 v226, v221
    s_nop 1
    v_permlane32_swap_b32 v221, v226
    s_nop 1
    v_max_f32 v221, v221, v226
    v_sub_f32 v204, 0, v221
    v_sub_f32 v205, 0, v221
    v_sub_f32 v206, 0, v221
    v_sub_f32 v207, 0, v221
    v_mov_b32 v225, 0
    v_mov_b32 v0, 0
    v_mov_b32 v1, 0
    v_mov_b32 v2, 0
    v_mov_b32 v3, 0
    v_mov_b32 v4, 0
    v_mov_b32 v5, 0
    v_mov_b32 v6, 0
    v_mov_b32 v7, 0
    v_mov_b32 v8, 0
    v_mov_b32 v9, 0
    v_mov_b32 v10, 0
    v_mov_b32 v11, 0
    v_mov_b32 v12, 0
    v_mov_b32 v13, 0
    v_mov_b32 v14, 0
    v_mov_b32 v15, 0
    v_mov_b32 v16, 0
    v_mov_b32 v17, 0
    v_mov_b32 v18, 0
    v_mov_b32 v19, 0
    v_mov_b32 v20, 0
    v_mov_b32 v21, 0
    v_mov_b32 v22, 0
    v_mov_b32 v23, 0
    v_mov_b32 v24, 0
    v_mov_b32 v25, 0
    v_mov_b32 v26, 0
    v_mov_b32 v27, 0
    v_mov_b32 v28, 0
    v_mov_b32 v29, 0
    v_mov_b32 v30, 0
    v_mov_b32 v31, 0
    v_mov_b32 v32, 0
    v_mov_b32 v33, 0
    v_mov_b32 v34, 0
    v_mov_b32 v35, 0
    v_mov_b32 v36, 0
    v_mov_b32 v37, 0
    v_mov_b32 v38, 0
    v_mov_b32 v39, 0
    v_mov_b32 v40, 0
    v_mov_b32 v41, 0
    v_mov_b32 v42, 0
    v_mov_b32 v43, 0
    v_mov_b32 v44, 0
    v_mov_b32 v45, 0
    v_mov_b32 v46, 0
    v_mov_b32 v47, 0
    v_mov_b32 v48, 0
    v_mov_b32 v49, 0
    v_mov_b32 v50, 0
    v_mov_b32 v51, 0
    v_mov_b32 v52, 0
    v_mov_b32 v53, 0
    v_mov_b32 v54, 0
    v_mov_b32 v55, 0
    v_mov_b32 v56, 0
    v_mov_b32 v57, 0
    v_mov_b32 v58, 0
    v_mov_b32 v59, 0
    v_mov_b32 v60, 0
    v_mov_b32 v61, 0
    v_mov_b32 v62, 0
    v_mov_b32 v63, 0
    v_mov_b32 v64, 0
    v_mov_b32 v65, 0
    v_mov_b32 v66, 0
    v_mov_b32 v67, 0
    v_mov_b32 v68, 0
    v_mov_b32 v69, 0
    v_mov_b32 v70, 0
    v_mov_b32 v71, 0
    v_mov_b32 v72, 0
    v_mov_b32 v73, 0
    v_mov_b32 v74, 0
    v_mov_b32 v75, 0
    v_mov_b32 v76, 0
    v_mov_b32 v77, 0
    v_mov_b32 v78, 0
    v_mov_b32 v79, 0
    v_mov_b32 v80, 0
    v_mov_b32 v81, 0
    v_mov_b32 v82, 0
    v_mov_b32 v83, 0
    v_mov_b32 v84, 0
    v_mov_b32 v85, 0
    v_mov_b32 v86, 0
    v_mov_b32 v87, 0
    v_mov_b32 v88, 0
    v_mov_b32 v89, 0
    v_mov_b32 v90, 0
    v_mov_b32 v91, 0
    v_mov_b32 v92, 0
    v_mov_b32 v93, 0
    v_mov_b32 v94, 0
    v_mov_b32 v95, 0
    v_mov_b32 v96, 0
    v_mov_b32 v97, 0
    v_mov_b32 v98, 0
    v_mov_b32 v99, 0
    v_mov_b32 v100, 0
    v_mov_b32 v101, 0
    v_mov_b32 v102, 0
    v_mov_b32 v103, 0
    v_mov_b32 v104, 0
    v_mov_b32 v105, 0
    v_mov_b32 v106, 0
    v_mov_b32 v107, 0
    v_mov_b32 v108, 0
    v_mov_b32 v109, 0
    v_mov_b32 v110, 0
    v_mov_b32 v111, 0
    v_mov_b32 v112, 0
    v_mov_b32 v113, 0
    v_mov_b32 v114, 0
    v_mov_b32 v115, 0
    v_mov_b32 v116, 0
    v_mov_b32 v117, 0
    v_mov_b32 v118, 0
    v_mov_b32 v119, 0
    v_mov_b32 v120, 0
    v_mov_b32 v121, 0
    v_mov_b32 v122, 0
    v_mov_b32 v123, 0
    v_mov_b32 v124, 0
    v_mov_b32 v125, 0
    v_mov_b32 v126, 0
    v_mov_b32 v127, 0
    v_mov_b32 v216, v240
    s_mov_b32 s78, 0
L_slow_pv:
    s_mul_i32 s86, s84, 0
    s_add_u32 s86, s86, s78
    s_and_b32 s86, s86, 15
    s_lshl_b32 s86, s86, 13
    s_add_u32 s86, s86, s49
    s_add_u32 s85, s86, 4096
    ds_read_b128 a[128:131], v216 offset:0
    ds_read_b128 a[132:135], v216 offset:1024
    ds_read_b128 a[136:139], v216 offset:2048
    ds_read_b128 a[140:143], v216 offset:3072
    ds_read_b128 a[144:147], v216 offset:4096
    ds_read_b128 a[148:151], v216 offset:5120
    ds_read_b128 a[152:155], v216 offset:6144
    ds_read_b128 a[156:159], v216 offset:7168
    s_waitcnt lgkmcnt(0)
    v_mfma_f32_16x16x32_bf16 v[128:131], a[128:131], a[0:3], v[192:195]
    v_mfma_f32_16x16x32_bf16 v[128:131], a[132:135], a[4:7], v[128:131]
    v_mfma_f32_16x16x32_bf16 v[128:131], a[136:139], a[8:11], v[128:131]
    v_mfma_f32_16x16x32_bf16 v[128:131], a[140:143], a[12:15], v[128:131]
    v_mfma_f32_16x16x32_bf16 v[132:135], a[128:131], a[16:19], v[196:199]
    v_mfma_f32_16x16x32_bf16 v[132:135], a[132:135], a[20:23], v[132:135]
    v_mfma_f32_16x16x32_bf16 v[132:135], a[136:139], a[24:27], v[132:135]
    v_mfma_f32_16x16x32_bf16 v[132:135], a[140:143], a[28:31], v[132:135]
    v_mfma_f32_16x16x32_bf16 v[136:139], a[128:131], a[32:35], v[200:203]
    v_mfma_f32_16x16x32_bf16 v[136:139], a[132:135], a[36:39], v[136:139]
    v_mfma_f32_16x16x32_bf16 v[136:139], a[136:139], a[40:43], v[136:139]
    v_mfma_f32_16x16x32_bf16 v[136:139], a[140:143], a[44:47], v[136:139]
    v_mfma_f32_16x16x32_bf16 v[140:143], a[128:131], a[48:51], v[204:207]
    v_mfma_f32_16x16x32_bf16 v[140:143], a[132:135], a[52:55], v[140:143]
    v_mfma_f32_16x16x32_bf16 v[140:143], a[136:139], a[56:59], v[140:143]
    v_mfma_f32_16x16x32_bf16 v[140:143], a[140:143], a[60:63], v[140:143]
    v_mfma_f32_16x16x32_bf16 v[144:147], a[144:147], a[0:3], v[192:195]
    v_mfma_f32_16x16x32_bf16 v[144:147], a[148:151], a[4:7], v[144:147]
    v_mfma_f32_16x16x32_bf16 v[144:147], a[152:155], a[8:11], v[144:147]
    v_mfma_f32_16x16x32_bf16 v[144:147], a[156:159], a[12:15], v[144:147]
    v_mfma_f32_16x16x32_bf16 v[148:151], a[144:147], a[16:19], v[196:199]
    v_mfma_f32_16x16x32_bf16 v[148:151], a[148:151], a[20:23], v[148:151]
    v_mfma_f32_16x16x32_bf16 v[148:151], a[152:155], a[24:27], v[148:151]
    v_mfma_f32_16x16x32_bf16 v[148:151], a[156:159], a[28:31], v[148:151]
    v_mfma_f32_16x16x32_bf16 v[152:155], a[144:147], a[32:35], v[200:203]
    v_mfma_f32_16x16x32_bf16 v[152:155], a[148:151], a[36:39], v[152:155]
    v_mfma_f32_16x16x32_bf16 v[152:155], a[152:155], a[40:43], v[152:155]
    v_mfma_f32_16x16x32_bf16 v[152:155], a[156:159], a[44:47], v[152:155]
    v_mfma_f32_16x16x32_bf16 v[156:159], a[144:147], a[48:51], v[204:207]
    v_mfma_f32_16x16x32_bf16 v[156:159], a[148:151], a[52:55], v[156:159]
    v_mfma_f32_16x16x32_bf16 v[156:159], a[152:155], a[56:59], v[156:159]
    v_mfma_f32_16x16x32_bf16 v[156:159], a[156:159], a[60:63], v[156:159]
    s_nop 15
    v_exp_f32 v128, v128
    v_exp_f32 v129, v129
    v_exp_f32 v130, v130
    v_exp_f32 v131, v131
    s_nop 0
    v_cvt_pk_bf16_f32 v160, v128, v129
    v_cvt_pk_bf16_f32 v161, v130, v131
    v_add_f32 v222, v222, v128
    v_add_f32 v222, v222, v129
    v_add_f32 v222, v222, v130
    v_add_f32 v222, v222, v131
    v_exp_f32 v144, v144
    v_exp_f32 v145, v145
    v_exp_f32 v146, v146
    v_exp_f32 v147, v147
    s_nop 0
    v_cvt_pk_bf16_f32 v162, v144, v145
    v_cvt_pk_bf16_f32 v163, v146, v147
    v_add_f32 v222, v222, v144
    v_add_f32 v222, v222, v145
    v_add_f32 v222, v222, v146
    v_add_f32 v222, v222, v147
    v_exp_f32 v132, v132
    v_exp_f32 v133, v133
    v_exp_f32 v134, v134
    v_exp_f32 v135, v135
    s_nop 0
    v_cvt_pk_bf16_f32 v164, v132, v133
    v_cvt_pk_bf16_f32 v165, v134, v135
    v_add_f32 v223, v223, v132
    v_add_f32 v223, v223, v133
    v_add_f32 v223, v223, v134
    v_add_f32 v223, v223, v135
    v_exp_f32 v148, v148
    v_exp_f32 v149, v149
    v_exp_f32 v150, v150
    v_exp_f32 v151, v151
    s_nop 0
    v_cvt_pk_bf16_f32 v166, v148, v149
    v_cvt_pk_bf16_f32 v167, v150, v151
    v_add_f32 v223, v223, v148
    v_add_f32 v223, v223, v149
    v_add_f32 v223, v223, v150
    v_add_f32 v223, v223, v151
    v_exp_f32 v136, v136
    v_exp_f32 v137, v137
    v_exp_f32 v138, v138
    v_exp_f32 v139, v139
    s_nop 0
    v_cvt_pk_bf16_f32 v168, v136, v137
    v_cvt_pk_bf16_f32 v169, v138, v139
    v_add_f32 v224, v224, v136
    v_add_f32 v224, v224, v137
    v_add_f32 v224, v224, v138
    v_add_f32 v224, v224, v139
    v_exp_f32 v152, v152
    v_exp_f32 v153, v153
    v_exp_f32 v154, v154
    v_exp_f32 v155, v155
    s_nop 0
    v_cvt_pk_bf16_f32 v170, v152, v153
    v_cvt_pk_bf16_f32 v171, v154, v155
    v_add_f32 v224, v224, v152
    v_add_f32 v224, v224, v153
    v_add_f32 v224, v224, v154
    v_add_f32 v224, v224, v155
    v_exp_f32 v140, v140
    v_exp_f32 v141, v141
    v_exp_f32 v142, v142
    v_exp_f32 v143, v143
    s_nop 0
    v_cvt_pk_bf16_f32 v172, v140, v141
    v_cvt_pk_bf16_f32 v173, v142, v143
    v_add_f32 v225, v225, v140
    v_add_f32 v225, v225, v141
    v_add_f32 v225, v225, v142
    v_add_f32 v225, v225, v143
    v_exp_f32 v156, v156
    v_exp_f32 v157, v157
    v_exp_f32 v158, v158
    v_exp_f32 v159, v159
    s_nop 0
    v_cvt_pk_bf16_f32 v174, v156, v157
    v_cvt_pk_bf16_f32 v175, v158, v159
    v_add_f32 v225, v225, v156
    v_add_f32 v225, v225, v157
    v_add_f32 v225, v225, v158
    v_add_f32 v225, v225, v159
    buffer_load_ushort v176, v217, s[20:23], s86 offen offset:0
    buffer_load_ushort v177, v217, s[20:23], s86 offen offset:256
    buffer_load_ushort v178, v217, s[20:23], s86 offen offset:512
    buffer_load_ushort v179, v217, s[20:23], s86 offen offset:768
    buffer_load_ushort v180, v217, s[20:23], s85 offen offset:0
    buffer_load_ushort v181, v217, s[20:23], s85 offen offset:256
    buffer_load_ushort v182, v217, s[20:23], s85 offen offset:512
    buffer_load_ushort v183, v217, s[20:23], s85 offen offset:768
    s_waitcnt vmcnt(0)
    v_lshl_or_b32 v184, v177, 16, v176
    v_lshl_or_b32 v185, v179, 16, v178
    v_lshl_or_b32 v186, v181, 16, v180
    v_lshl_or_b32 v187, v183, 16, v182
    s_nop 1
    v_mfma_f32_16x16x32_bf16 v[0:3], v[184:187], v[160:163], v[0:3]
    v_mfma_f32_16x16x32_bf16 v[4:7], v[184:187], v[164:167], v[4:7]
    v_mfma_f32_16x16x32_bf16 v[8:11], v[184:187], v[168:171], v[8:11]
    v_mfma_f32_16x16x32_bf16 v[12:15], v[184:187], v[172:175], v[12:15]
    s_nop 7
    buffer_load_ushort v176, v217, s[20:23], s86 offen offset:8
    buffer_load_ushort v177, v217, s[20:23], s86 offen offset:264
    buffer_load_ushort v178, v217, s[20:23], s86 offen offset:520
    buffer_load_ushort v179, v217, s[20:23], s86 offen offset:776
    buffer_load_ushort v180, v217, s[20:23], s85 offen offset:8
    buffer_load_ushort v181, v217, s[20:23], s85 offen offset:264
    buffer_load_ushort v182, v217, s[20:23], s85 offen offset:520
    buffer_load_ushort v183, v217, s[20:23], s85 offen offset:776
    s_waitcnt vmcnt(0)
    v_lshl_or_b32 v184, v177, 16, v176
    v_lshl_or_b32 v185, v179, 16, v178
    v_lshl_or_b32 v186, v181, 16, v180
    v_lshl_or_b32 v187, v183, 16, v182
    s_nop 1
    v_mfma_f32_16x16x32_bf16 v[16:19], v[184:187], v[160:163], v[16:19]
    v_mfma_f32_16x16x32_bf16 v[20:23], v[184:187], v[164:167], v[20:23]
    v_mfma_f32_16x16x32_bf16 v[24:27], v[184:187], v[168:171], v[24:27]
    v_mfma_f32_16x16x32_bf16 v[28:31], v[184:187], v[172:175], v[28:31]
    s_nop 7
    buffer_load_ushort v176, v217, s[20:23], s86 offen offset:64
    buffer_load_ushort v177, v217, s[20:23], s86 offen offset:320
    buffer_load_ushort v178, v217, s[20:23], s86 offen offset:576
    buffer_load_ushort v179, v217, s[20:23], s86 offen offset:832
    buffer_load_ushort v180, v217, s[20:23], s85 offen offset:64
    buffer_load_ushort v181, v217, s[20:23], s85 offen offset:320
    buffer_load_ushort v182, v217, s[20:23], s85 offen offset:576
    buffer_load_ushort v183, v217, s[20:23], s85 offen offset:832
    s_waitcnt vmcnt(0)
    v_lshl_or_b32 v184, v177, 16, v176
    v_lshl_or_b32 v185, v179, 16, v178
    v_lshl_or_b32 v186, v181, 16, v180
    v_lshl_or_b32 v187, v183, 16, v182
    s_nop 1
    v_mfma_f32_16x16x32_bf16 v[32:35], v[184:187], v[160:163], v[32:35]
    v_mfma_f32_16x16x32_bf16 v[36:39], v[184:187], v[164:167], v[36:39]
    v_mfma_f32_16x16x32_bf16 v[40:43], v[184:187], v[168:171], v[40:43]
    v_mfma_f32_16x16x32_bf16 v[44:47], v[184:187], v[172:175], v[44:47]
    s_nop 7
    buffer_load_ushort v176, v217, s[20:23], s86 offen offset:72
    buffer_load_ushort v177, v217, s[20:23], s86 offen offset:328
    buffer_load_ushort v178, v217, s[20:23], s86 offen offset:584
    buffer_load_ushort v179, v217, s[20:23], s86 offen offset:840
    buffer_load_ushort v180, v217, s[20:23], s85 offen offset:72
    buffer_load_ushort v181, v217, s[20:23], s85 offen offset:328
    buffer_load_ushort v182, v217, s[20:23], s85 offen offset:584
    buffer_load_ushort v183, v217, s[20:23], s85 offen offset:840
    s_waitcnt vmcnt(0)
    v_lshl_or_b32 v184, v177, 16, v176
    v_lshl_or_b32 v185, v179, 16, v178
    v_lshl_or_b32 v186, v181, 16, v180
    v_lshl_or_b32 v187, v183, 16, v182
    s_nop 1
    v_mfma_f32_16x16x32_bf16 v[48:51], v[184:187], v[160:163], v[48:51]
    v_mfma_f32_16x16x32_bf16 v[52:55], v[184:187], v[164:167], v[52:55]
    v_mfma_f32_16x16x32_bf16 v[56:59], v[184:187], v[168:171], v[56:59]
    v_mfma_f32_16x16x32_bf16 v[60:63], v[184:187], v[172:175], v[60:63]
    s_nop 7
    buffer_load_ushort v176, v217, s[20:23], s86 offen offset:128
    buffer_load_ushort v177, v217, s[20:23], s86 offen offset:384
    buffer_load_ushort v178, v217, s[20:23], s86 offen offset:640
    buffer_load_ushort v179, v217, s[20:23], s86 offen offset:896
    buffer_load_ushort v180, v217, s[20:23], s85 offen offset:128
    buffer_load_ushort v181, v217, s[20:23], s85 offen offset:384
    buffer_load_ushort v182, v217, s[20:23], s85 offen offset:640
    buffer_load_ushort v183, v217, s[20:23], s85 offen offset:896
    s_waitcnt vmcnt(0)
    v_lshl_or_b32 v184, v177, 16, v176
    v_lshl_or_b32 v185, v179, 16, v178
    v_lshl_or_b32 v186, v181, 16, v180
    v_lshl_or_b32 v187, v183, 16, v182
    s_nop 1
    v_mfma_f32_16x16x32_bf16 v[64:67], v[184:187], v[160:163], v[64:67]
    v_mfma_f32_16x16x32_bf16 v[68:71], v[184:187], v[164:167], v[68:71]
    v_mfma_f32_16x16x32_bf16 v[72:75], v[184:187], v[168:171], v[72:75]
    v_mfma_f32_16x16x32_bf16 v[76:79], v[184:187], v[172:175], v[76:79]
    s_nop 7
    buffer_load_ushort v176, v217, s[20:23], s86 offen offset:136
    buffer_load_ushort v177, v217, s[20:23], s86 offen offset:392
    buffer_load_ushort v178, v217, s[20:23], s86 offen offset:648
    buffer_load_ushort v179, v217, s[20:23], s86 offen offset:904
    buffer_load_ushort v180, v217, s[20:23], s85 offen offset:136
    buffer_load_ushort v181, v217, s[20:23], s85 offen offset:392
    buffer_load_ushort v182, v217, s[20:23], s85 offen offset:648
    buffer_load_ushort v183, v217, s[20:23], s85 offen offset:904
    s_waitcnt vmcnt(0)
    v_lshl_or_b32 v184, v177, 16, v176
    v_lshl_or_b32 v185, v179, 16, v178
    v_lshl_or_b32 v186, v181, 16, v180
    v_lshl_or_b32 v187, v183, 16, v182
    s_nop 1
    v_mfma_f32_16x16x32_bf16 v[80:83], v[184:187], v[160:163], v[80:83]
    v_mfma_f32_16x16x32_bf16 v[84:87], v[184:187], v[164:167], v[84:87]
    v_mfma_f32_16x16x32_bf16 v[88:91], v[184:187], v[168:171], v[88:91]
    v_mfma_f32_16x16x32_bf16 v[92:95], v[184:187], v[172:175], v[92:95]
    s_nop 7
    buffer_load_ushort v176, v217, s[20:23], s86 offen offset:192
    buffer_load_ushort v177, v217, s[20:23], s86 offen offset:448
    buffer_load_ushort v178, v217, s[20:23], s86 offen offset:704
    buffer_load_ushort v179, v217, s[20:23], s86 offen offset:960
    buffer_load_ushort v180, v217, s[20:23], s85 offen offset:192
    buffer_load_ushort v181, v217, s[20:23], s85 offen offset:448
    buffer_load_ushort v182, v217, s[20:23], s85 offen offset:704
    buffer_load_ushort v183, v217, s[20:23], s85 offen offset:960
    s_waitcnt vmcnt(0)
    v_lshl_or_b32 v184, v177, 16, v176
    v_lshl_or_b32 v185, v179, 16, v178
    v_lshl_or_b32 v186, v181, 16, v180
    v_lshl_or_b32 v187, v183, 16, v182
    s_nop 1
    v_mfma_f32_16x16x32_bf16 v[96:99], v[184:187], v[160:163], v[96:99]
    v_mfma_f32_16x16x32_bf16 v[100:103], v[184:187], v[164:167], v[100:103]
    v_mfma_f32_16x16x32_bf16 v[104:107], v[184:187], v[168:171], v[104:107]
    v_mfma_f32_16x16x32_bf16 v[108:111], v[184:187], v[172:175], v[108:111]
    s_nop 7
    buffer_load_ushort v176, v217, s[20:23], s86 offen offset:200
    buffer_load_ushort v177, v217, s[20:23], s86 offen offset:456
    buffer_load_ushort v178, v217, s[20:23], s86 offen offset:712
    buffer_load_ushort v179, v217, s[20:23], s86 offen offset:968
    buffer_load_ushort v180, v217, s[20:23], s85 offen offset:200
    buffer_load_ushort v181, v217, s[20:23], s85 offen offset:456
    buffer_load_ushort v182, v217, s[20:23], s85 offen offset:712
    buffer_load_ushort v183, v217, s[20:23], s85 offen offset:968
    s_waitcnt vmcnt(0)
    v_lshl_or_b32 v184, v177, 16, v176
    v_lshl_or_b32 v185, v179, 16, v178
    v_lshl_or_b32 v186, v181, 16, v180
    v_lshl_or_b32 v187, v183, 16, v182
    s_nop 1
    v_mfma_f32_16x16x32_bf16 v[112:115], v[184:187], v[160:163], v[112:115]
    v_mfma_f32_16x16x32_bf16 v[116:119], v[184:187], v[164:167], v[116:119]
    v_mfma_f32_16x16x32_bf16 v[120:123], v[184:187], v[168:171], v[120:123]
    v_mfma_f32_16x16x32_bf16 v[124:127], v[184:187], v[172:175], v[124:127]
    s_nop 7
    v_add_u32 v216, 8192, v216
    s_add_u32 s78, s78, 1
    s_cmp_lt_u32 s78, 16
    s_nop 15
    s_cbranch_scc1 L_slow_pv
    v_mov_b32 v226, v222
    s_nop 1
    v_permlane16_swap_b32 v222, v226
    s_nop 1
    v_add_f32 v222, v222, v226
    v_mov_b32 v226, v222
    s_nop 1
    v_permlane32_swap_b32 v222, v226
    s_nop 1
    v_add_f32 v222, v222, v226
    v_rcp_f32 v222, v222
    v_mov_b32 v226, v223
    s_nop 1
    v_permlane16_swap_b32 v223, v226
    s_nop 1
    v_add_f32 v223, v223, v226
    v_mov_b32 v226, v223
    s_nop 1
    v_permlane32_swap_b32 v223, v226
    s_nop 1
    v_add_f32 v223, v223, v226
    v_rcp_f32 v223, v223
    v_mov_b32 v226, v224
    s_nop 1
    v_permlane16_swap_b32 v224, v226
    s_nop 1
    v_add_f32 v224, v224, v226
    v_mov_b32 v226, v224
    s_nop 1
    v_permlane32_swap_b32 v224, v226
    s_nop 1
    v_add_f32 v224, v224, v226
    v_rcp_f32 v224, v224
    v_mov_b32 v226, v225
    s_nop 1
    v_permlane16_swap_b32 v225, v226
    s_nop 1
    v_add_f32 v225, v225, v226
    v_mov_b32 v226, v225
    s_nop 1
    v_permlane32_swap_b32 v225, v226
    s_nop 1
    v_add_f32 v225, v225, v226
    v_rcp_f32 v225, v225
    s_nop 1
    v_mul_f32 v0, v0, v222
    v_mul_f32 v1, v1, v222
    v_mul_f32 v2, v2, v222
    v_mul_f32 v3, v3, v222
    v_cvt_pk_bf16_f32 v128, v0, v1
    v_cvt_pk_bf16_f32 v129, v2, v3
    v_mul_f32 v16, v16, v222
    v_mul_f32 v17, v17, v222
    v_mul_f32 v18, v18, v222
    v_mul_f32 v19, v19, v222
    v_cvt_pk_bf16_f32 v130, v16, v17
    v_cvt_pk_bf16_f32 v131, v18, v19
    buffer_store_dwordx4 v[128:131], v246, s[24:27], s30 offen offset:0
    s_nop 1
    v_mul_f32 v4, v4, v223
    v_mul_f32 v5, v5, v223
    v_mul_f32 v6, v6, v223
    v_mul_f32 v7, v7, v223
    v_cvt_pk_bf16_f32 v132, v4, v5
    v_cvt_pk_bf16_f32 v133, v6, v7
    v_mul_f32 v20, v20, v223
    v_mul_f32 v21, v21, v223
    v_mul_f32 v22, v22, v223
    v_mul_f32 v23, v23, v223
    v_cvt_pk_bf16_f32 v134, v20, v21
    v_cvt_pk_bf16_f32 v135, v22, v23
    buffer_store_dwordx4 v[132:135], v246, s[24:27], s31 offen offset:0
    s_nop 1
    v_mul_f32 v8, v8, v224
    v_mul_f32 v9, v9, v224
    v_mul_f32 v10, v10, v224
    v_mul_f32 v11, v11, v224
    v_cvt_pk_bf16_f32 v136, v8, v9
    v_cvt_pk_bf16_f32 v137, v10, v11
    v_mul_f32 v24, v24, v224
    v_mul_f32 v25, v25, v224
    v_mul_f32 v26, v26, v224
    v_mul_f32 v27, v27, v224
    v_cvt_pk_bf16_f32 v138, v24, v25
    v_cvt_pk_bf16_f32 v139, v26, v27
    buffer_store_dwordx4 v[136:139], v246, s[24:27], s32 offen offset:0
    s_nop 1
    v_mul_f32 v12, v12, v225
    v_mul_f32 v13, v13, v225
    v_mul_f32 v14, v14, v225
    v_mul_f32 v15, v15, v225
    v_cvt_pk_bf16_f32 v140, v12, v13
    v_cvt_pk_bf16_f32 v141, v14, v15
    v_mul_f32 v28, v28, v225
    v_mul_f32 v29, v29, v225
    v_mul_f32 v30, v30, v225
    v_mul_f32 v31, v31, v225
    v_cvt_pk_bf16_f32 v142, v28, v29
    v_cvt_pk_bf16_f32 v143, v30, v31
    buffer_store_dwordx4 v[140:143], v246, s[24:27], s33 offen offset:0
    s_nop 1
    v_mul_f32 v32, v32, v222
    v_mul_f32 v33, v33, v222
    v_mul_f32 v34, v34, v222
    v_mul_f32 v35, v35, v222
    v_cvt_pk_bf16_f32 v144, v32, v33
    v_cvt_pk_bf16_f32 v145, v34, v35
    v_mul_f32 v48, v48, v222
    v_mul_f32 v49, v49, v222
    v_mul_f32 v50, v50, v222
    v_mul_f32 v51, v51, v222
    v_cvt_pk_bf16_f32 v146, v48, v49
    v_cvt_pk_bf16_f32 v147, v50, v51
    buffer_store_dwordx4 v[144:147], v246, s[24:27], s30 offen offset:64
    s_nop 1
    v_mul_f32 v36, v36, v223
    v_mul_f32 v37, v37, v223
    v_mul_f32 v38, v38, v223
    v_mul_f32 v39, v39, v223
    v_cvt_pk_bf16_f32 v148, v36, v37
    v_cvt_pk_bf16_f32 v149, v38, v39
    v_mul_f32 v52, v52, v223
    v_mul_f32 v53, v53, v223
    v_mul_f32 v54, v54, v223
    v_mul_f32 v55, v55, v223
    v_cvt_pk_bf16_f32 v150, v52, v53
    v_cvt_pk_bf16_f32 v151, v54, v55
    buffer_store_dwordx4 v[148:151], v246, s[24:27], s31 offen offset:64
    s_nop 1
    v_mul_f32 v40, v40, v224
    v_mul_f32 v41, v41, v224
    v_mul_f32 v42, v42, v224
    v_mul_f32 v43, v43, v224
    v_cvt_pk_bf16_f32 v152, v40, v41
    v_cvt_pk_bf16_f32 v153, v42, v43
    v_mul_f32 v56, v56, v224
    v_mul_f32 v57, v57, v224
    v_mul_f32 v58, v58, v224
    v_mul_f32 v59, v59, v224
    v_cvt_pk_bf16_f32 v154, v56, v57
    v_cvt_pk_bf16_f32 v155, v58, v59
    buffer_store_dwordx4 v[152:155], v246, s[24:27], s32 offen offset:64
    s_nop 1
    v_mul_f32 v44, v44, v225
    v_mul_f32 v45, v45, v225
    v_mul_f32 v46, v46, v225
    v_mul_f32 v47, v47, v225
    v_cvt_pk_bf16_f32 v156, v44, v45
    v_cvt_pk_bf16_f32 v157, v46, v47
    v_mul_f32 v60, v60, v225
    v_mul_f32 v61, v61, v225
    v_mul_f32 v62, v62, v225
    v_mul_f32 v63, v63, v225
    v_cvt_pk_bf16_f32 v158, v60, v61
    v_cvt_pk_bf16_f32 v159, v62, v63
    buffer_store_dwordx4 v[156:159], v246, s[24:27], s33 offen offset:64
    s_nop 1
    v_mul_f32 v64, v64, v222
    v_mul_f32 v65, v65, v222
    v_mul_f32 v66, v66, v222
    v_mul_f32 v67, v67, v222
    v_cvt_pk_bf16_f32 v128, v64, v65
    v_cvt_pk_bf16_f32 v129, v66, v67
    v_mul_f32 v80, v80, v222
    v_mul_f32 v81, v81, v222
    v_mul_f32 v82, v82, v222
    v_mul_f32 v83, v83, v222
    v_cvt_pk_bf16_f32 v130, v80, v81
    v_cvt_pk_bf16_f32 v131, v82, v83
    buffer_store_dwordx4 v[128:131], v246, s[24:27], s30 offen offset:128
    s_nop 1
    v_mul_f32 v68, v68, v223
    v_mul_f32 v69, v69, v223
    v_mul_f32 v70, v70, v223
    v_mul_f32 v71, v71, v223
    v_cvt_pk_bf16_f32 v132, v68, v69
    v_cvt_pk_bf16_f32 v133, v70, v71
    v_mul_f32 v84, v84, v223
    v_mul_f32 v85, v85, v223
    v_mul_f32 v86, v86, v223
    v_mul_f32 v87, v87, v223
    v_cvt_pk_bf16_f32 v134, v84, v85
    v_cvt_pk_bf16_f32 v135, v86, v87
    buffer_store_dwordx4 v[132:135], v246, s[24:27], s31 offen offset:128
    s_nop 1
    v_mul_f32 v72, v72, v224
    v_mul_f32 v73, v73, v224
    v_mul_f32 v74, v74, v224
    v_mul_f32 v75, v75, v224
    v_cvt_pk_bf16_f32 v136, v72, v73
    v_cvt_pk_bf16_f32 v137, v74, v75
    v_mul_f32 v88, v88, v224
    v_mul_f32 v89, v89, v224
    v_mul_f32 v90, v90, v224
    v_mul_f32 v91, v91, v224
    v_cvt_pk_bf16_f32 v138, v88, v89
    v_cvt_pk_bf16_f32 v139, v90, v91
    buffer_store_dwordx4 v[136:139], v246, s[24:27], s32 offen offset:128
    s_nop 1
    v_mul_f32 v76, v76, v225
    v_mul_f32 v77, v77, v225
    v_mul_f32 v78, v78, v225
    v_mul_f32 v79, v79, v225
    v_cvt_pk_bf16_f32 v140, v76, v77
    v_cvt_pk_bf16_f32 v141, v78, v79
    v_mul_f32 v92, v92, v225
    v_mul_f32 v93, v93, v225
    v_mul_f32 v94, v94, v225
    v_mul_f32 v95, v95, v225
    v_cvt_pk_bf16_f32 v142, v92, v93
    v_cvt_pk_bf16_f32 v143, v94, v95
    buffer_store_dwordx4 v[140:143], v246, s[24:27], s33 offen offset:128
    s_nop 1
    v_mul_f32 v96, v96, v222
    v_mul_f32 v97, v97, v222
    v_mul_f32 v98, v98, v222
    v_mul_f32 v99, v99, v222
    v_cvt_pk_bf16_f32 v144, v96, v97
    v_cvt_pk_bf16_f32 v145, v98, v99
    v_mul_f32 v112, v112, v222
    v_mul_f32 v113, v113, v222
    v_mul_f32 v114, v114, v222
    v_mul_f32 v115, v115, v222
    v_cvt_pk_bf16_f32 v146, v112, v113
    v_cvt_pk_bf16_f32 v147, v114, v115
    buffer_store_dwordx4 v[144:147], v246, s[24:27], s30 offen offset:192
    s_nop 1
    v_mul_f32 v100, v100, v223
    v_mul_f32 v101, v101, v223
    v_mul_f32 v102, v102, v223
    v_mul_f32 v103, v103, v223
    v_cvt_pk_bf16_f32 v148, v100, v101
    v_cvt_pk_bf16_f32 v149, v102, v103
    v_mul_f32 v116, v116, v223
    v_mul_f32 v117, v117, v223
    v_mul_f32 v118, v118, v223
    v_mul_f32 v119, v119, v223
    v_cvt_pk_bf16_f32 v150, v116, v117
    v_cvt_pk_bf16_f32 v151, v118, v119
    buffer_store_dwordx4 v[148:151], v246, s[24:27], s31 offen offset:192
    s_nop 1
    v_mul_f32 v104, v104, v224
    v_mul_f32 v105, v105, v224
    v_mul_f32 v106, v106, v224
    v_mul_f32 v107, v107, v224
    v_cvt_pk_bf16_f32 v152, v104, v105
    v_cvt_pk_bf16_f32 v153, v106, v107
    v_mul_f32 v120, v120, v224
    v_mul_f32 v121, v121, v224
    v_mul_f32 v122, v122, v224
    v_mul_f32 v123, v123, v224
    v_cvt_pk_bf16_f32 v154, v120, v121
    v_cvt_pk_bf16_f32 v155, v122, v123
    buffer_store_dwordx4 v[152:155], v246, s[24:27], s32 offen offset:192
    s_nop 1
    v_mul_f32 v108, v108, v225
    v_mul_f32 v109, v109, v225
    v_mul_f32 v110, v110, v225
    v_mul_f32 v111, v111, v225
    v_cvt_pk_bf16_f32 v156, v108, v109
    v_cvt_pk_bf16_f32 v157, v110, v111
    v_mul_f32 v124, v124, v225
    v_mul_f32 v125, v125, v225
    v_mul_f32 v126, v126, v225
    v_mul_f32 v127, v127, v225
    v_cvt_pk_bf16_f32 v158, v124, v125
    v_cvt_pk_bf16_f32 v159, v126, v127
    buffer_store_dwordx4 v[156:159], v246, s[24:27], s33 offen offset:192
    s_nop 1
    s_waitcnt vmcnt(0)
    s_add_u32 s44, s44, 256
    s_add_u32 s79, s79, 1
    s_cmp_lt_u32 s79, 4
    s_cbranch_scc1 L_slow_pass
    s_endpgm

.section .rodata,"a"
.p2align 6
.amdhsa_kernel standalone__gqa_softmax__near_ridge_kernel
  .amdhsa_next_free_vgpr 512
  .amdhsa_next_free_sgpr 96
  .amdhsa_accum_offset 256
  .amdhsa_group_segment_fixed_size 0
  .amdhsa_kernarg_size 48
  .amdhsa_user_sgpr_count 2
  .amdhsa_user_sgpr_kernarg_segment_ptr 1
  .amdhsa_system_sgpr_workgroup_id_x 1
.end_amdhsa_kernel
```
